```python
import torch

def _softmax(x, axis=-1):
    return torch.softmax(x, dim=axis)
def _gelu(x):
    return torch.nn.functional.gelu(x, approximate="tanh")
def _silu(x):
    return torch.nn.functional.silu(x)
def _sigmoid(x):
    return torch.sigmoid(x)
def _layernorm(x, axis=-1, eps=1e-5):
    m = x.mean(dim=axis, keepdim=True)
    v = x.var(dim=axis, keepdim=True, unbiased=False)
    return (x - m) / torch.sqrt(v + eps)
def _scatter_add(tgt, idx, src, axis=0):
    return tgt.clone().index_add_(axis, idx, src)
def _segment_sum(src, seg, n):
    out = torch.zeros((n,) + src.shape[1:], dtype=src.dtype)
    return out.index_add_(0, seg, src)
def _pad(x, pw):
    flat = tuple(v for pair in reversed(pw) for v in pair)
    return torch.nn.functional.pad(x, flat)

kernel_name = 'concat_heads__gqa_block_cached__mha_block_cached__near_ridge'

def setup_inputs():

    _w = (lambda a: (lambda t: t.to(torch.bfloat16) if t.is_floating_point() else t)(torch.as_tensor(a)))
    def _A_setup():
        B, Sq, D = 16, 96, 576
        Hq, Hkv, Sk, Dh = 32, 16, 1024, 128
        assert Hq % Hkv == 0, (Hq, Hkv)
        return {
            "x": _w((lambda *s: torch.randn(*s, dtype=torch.bfloat16) * 0.8)(B, Sq, D)),
            "k_cache": _w((lambda *s: torch.randn(*s, dtype=torch.bfloat16) * 0.8)(B, Hkv, Sk, Dh)),
            "v_cache": _w((lambda *s: torch.randn(*s, dtype=torch.bfloat16) * 0.05)(B, Hkv, Sk, Dh)),
            "wq": _w((lambda *s: torch.randn(*s, dtype=torch.bfloat16) * 0.8)(D, Hq * Dh) * (D ** -0.5)),
            "wo": _w((lambda *s: torch.randn(*s, dtype=torch.bfloat16) * 0.05)(Hq * Dh, D) * ((Hq * Dh) ** -0.5)),
        }
    _A_in = _A_setup()

    def _B_setup():
        B, Sq, D = 16, 96, 576
        H, Sk, Dh = 32, 1024, 128
        return {
            "x": _w((lambda *s: torch.randn(*s, dtype=torch.bfloat16) * 0.8)(B, Sq, D)),
            "k_cache": _w((lambda *s: torch.randn(*s, dtype=torch.bfloat16) * 0.8)(B, H, Sk, Dh)),
            "v_cache": _w((lambda *s: torch.randn(*s, dtype=torch.bfloat16) * 0.05)(B, H, Sk, Dh)),
            "wq": _w((lambda *s: torch.randn(*s, dtype=torch.bfloat16) * 0.8)(D, H * Dh) * (D ** -0.5)),
            "wo": _w((lambda *s: torch.randn(*s, dtype=torch.bfloat16) * 0.05)(H * Dh, D) * ((H * Dh) ** -0.5)),
        }
    _B_in = _B_setup()

    return {
        "A_x": _A_in["x"],
        "A_k_cache": _A_in["k_cache"],
        "A_v_cache": _A_in["v_cache"],
        "A_wq": _A_in["wq"],
        "A_wo": _A_in["wo"],
        "B_x": _B_in["x"],
        "B_k_cache": _B_in["k_cache"],
        "B_v_cache": _B_in["v_cache"],
        "B_wq": _B_in["wq"],
        "B_wo": _B_in["wo"],
    }

def reference(A_x, A_k_cache, A_v_cache, A_wq, A_wo, B_x, B_k_cache, B_v_cache, B_wq, B_wo):
    def _A_ref(x, k_cache, v_cache, wq, wo):
        B, Sq, D = x.shape
        Hq, Dh = 32, 128
        Hkv = k_cache.shape[1]
        rep = Hq // Hkv
        q = (lambda x, *d: x.permute(*d))((x @ wq).reshape(B, Sq, Hq, Dh), 0, 2, 1, 3)
        k = (lambda x, n, axis: torch.repeat_interleave(x, n, dim=axis))(k_cache, rep, axis=1)
        v = (lambda x, n, axis: torch.repeat_interleave(x, n, dim=axis))(v_cache, rep, axis=1)
        scores = torch.einsum("bhqd,bhkd->bhqk", q, k) * (Dh ** -0.5)
        p = _softmax(scores, axis=-1)
        o = torch.einsum("bhqk,bhkd->bhqd", p, v)
        return (lambda x, *d: x.permute(*d))(o, 0, 2, 1, 3).reshape(B, Sq, Hq * Dh) @ wo

    def _B_ref(x, k_cache, v_cache, wq, wo):
        B, Sq, D = x.shape
        H, Dh = 32, 128
        q = (lambda x, *d: x.permute(*d))((x @ wq).reshape(B, Sq, H, Dh), 0, 2, 1, 3)
        scores = torch.einsum("bhqd,bhkd->bhqk", q, k_cache) * (Dh ** -0.5)
        p = _softmax(scores, axis=-1)
        o = torch.einsum("bhqk,bhkd->bhqd", p, v_cache)
        return (lambda x, *d: x.permute(*d))(o, 0, 2, 1, 3).reshape(B, Sq, H * Dh) @ wo

    a = _A_ref(A_x, A_k_cache, A_v_cache, A_wq, A_wo)
    b = _B_ref(B_x, B_k_cache, B_v_cache, B_wq, B_wo)
    return torch.concatenate([a, b], axis=-1)
```

```asm
; @launch grid=(256,1,1) block=(512,1,1) lds=163840
.amdgcn_target "amdgcn-amd-amdhsa--gfx950"
.text
.globl concat_heads__gqa_block_cached__mha_block_cached__near_ridge_kernel
.p2align 8
.type concat_heads__gqa_block_cached__mha_block_cached__near_ridge_kernel,@function
concat_heads__gqa_block_cached__mha_block_cached__near_ridge_kernel:
  s_cmp_ge_u32 s2, 256
  s_cbranch_scc1 L_end
  s_load_dwordx16 s[4:19], s[0:1], 0
  s_load_dwordx8 s[20:27], s[0:1], 64
  s_load_dwordx2 s[28:29], s[0:1], 96
  v_lshrrev_b32 v1, 6, v0
  v_and_b32 v250, 63, v0
  v_readfirstlane_b32 s85, v1
  s_and_b32 s84, s2, 1
  s_xor_b32 s84, s84, 1
  s_and_b32 s70, s2, 6
  s_bfe_u32 s31, s2, 0x10003
  s_add_u32 s70, s70, s31
  s_lshr_b32 s71, s2, 4
  s_and_b32 s30, s85, 3
  s_lshl_b32 s31, s70, 2
  s_add_u32 s60, s71, s31
  s_mul_i32 s31, s60, 57
  s_lshr_b32 s31, s31, 9
  s_mul_i32 s31, s31, 9
  s_sub_u32 s60, s60, s31
  v_lshrrev_b32 v1, 3, v250
  v_and_b32 v2, 7, v250
  s_mul_i32 s31, s30, 24
  v_add_u32 v3, s31, v1
  v_bfe_u32 v4, v3, 1, 3
  v_xor_b32 v4, v4, v2
  v_mul_u32_u24 v3, 1152, v3
  v_lshl_add_u32 v224, v4, 4, v3
  v_xor_b32 v225, 64, v224
  v_add_u32 v225, 8192, v225
  v_add_u32 v226, 16384, v224
  v_lshrrev_b32 v1, 4, v250
  v_and_b32 v2, 15, v250
  v_lshlrev_b32 v4, 1, v1
  v_xor_b32 v4, v4, v2
  s_lshl_b32 s31, s30, 4
  v_add_u32 v3, s31, v1
  v_lshlrev_b32 v3, 13, v3
  v_lshl_add_u32 v227, v4, 4, v3
  v_add_u32 v228, 31744, v227
  v_xor_b32 v229, 128, v227
  v_add_u32 v230, 95232, v229
  v_add_u32 v229, 63488, v229
  v_lshlrev_b32 v251, 4, v250
  s_mul_i32 s68, s30, 3072
  s_lshl_b32 s69, s30, 12
  s_add_u32 s69, s69, 12288
  s_lshl_b32 s61, s70, 10
  s_mul_i32 s31, s60, 64
  s_lshr_b32 s31, s31, 8
  s_mul_i32 s31, s31, 4
  s_sub_u32 s88, s60, s31
  s_mov_b32 s86, 1985229328
  s_mov_b32 s87, 8
  s_cmp_eq_u32 s88, 1
  s_cselect_b32 s86, 2271363841, s86
  s_cselect_b32 s87, 5, s87
  s_cmp_eq_u32 s88, 2
  s_cselect_b32 s86, 1483940880, s86
  s_cselect_b32 s87, 6, s87
  s_cmp_eq_u32 s88, 3
  s_cselect_b32 s86, 1703162369, s86
  s_cselect_b32 s87, 7, s87
  s_mul_i32 s3, s71, 110592
  s_waitcnt lgkmcnt(0)
  s_cmp_eq_u32 s84, 1
  s_cselect_b64 s[4:5], s[14:15], s[4:5]
  s_cselect_b64 s[10:11], s[20:21], s[10:11]
  s_cselect_b64 s[6:7], s[16:17], s[6:7]
  s_cselect_b64 s[8:9], s[18:19], s[8:9]
  s_cselect_b64 s[12:13], s[22:23], s[12:13]
  s_add_u32 s72, s4, s3
  s_addc_u32 s73, s5, 0
  s_and_b32 s73, s73, 0xffff
  s_mov_b32 s74, 110592
  s_mov_b32 s75, 0x20000
  s_mov_b32 s76, s10
  s_and_b32 s77, s11, 0xffff
  s_mov_b32 s78, 4718592
  s_mov_b32 s79, 0x20000
  s_cmp_lt_u32 s85, 4
  s_cbranch_scc1 L_attn
  s_lshl_b32 s31, s71, 3
  s_add_u32 s52, s31, s70
  s_add_u32 s31, s84, 19
  s_lshl_b32 s54, s52, s31
  s_lshl_b32 s55, s30, 11
  s_add_u32 s54, s54, s55
  s_lshl_b32 s53, 1, s31
  s_sub_u32 s53, s53, s55
  s_add_u32 s32, s6, s54
  s_addc_u32 s33, s7, 0
  s_and_b32 s33, s33, 0xffff
  s_mov_b32 s34, s53
  s_mov_b32 s35, 0x20000
  s_add_u32 s36, s8, s54
  s_addc_u32 s37, s9, 0
  s_and_b32 s37, s37, 0xffff
  s_mov_b32 s38, s53
  s_mov_b32 s39, 0x20000
  s_lshl_b32 s50, s84, 18
  s_mov_b32 s44, 0
  s_mov_b32 s45, 0
  s_mov_b32 s46, 0
  s_mov_b32 s47, 0
  s_mul_i32 s31, s30, 2112
  s_add_u32 s48, s31, 96256
  s_mov_b32 s90, s48
  s_add_u32 s49, s31, 163840
  s_add_u32 s51, s44, s45
  s_xor_b32 s45, s45, s50
  s_cselect_b32 s31, 0, 8192
  s_add_u32 s44, s44, s31
  s_and_b32 s31, s44, s50
  s_add_u32 s44, s44, s31
  s_add_u32 s90, s90, 16896
  s_cmp_eq_u32 s90, s49
  s_cselect_b32 s31, 67584, 0
  s_sub_u32 s90, s90, s31
  s_add_u32 s51, s44, s45
  s_xor_b32 s45, s45, s50
  s_cselect_b32 s31, 0, 8192
  s_add_u32 s44, s44, s31
  s_and_b32 s31, s44, s50
  s_add_u32 s44, s44, s31
  s_add_u32 s48, s48, 16896
  s_cmp_eq_u32 s48, s49
  s_cselect_b32 s31, 67584, 0
  s_sub_u32 s48, s48, s31
  s_add_u32 s51, s46, s47
  s_cmp_eq_u32 s84, 0
  s_cselect_b32 s46, 8192, 0
  s_add_u32 s90, s90, 16896
  s_cmp_eq_u32 s90, s49
  s_cselect_b32 s31, 67584, 0
  s_sub_u32 s90, s90, s31
  s_add_u32 s51, s44, s45
  s_xor_b32 s45, s45, s50
  s_cselect_b32 s31, 0, 8192
  s_add_u32 s44, s44, s31
  s_and_b32 s31, s44, s50
  s_add_u32 s44, s44, s31
  s_add_u32 s48, s48, 16896
  s_cmp_eq_u32 s48, s49
  s_cselect_b32 s31, 67584, 0
  s_sub_u32 s48, s48, s31
  s_add_u32 s51, s46, s47
  s_xor_b32 s47, s47, s50
  s_cselect_b32 s31, 0, 8192
  s_add_u32 s46, s46, s31
  s_and_b32 s31, s46, s50
  s_add_u32 s46, s46, s31
  s_add_u32 s90, s90, 16896
  s_cmp_eq_u32 s90, s49
  s_cselect_b32 s31, 67584, 0
  s_sub_u32 s90, s90, s31
  s_add_u32 s51, s44, s45
  s_xor_b32 s45, s45, s50
  s_cselect_b32 s31, 0, 8192
  s_add_u32 s44, s44, s31
  s_and_b32 s31, s44, s50
  s_add_u32 s44, s44, s31
  s_add_u32 s48, s48, 16896
  s_cmp_eq_u32 s48, s49
  s_cselect_b32 s31, 67584, 0
  s_sub_u32 s48, s48, s31
  s_mov_b32 s54, 1040356334
  s_mov_b32 s55, 1040356334
  v_and_b32 v1, 15, v250
  v_lshrrev_b32 v2, 4, v250
  v_lshrrev_b32 v3, 1, v1
  v_xor_b32 v4, v2, v3
  v_lshlrev_b32 v4, 4, v4
  v_lshl_add_u32 v231, v1, 7, v4
  v_xor_b32 v232, 64, v231
  v_mul_u32_u24 v4, 272, v1
  v_lshl_add_u32 v4, v2, 3, v4
  s_lshl_b32 s31, s30, 6
  v_add_u32 v241, s31, v4
  v_bfe_u32 v3, v250, 2, 3
  v_lshlrev_b32 v3, 1, v3
  v_bfe_u32 v4, v250, 1, 1
  s_lshl_b32 s31, s30, 2
  v_add_u32 v4, s31, v4
  v_xor_b32 v4, v4, v3
  v_lshlrev_b32 v4, 4, v4
  v_lshrrev_b32 v3, 2, v1
  v_lshl_add_u32 v3, v2, 3, v3
  v_lshl_add_u32 v4, v3, 8, v4
  v_and_b32 v5, 1, v250
  v_lshl_add_u32 v4, v5, 3, v4
  v_add_u32 v233, 12288, v4
  v_xor_b32 v234, 32, v233
  v_mov_b64 v[0:1], 0
  v_mov_b64 v[2:3], 0
  v_mov_b64 v[4:5], 0
  v_mov_b64 v[6:7], 0
  v_mov_b64 v[8:9], 0
  v_mov_b64 v[10:11], 0
  v_mov_b64 v[12:13], 0
  v_mov_b64 v[14:15], 0
  v_mov_b64 v[16:17], 0
  v_mov_b64 v[18:19], 0
  v_mov_b64 v[20:21], 0
  v_mov_b64 v[22:23], 0
  v_mov_b64 v[24:25], 0
  v_mov_b64 v[26:27], 0
  v_mov_b64 v[28:29], 0
  v_mov_b64 v[30:31], 0
  v_mov_b64 v[32:33], 0
  v_mov_b64 v[34:35], 0
  v_mov_b64 v[36:37], 0
  v_mov_b64 v[38:39], 0
  v_mov_b64 v[40:41], 0
  v_mov_b64 v[42:43], 0
  v_mov_b64 v[44:45], 0
  v_mov_b64 v[46:47], 0
  v_mov_b64 v[48:49], 0
  v_mov_b64 v[50:51], 0
  v_mov_b64 v[52:53], 0
  v_mov_b64 v[54:55], 0
  v_mov_b64 v[56:57], 0
  v_mov_b64 v[58:59], 0
  v_mov_b64 v[60:61], 0
  v_mov_b64 v[62:63], 0
  v_mov_b64 v[64:65], 0
  v_mov_b64 v[66:67], 0
  v_mov_b64 v[68:69], 0
  v_mov_b64 v[70:71], 0
  v_mov_b64 v[72:73], 0
  v_mov_b64 v[74:75], 0
  v_mov_b64 v[76:77], 0
  v_mov_b64 v[78:79], 0
  v_mov_b64 v[80:81], 0
  v_mov_b64 v[82:83], 0
  v_mov_b64 v[84:85], 0
  v_mov_b64 v[86:87], 0
  v_mov_b64 v[88:89], 0
  v_mov_b64 v[90:91], 0
  v_mov_b64 v[92:93], 0
  v_mov_b64 v[94:95], 0
  s_mov_b32 s63, 118784
  v_add_u32 v238, s63, v233
  v_add_u32 v239, s63, v234
  v_add_u32 v236, s63, v231
  v_add_u32 v237, s63, v232
  s_barrier
  ds_read_b64_tr_b16 v[192:193], v238 offset:0
  ds_read_b64_tr_b16 v[194:195], v238 offset:1024
  ds_read_b64_tr_b16 v[196:197], v239 offset:0
  ds_read_b64_tr_b16 v[198:199], v239 offset:1024
  ds_read_b128 v[96:99], v236 offset:0
  ds_read_b128 v[100:103], v236 offset:2048
  ds_read_b128 v[104:107], v236 offset:4096
  ds_read_b128 v[108:111], v236 offset:6144
  ds_read_b128 v[112:115], v236 offset:8192
  ds_read_b128 v[116:119], v236 offset:10240
  ds_read_b64_tr_b16 v[200:201], v238 offset:8192
  ds_read_b64_tr_b16 v[202:203], v238 offset:9216
  ds_read_b64_tr_b16 v[204:205], v239 offset:8192
  ds_read_b64_tr_b16 v[206:207], v239 offset:9216
  ds_read_b128 v[120:123], v237 offset:0
  s_waitcnt lgkmcnt(7)
  ds_read_b128 v[124:127], v237 offset:2048
  ds_read_b128 v[128:131], v237 offset:4096
  ds_read_b128 v[132:135], v237 offset:6144
  ds_read_b128 v[136:139], v237 offset:8192
  ds_read_b128 v[140:143], v237 offset:10240
  v_mfma_f32_16x16x32_bf16 v[0:3], v[192:195], v[96:99], v[0:3]
  ds_read_b64_tr_b16 v[208:209], v238 offset:16384
  v_mfma_f32_16x16x32_bf16 v[4:7], v[196:199], v[96:99], v[4:7]
  ds_read_b64_tr_b16 v[210:211], v238 offset:17408
  v_mfma_f32_16x16x32_bf16 v[8:11], v[192:195], v[100:103], v[8:11]
  ds_read_b64_tr_b16 v[212:213], v239 offset:16384
  v_mfma_f32_16x16x32_bf16 v[12:15], v[196:199], v[100:103], v[12:15]
  s_waitcnt lgkmcnt(7)
  ds_read_b64_tr_b16 v[214:215], v239 offset:17408
  v_mfma_f32_16x16x32_bf16 v[16:19], v[192:195], v[104:107], v[16:19]
  ds_read_b64_tr_b16 v[216:217], v238 offset:24576
  v_mfma_f32_16x16x32_bf16 v[20:23], v[196:199], v[104:107], v[20:23]
  ds_read_b64_tr_b16 v[218:219], v238 offset:25600
  v_mfma_f32_16x16x32_bf16 v[24:27], v[192:195], v[108:111], v[24:27]
  ds_read_b64_tr_b16 v[220:221], v239 offset:24576
  v_mfma_f32_16x16x32_bf16 v[28:31], v[196:199], v[108:111], v[28:31]
  ds_read_b64_tr_b16 v[222:223], v239 offset:25600
  v_mfma_f32_16x16x32_bf16 v[32:35], v[192:195], v[112:115], v[32:35]
  v_mfma_f32_16x16x32_bf16 v[36:39], v[196:199], v[112:115], v[36:39]
  v_mfma_f32_16x16x32_bf16 v[40:43], v[192:195], v[116:119], v[40:43]
  v_mfma_f32_16x16x32_bf16 v[44:47], v[196:199], v[116:119], v[44:47]
  s_waitcnt lgkmcnt(8)
  v_mfma_f32_16x16x32_bf16 v[0:3], v[200:203], v[120:123], v[0:3]
  v_mfma_f32_16x16x32_bf16 v[4:7], v[204:207], v[120:123], v[4:7]
  v_mfma_f32_16x16x32_bf16 v[8:11], v[200:203], v[124:127], v[8:11]
  s_add_u32 s63, s63, 45056
  s_cmp_eq_u32 s63, 90112
  s_cselect_b32 s63, 118784, s63
  s_cmp_eq_u32 s63, 163840
  s_cselect_b32 s63, 0, s63
  v_mfma_f32_16x16x32_bf16 v[12:15], v[204:207], v[124:127], v[12:15]
  v_mfma_f32_16x16x32_bf16 v[16:19], v[200:203], v[128:131], v[16:19]
  s_waitcnt lgkmcnt(0)
  v_mfma_f32_16x16x32_bf16 v[20:23], v[204:207], v[128:131], v[20:23]
  v_mfma_f32_16x16x32_bf16 v[24:27], v[200:203], v[132:135], v[24:27]
  v_add_u32 v238, s63, v233
  v_add_u32 v239, s63, v234
  v_add_u32 v236, s63, v231
  v_add_u32 v237, s63, v232
  v_mfma_f32_16x16x32_bf16 v[28:31], v[204:207], v[132:135], v[28:31]
  v_mfma_f32_16x16x32_bf16 v[32:35], v[200:203], v[136:139], v[32:35]
  v_mfma_f32_16x16x32_bf16 v[36:39], v[204:207], v[136:139], v[36:39]
  v_mfma_f32_16x16x32_bf16 v[40:43], v[200:203], v[140:143], v[40:43]
  v_mfma_f32_16x16x32_bf16 v[44:47], v[204:207], v[140:143], v[44:47]
  s_mov_b32 s64, 4
L_qs:
  s_barrier
  v_mfma_f32_16x16x32_bf16 v[48:51], v[208:211], v[96:99], v[48:51]
  ds_read_b64_tr_b16 v[192:193], v238 offset:0
  v_mfma_f32_16x16x32_bf16 v[52:55], v[212:215], v[96:99], v[52:55]
  ds_read_b64_tr_b16 v[194:195], v238 offset:1024
  v_mfma_f32_16x16x32_bf16 v[56:59], v[208:211], v[100:103], v[56:59]
  ds_read_b64_tr_b16 v[196:197], v239 offset:0
  v_mfma_f32_16x16x32_bf16 v[60:63], v[212:215], v[100:103], v[60:63]
  ds_read_b64_tr_b16 v[198:199], v239 offset:1024
  v_mfma_f32_16x16x32_bf16 v[64:67], v[208:211], v[104:107], v[64:67]
  ds_read_b128 v[144:147], v236 offset:0
  v_mfma_f32_16x16x32_bf16 v[68:71], v[212:215], v[104:107], v[68:71]
  ds_read_b128 v[148:151], v236 offset:2048
  v_mfma_f32_16x16x32_bf16 v[72:75], v[208:211], v[108:111], v[72:75]
  ds_read_b128 v[152:155], v236 offset:4096
  v_mfma_f32_16x16x32_bf16 v[76:79], v[212:215], v[108:111], v[76:79]
  ds_read_b128 v[156:159], v236 offset:6144
  v_mfma_f32_16x16x32_bf16 v[80:83], v[208:211], v[112:115], v[80:83]
  ds_read_b128 v[160:163], v236 offset:8192
  v_mfma_f32_16x16x32_bf16 v[84:87], v[212:215], v[112:115], v[84:87]
  ds_read_b128 v[164:167], v236 offset:10240
  v_mfma_f32_16x16x32_bf16 v[88:91], v[208:211], v[116:119], v[88:91]
  ds_read_b64_tr_b16 v[200:201], v238 offset:8192
  v_mfma_f32_16x16x32_bf16 v[92:95], v[212:215], v[116:119], v[92:95]
  ds_read_b64_tr_b16 v[202:203], v238 offset:9216
  v_mfma_f32_16x16x32_bf16 v[48:51], v[216:219], v[120:123], v[48:51]
  ds_read_b64_tr_b16 v[204:205], v239 offset:8192
  v_mfma_f32_16x16x32_bf16 v[52:55], v[220:223], v[120:123], v[52:55]
  ds_read_b64_tr_b16 v[206:207], v239 offset:9216
  v_mfma_f32_16x16x32_bf16 v[56:59], v[216:219], v[124:127], v[56:59]
  ds_read_b128 v[168:171], v237 offset:0
  v_mfma_f32_16x16x32_bf16 v[60:63], v[220:223], v[124:127], v[60:63]
  s_waitcnt lgkmcnt(7)
  ds_read_b128 v[172:175], v237 offset:2048
  v_mfma_f32_16x16x32_bf16 v[64:67], v[216:219], v[128:131], v[64:67]
  ds_read_b128 v[176:179], v237 offset:4096
  v_mfma_f32_16x16x32_bf16 v[68:71], v[220:223], v[128:131], v[68:71]
  ds_read_b128 v[180:183], v237 offset:6144
  v_mfma_f32_16x16x32_bf16 v[72:75], v[216:219], v[132:135], v[72:75]
  ds_read_b128 v[184:187], v237 offset:8192
  v_mfma_f32_16x16x32_bf16 v[76:79], v[220:223], v[132:135], v[76:79]
  ds_read_b128 v[188:191], v237 offset:10240
  v_mfma_f32_16x16x32_bf16 v[80:83], v[216:219], v[136:139], v[80:83]
  v_mfma_f32_16x16x32_bf16 v[84:87], v[220:223], v[136:139], v[84:87]
  v_mfma_f32_16x16x32_bf16 v[88:91], v[216:219], v[140:143], v[88:91]
  v_mfma_f32_16x16x32_bf16 v[92:95], v[220:223], v[140:143], v[92:95]
  s_waitcnt lgkmcnt(10)
  v_mfma_f32_16x16x32_bf16 v[0:3], v[192:195], v[144:147], v[0:3]
  ds_read_b64_tr_b16 v[208:209], v238 offset:16384
  v_mfma_f32_16x16x32_bf16 v[4:7], v[196:199], v[144:147], v[4:7]
  ds_read_b64_tr_b16 v[210:211], v238 offset:17408
  v_mfma_f32_16x16x32_bf16 v[8:11], v[192:195], v[148:151], v[8:11]
  ds_read_b64_tr_b16 v[212:213], v239 offset:16384
  v_mfma_f32_16x16x32_bf16 v[12:15], v[196:199], v[148:151], v[12:15]
  ds_read_b64_tr_b16 v[214:215], v239 offset:17408
  v_mfma_f32_16x16x32_bf16 v[16:19], v[192:195], v[152:155], v[16:19]
  ds_read_b64_tr_b16 v[216:217], v238 offset:24576
  v_mfma_f32_16x16x32_bf16 v[20:23], v[196:199], v[152:155], v[20:23]
  s_waitcnt lgkmcnt(7)
  ds_read_b64_tr_b16 v[218:219], v238 offset:25600
  v_mfma_f32_16x16x32_bf16 v[24:27], v[192:195], v[156:159], v[24:27]
  ds_read_b64_tr_b16 v[220:221], v239 offset:24576
  v_mfma_f32_16x16x32_bf16 v[28:31], v[196:199], v[156:159], v[28:31]
  ds_read_b64_tr_b16 v[222:223], v239 offset:25600
  v_mfma_f32_16x16x32_bf16 v[32:35], v[192:195], v[160:163], v[32:35]
  v_mfma_f32_16x16x32_bf16 v[36:39], v[196:199], v[160:163], v[36:39]
  v_mfma_f32_16x16x32_bf16 v[40:43], v[192:195], v[164:167], v[40:43]
  v_mfma_f32_16x16x32_bf16 v[44:47], v[196:199], v[164:167], v[44:47]
  s_waitcnt lgkmcnt(8)
  v_mfma_f32_16x16x32_bf16 v[0:3], v[200:203], v[168:171], v[0:3]
  v_mfma_f32_16x16x32_bf16 v[4:7], v[204:207], v[168:171], v[4:7]
  v_mfma_f32_16x16x32_bf16 v[8:11], v[200:203], v[172:175], v[8:11]
  s_add_u32 s63, s63, 45056
  s_cmp_eq_u32 s63, 90112
  s_cselect_b32 s63, 118784, s63
  s_cmp_eq_u32 s63, 163840
  s_cselect_b32 s63, 0, s63
  v_mfma_f32_16x16x32_bf16 v[12:15], v[204:207], v[172:175], v[12:15]
  v_mfma_f32_16x16x32_bf16 v[16:19], v[200:203], v[176:179], v[16:19]
  s_waitcnt lgkmcnt(0)
  v_mfma_f32_16x16x32_bf16 v[20:23], v[204:207], v[176:179], v[20:23]
  v_mfma_f32_16x16x32_bf16 v[24:27], v[200:203], v[180:183], v[24:27]
  v_add_u32 v238, s63, v233
  v_add_u32 v239, s63, v234
  v_add_u32 v236, s63, v231
  v_add_u32 v237, s63, v232
  v_mfma_f32_16x16x32_bf16 v[28:31], v[204:207], v[180:183], v[28:31]
  v_mfma_f32_16x16x32_bf16 v[32:35], v[200:203], v[184:187], v[32:35]
  v_mfma_f32_16x16x32_bf16 v[36:39], v[204:207], v[184:187], v[36:39]
  v_mfma_f32_16x16x32_bf16 v[40:43], v[200:203], v[188:191], v[40:43]
  v_mfma_f32_16x16x32_bf16 v[44:47], v[204:207], v[188:191], v[44:47]
  s_barrier
  v_mfma_f32_16x16x32_bf16 v[48:51], v[208:211], v[144:147], v[48:51]
  ds_read_b64_tr_b16 v[192:193], v238 offset:0
  v_mfma_f32_16x16x32_bf16 v[52:55], v[212:215], v[144:147], v[52:55]
  ds_read_b64_tr_b16 v[194:195], v238 offset:1024
  v_mfma_f32_16x16x32_bf16 v[56:59], v[208:211], v[148:151], v[56:59]
  ds_read_b64_tr_b16 v[196:197], v239 offset:0
  v_mfma_f32_16x16x32_bf16 v[60:63], v[212:215], v[148:151], v[60:63]
  ds_read_b64_tr_b16 v[198:199], v239 offset:1024
  v_mfma_f32_16x16x32_bf16 v[64:67], v[208:211], v[152:155], v[64:67]
  ds_read_b128 v[96:99], v236 offset:0
  v_mfma_f32_16x16x32_bf16 v[68:71], v[212:215], v[152:155], v[68:71]
  ds_read_b128 v[100:103], v236 offset:2048
  v_mfma_f32_16x16x32_bf16 v[72:75], v[208:211], v[156:159], v[72:75]
  ds_read_b128 v[104:107], v236 offset:4096
  v_mfma_f32_16x16x32_bf16 v[76:79], v[212:215], v[156:159], v[76:79]
  ds_read_b128 v[108:111], v236 offset:6144
  v_mfma_f32_16x16x32_bf16 v[80:83], v[208:211], v[160:163], v[80:83]
  ds_read_b128 v[112:115], v236 offset:8192
  v_mfma_f32_16x16x32_bf16 v[84:87], v[212:215], v[160:163], v[84:87]
  ds_read_b128 v[116:119], v236 offset:10240
  v_mfma_f32_16x16x32_bf16 v[88:91], v[208:211], v[164:167], v[88:91]
  ds_read_b64_tr_b16 v[200:201], v238 offset:8192
  v_mfma_f32_16x16x32_bf16 v[92:95], v[212:215], v[164:167], v[92:95]
  ds_read_b64_tr_b16 v[202:203], v238 offset:9216
  v_mfma_f32_16x16x32_bf16 v[48:51], v[216:219], v[168:171], v[48:51]
  ds_read_b64_tr_b16 v[204:205], v239 offset:8192
  v_mfma_f32_16x16x32_bf16 v[52:55], v[220:223], v[168:171], v[52:55]
  ds_read_b64_tr_b16 v[206:207], v239 offset:9216
  v_mfma_f32_16x16x32_bf16 v[56:59], v[216:219], v[172:175], v[56:59]
  ds_read_b128 v[120:123], v237 offset:0
  v_mfma_f32_16x16x32_bf16 v[60:63], v[220:223], v[172:175], v[60:63]
  s_waitcnt lgkmcnt(7)
  ds_read_b128 v[124:127], v237 offset:2048
  v_mfma_f32_16x16x32_bf16 v[64:67], v[216:219], v[176:179], v[64:67]
  ds_read_b128 v[128:131], v237 offset:4096
  v_mfma_f32_16x16x32_bf16 v[68:71], v[220:223], v[176:179], v[68:71]
  ds_read_b128 v[132:135], v237 offset:6144
  v_mfma_f32_16x16x32_bf16 v[72:75], v[216:219], v[180:183], v[72:75]
  ds_read_b128 v[136:139], v237 offset:8192
  v_mfma_f32_16x16x32_bf16 v[76:79], v[220:223], v[180:183], v[76:79]
  ds_read_b128 v[140:143], v237 offset:10240
  v_mfma_f32_16x16x32_bf16 v[80:83], v[216:219], v[184:187], v[80:83]
  v_mfma_f32_16x16x32_bf16 v[84:87], v[220:223], v[184:187], v[84:87]
  v_mfma_f32_16x16x32_bf16 v[88:91], v[216:219], v[188:191], v[88:91]
  v_mfma_f32_16x16x32_bf16 v[92:95], v[220:223], v[188:191], v[92:95]
  s_waitcnt lgkmcnt(10)
  v_mfma_f32_16x16x32_bf16 v[0:3], v[192:195], v[96:99], v[0:3]
  ds_read_b64_tr_b16 v[208:209], v238 offset:16384
  v_mfma_f32_16x16x32_bf16 v[4:7], v[196:199], v[96:99], v[4:7]
  ds_read_b64_tr_b16 v[210:211], v238 offset:17408
  v_mfma_f32_16x16x32_bf16 v[8:11], v[192:195], v[100:103], v[8:11]
  ds_read_b64_tr_b16 v[212:213], v239 offset:16384
  v_mfma_f32_16x16x32_bf16 v[12:15], v[196:199], v[100:103], v[12:15]
  ds_read_b64_tr_b16 v[214:215], v239 offset:17408
  v_mfma_f32_16x16x32_bf16 v[16:19], v[192:195], v[104:107], v[16:19]
  ds_read_b64_tr_b16 v[216:217], v238 offset:24576
  v_mfma_f32_16x16x32_bf16 v[20:23], v[196:199], v[104:107], v[20:23]
  s_waitcnt lgkmcnt(7)
  ds_read_b64_tr_b16 v[218:219], v238 offset:25600
  v_mfma_f32_16x16x32_bf16 v[24:27], v[192:195], v[108:111], v[24:27]
  ds_read_b64_tr_b16 v[220:221], v239 offset:24576
  v_mfma_f32_16x16x32_bf16 v[28:31], v[196:199], v[108:111], v[28:31]
  ds_read_b64_tr_b16 v[222:223], v239 offset:25600
  v_mfma_f32_16x16x32_bf16 v[32:35], v[192:195], v[112:115], v[32:35]
  v_mfma_f32_16x16x32_bf16 v[36:39], v[196:199], v[112:115], v[36:39]
  v_mfma_f32_16x16x32_bf16 v[40:43], v[192:195], v[116:119], v[40:43]
  v_mfma_f32_16x16x32_bf16 v[44:47], v[196:199], v[116:119], v[44:47]
  s_waitcnt lgkmcnt(8)
  v_mfma_f32_16x16x32_bf16 v[0:3], v[200:203], v[120:123], v[0:3]
  v_mfma_f32_16x16x32_bf16 v[4:7], v[204:207], v[120:123], v[4:7]
  v_mfma_f32_16x16x32_bf16 v[8:11], v[200:203], v[124:127], v[8:11]
  s_add_u32 s63, s63, 45056
  s_cmp_eq_u32 s63, 90112
  s_cselect_b32 s63, 118784, s63
  s_cmp_eq_u32 s63, 163840
  s_cselect_b32 s63, 0, s63
  v_mfma_f32_16x16x32_bf16 v[12:15], v[204:207], v[124:127], v[12:15]
  v_mfma_f32_16x16x32_bf16 v[16:19], v[200:203], v[128:131], v[16:19]
  s_waitcnt lgkmcnt(0)
  v_mfma_f32_16x16x32_bf16 v[20:23], v[204:207], v[128:131], v[20:23]
  v_mfma_f32_16x16x32_bf16 v[24:27], v[200:203], v[132:135], v[24:27]
  v_add_u32 v238, s63, v233
  v_add_u32 v239, s63, v234
  v_add_u32 v236, s63, v231
  v_add_u32 v237, s63, v232
  v_mfma_f32_16x16x32_bf16 v[28:31], v[204:207], v[132:135], v[28:31]
  v_mfma_f32_16x16x32_bf16 v[32:35], v[200:203], v[136:139], v[32:35]
  v_mfma_f32_16x16x32_bf16 v[36:39], v[204:207], v[136:139], v[36:39]
  v_mfma_f32_16x16x32_bf16 v[40:43], v[200:203], v[140:143], v[40:43]
  v_mfma_f32_16x16x32_bf16 v[44:47], v[204:207], v[140:143], v[44:47]
  s_sub_u32 s64, s64, 1
  s_cmp_lg_u32 s64, 0
  s_cbranch_scc1 L_qs
  s_barrier
  v_mfma_f32_16x16x32_bf16 v[48:51], v[208:211], v[96:99], v[48:51]
  v_mfma_f32_16x16x32_bf16 v[52:55], v[212:215], v[96:99], v[52:55]
  v_mfma_f32_16x16x32_bf16 v[56:59], v[208:211], v[100:103], v[56:59]
  v_mfma_f32_16x16x32_bf16 v[60:63], v[212:215], v[100:103], v[60:63]
  v_pk_mul_f32 v[0:1], v[0:1], s[54:55]
  v_pk_mul_f32 v[2:3], v[2:3], s[54:55]
  v_cvt_pk_bf16_f32 v144, v0, v1
  v_mfma_f32_16x16x32_bf16 v[64:67], v[208:211], v[104:107], v[64:67]
  v_pk_mul_f32 v[4:5], v[4:5], s[54:55]
  v_cvt_pk_bf16_f32 v145, v2, v3
  v_pk_mul_f32 v[6:7], v[6:7], s[54:55]
  v_mfma_f32_16x16x32_bf16 v[68:71], v[212:215], v[104:107], v[68:71]
  v_cvt_pk_bf16_f32 v146, v4, v5
  v_pk_mul_f32 v[8:9], v[8:9], s[54:55]
  v_cvt_pk_bf16_f32 v147, v6, v7
  v_mfma_f32_16x16x32_bf16 v[72:75], v[208:211], v[108:111], v[72:75]
  v_pk_mul_f32 v[10:11], v[10:11], s[54:55]
  v_cvt_pk_bf16_f32 v148, v8, v9
  v_pk_mul_f32 v[12:13], v[12:13], s[54:55]
  v_mfma_f32_16x16x32_bf16 v[76:79], v[212:215], v[108:111], v[76:79]
  v_cvt_pk_bf16_f32 v149, v10, v11
  v_pk_mul_f32 v[14:15], v[14:15], s[54:55]
  v_cvt_pk_bf16_f32 v150, v12, v13
  v_mfma_f32_16x16x32_bf16 v[80:83], v[208:211], v[112:115], v[80:83]
  v_pk_mul_f32 v[16:17], v[16:17], s[54:55]
  v_cvt_pk_bf16_f32 v151, v14, v15
  v_pk_mul_f32 v[18:19], v[18:19], s[54:55]
  v_mfma_f32_16x16x32_bf16 v[84:87], v[212:215], v[112:115], v[84:87]
  v_cvt_pk_bf16_f32 v152, v16, v17
  v_pk_mul_f32 v[20:21], v[20:21], s[54:55]
  v_cvt_pk_bf16_f32 v153, v18, v19
  v_mfma_f32_16x16x32_bf16 v[88:91], v[208:211], v[116:119], v[88:91]
  v_pk_mul_f32 v[22:23], v[22:23], s[54:55]
  v_cvt_pk_bf16_f32 v154, v20, v21
  v_pk_mul_f32 v[24:25], v[24:25], s[54:55]
  v_mfma_f32_16x16x32_bf16 v[92:95], v[212:215], v[116:119], v[92:95]
  v_cvt_pk_bf16_f32 v155, v22, v23
  v_pk_mul_f32 v[26:27], v[26:27], s[54:55]
  v_cvt_pk_bf16_f32 v156, v24, v25
  v_mfma_f32_16x16x32_bf16 v[48:51], v[216:219], v[120:123], v[48:51]
  v_pk_mul_f32 v[28:29], v[28:29], s[54:55]
  v_cvt_pk_bf16_f32 v157, v26, v27
  v_pk_mul_f32 v[30:31], v[30:31], s[54:55]
  v_mfma_f32_16x16x32_bf16 v[52:55], v[220:223], v[120:123], v[52:55]
  v_cvt_pk_bf16_f32 v158, v28, v29
  v_pk_mul_f32 v[32:33], v[32:33], s[54:55]
  v_cvt_pk_bf16_f32 v159, v30, v31
  v_mfma_f32_16x16x32_bf16 v[56:59], v[216:219], v[124:127], v[56:59]
  v_pk_mul_f32 v[34:35], v[34:35], s[54:55]
  v_cvt_pk_bf16_f32 v160, v32, v33
  v_pk_mul_f32 v[36:37], v[36:37], s[54:55]
  v_mfma_f32_16x16x32_bf16 v[60:63], v[220:223], v[124:127], v[60:63]
  v_cvt_pk_bf16_f32 v161, v34, v35
  v_pk_mul_f32 v[38:39], v[38:39], s[54:55]
  v_cvt_pk_bf16_f32 v162, v36, v37
  v_mfma_f32_16x16x32_bf16 v[64:67], v[216:219], v[128:131], v[64:67]
  v_pk_mul_f32 v[40:41], v[40:41], s[54:55]
  v_cvt_pk_bf16_f32 v163, v38, v39
  v_pk_mul_f32 v[42:43], v[42:43], s[54:55]
  v_mfma_f32_16x16x32_bf16 v[68:71], v[220:223], v[128:131], v[68:71]
  v_cvt_pk_bf16_f32 v164, v40, v41
  v_pk_mul_f32 v[44:45], v[44:45], s[54:55]
  v_cvt_pk_bf16_f32 v165, v42, v43
  v_mfma_f32_16x16x32_bf16 v[72:75], v[216:219], v[132:135], v[72:75]
  v_pk_mul_f32 v[46:47], v[46:47], s[54:55]
  v_cvt_pk_bf16_f32 v166, v44, v45
  v_cvt_pk_bf16_f32 v167, v46, v47
  v_mfma_f32_16x16x32_bf16 v[76:79], v[220:223], v[132:135], v[76:79]
  ds_write_b64 v241, v[144:145] offset:0
  ds_write_b64 v241, v[146:147] offset:32
  ds_write_b64 v241, v[148:149] offset:4352
  v_mfma_f32_16x16x32_bf16 v[80:83], v[216:219], v[136:139], v[80:83]
  ds_write_b64 v241, v[150:151] offset:4384
  ds_write_b64 v241, v[152:153] offset:8704
  ds_write_b64 v241, v[154:155] offset:8736
  v_mfma_f32_16x16x32_bf16 v[84:87], v[220:223], v[136:139], v[84:87]
  ds_write_b64 v241, v[156:157] offset:13056
  ds_write_b64 v241, v[158:159] offset:13088
  ds_write_b64 v241, v[160:161] offset:17408
  v_mfma_f32_16x16x32_bf16 v[88:91], v[216:219], v[140:143], v[88:91]
  ds_write_b64 v241, v[162:163] offset:17440
  ds_write_b64 v241, v[164:165] offset:21760
  ds_write_b64 v241, v[166:167] offset:21792
  v_mfma_f32_16x16x32_bf16 v[92:95], v[220:223], v[140:143], v[92:95]
  v_pk_mul_f32 v[48:49], v[48:49], s[54:55]
  v_pk_mul_f32 v[50:51], v[50:51], s[54:55]
  v_cvt_pk_bf16_f32 v168, v48, v49
  v_pk_mul_f32 v[52:53], v[52:53], s[54:55]
  v_cvt_pk_bf16_f32 v169, v50, v51
  v_pk_mul_f32 v[54:55], v[54:55], s[54:55]
  v_cvt_pk_bf16_f32 v170, v52, v53
  ds_write_b64 v241, v[168:169] offset:26112
  v_pk_mul_f32 v[56:57], v[56:57], s[54:55]
  v_cvt_pk_bf16_f32 v171, v54, v55
  v_pk_mul_f32 v[58:59], v[58:59], s[54:55]
  v_cvt_pk_bf16_f32 v172, v56, v57
  ds_write_b64 v241, v[170:171] offset:26144
  v_pk_mul_f32 v[60:61], v[60:61], s[54:55]
  v_cvt_pk_bf16_f32 v173, v58, v59
  v_pk_mul_f32 v[62:63], v[62:63], s[54:55]
  v_cvt_pk_bf16_f32 v174, v60, v61
  ds_write_b64 v241, v[172:173] offset:30464
  v_pk_mul_f32 v[64:65], v[64:65], s[54:55]
  v_cvt_pk_bf16_f32 v175, v62, v63
  v_pk_mul_f32 v[66:67], v[66:67], s[54:55]
  v_cvt_pk_bf16_f32 v176, v64, v65
  ds_write_b64 v241, v[174:175] offset:30496
  v_pk_mul_f32 v[68:69], v[68:69], s[54:55]
  v_cvt_pk_bf16_f32 v177, v66, v67
  v_pk_mul_f32 v[70:71], v[70:71], s[54:55]
  v_cvt_pk_bf16_f32 v178, v68, v69
  ds_write_b64 v241, v[176:177] offset:34816
  v_pk_mul_f32 v[72:73], v[72:73], s[54:55]
  v_cvt_pk_bf16_f32 v179, v70, v71
  v_pk_mul_f32 v[74:75], v[74:75], s[54:55]
  v_cvt_pk_bf16_f32 v180, v72, v73
  ds_write_b64 v241, v[178:179] offset:34848
  v_pk_mul_f32 v[76:77], v[76:77], s[54:55]
  v_cvt_pk_bf16_f32 v181, v74, v75
  v_pk_mul_f32 v[78:79], v[78:79], s[54:55]
  v_cvt_pk_bf16_f32 v182, v76, v77
  ds_write_b64 v241, v[180:181] offset:39168
  v_pk_mul_f32 v[80:81], v[80:81], s[54:55]
  v_cvt_pk_bf16_f32 v183, v78, v79
  v_pk_mul_f32 v[82:83], v[82:83], s[54:55]
  v_cvt_pk_bf16_f32 v184, v80, v81
  ds_write_b64 v241, v[182:183] offset:39200
  v_pk_mul_f32 v[84:85], v[84:85], s[54:55]
  v_cvt_pk_bf16_f32 v185, v82, v83
  v_pk_mul_f32 v[86:87], v[86:87], s[54:55]
  v_cvt_pk_bf16_f32 v186, v84, v85
  ds_write_b64 v241, v[184:185] offset:43520
  v_pk_mul_f32 v[88:89], v[88:89], s[54:55]
  v_cvt_pk_bf16_f32 v187, v86, v87
  v_pk_mul_f32 v[90:91], v[90:91], s[54:55]
  v_cvt_pk_bf16_f32 v188, v88, v89
  ds_write_b64 v241, v[186:187] offset:43552
  v_pk_mul_f32 v[92:93], v[92:93], s[54:55]
  v_cvt_pk_bf16_f32 v189, v90, v91
  v_pk_mul_f32 v[94:95], v[94:95], s[54:55]
  v_cvt_pk_bf16_f32 v190, v92, v93
  ds_write_b64 v241, v[188:189] offset:47872
  v_cvt_pk_bf16_f32 v191, v94, v95
  ds_write_b64 v241, v[190:191] offset:47904
  s_waitcnt lgkmcnt(0)
  s_barrier
  s_cmp_lg_u32 s84, 1
  s_cbranch_scc1 L_only_1
  s_add_u32 m0, s90, 8448
  s_add_u32 s51, s46, s47
  buffer_load_dwordx4 v251, s[36:39], s51 offen nt lds
  s_add_u32 m0, s90, 8480
  s_nop 0
  buffer_load_dwordx4 v251, s[36:39], s51 offen offset:1024 nt lds
  s_xor_b32 s47, s47, s50
  s_cselect_b32 s31, 0, 8192
  s_add_u32 s46, s46, s31
  s_and_b32 s31, s46, s50
  s_add_u32 s46, s46, s31
  s_add_u32 s90, s90, 16896
  s_cmp_eq_u32 s90, s49
  s_cselect_b32 s31, 67584, 0
  s_sub_u32 s90, s90, s31
  s_add_u32 m0, s48, 0
  s_add_u32 s51, s44, s45
  buffer_load_dwordx4 v251, s[32:35], s51 offen nt lds
  s_add_u32 m0, s48, 32
  s_nop 0
  buffer_load_dwordx4 v251, s[32:35], s51 offen offset:1024 nt lds
  s_xor_b32 s45, s45, s50
  s_cselect_b32 s31, 0, 8192
  s_add_u32 s44, s44, s31
  s_and_b32 s31, s44, s50
  s_add_u32 s44, s44, s31
  s_add_u32 s48, s48, 16896
  s_cmp_eq_u32 s48, s49
  s_cselect_b32 s31, 67584, 0
  s_sub_u32 s48, s48, s31
L_only_1:
  s_add_u32 s61, s61, 512
  s_lshl_b32 s31, s71, 7
  s_add_u32 s31, s31, 62914560
  s_add_u32 s56, s28, s31
  s_addc_u32 s57, s29, 0
  s_and_b32 s57, s57, 0xffff
  s_mov_b32 s58, 4096
  s_mov_b32 s59, 0x20000
  v_lshrrev_b32 v2, 2, v251
  v_and_b32 v3, 64, v2
  v_and_b32 v2, 60, v2
  v_lshl_add_u32 v2, v3, 5, v2
  buffer_load_dword v252, v2, s[56:59], 0 offen sc1
  v_mov_b64 v[0:1], 0
  v_mov_b64 v[2:3], 0
  v_mov_b64 v[4:5], 0
  v_mov_b64 v[6:7], 0
  v_mov_b64 v[8:9], 0
  v_mov_b64 v[10:11], 0
  v_mov_b64 v[12:13], 0
  v_mov_b64 v[14:15], 0
  v_mov_b64 v[16:17], 0
  v_mov_b64 v[18:19], 0
  v_mov_b64 v[20:21], 0
  v_mov_b64 v[22:23], 0
  v_mov_b64 v[24:25], 0
  v_mov_b64 v[26:27], 0
  v_mov_b64 v[28:29], 0
  v_mov_b64 v[30:31], 0
  v_mov_b64 v[32:33], 0
  v_mov_b64 v[34:35], 0
  v_mov_b64 v[36:37], 0
  v_mov_b64 v[38:39], 0
  v_mov_b64 v[40:41], 0
  v_mov_b64 v[42:43], 0
  v_mov_b64 v[44:45], 0
  v_mov_b64 v[46:47], 0
  v_mov_b64 v[48:49], 0
  v_mov_b64 v[50:51], 0
  v_mov_b64 v[52:53], 0
  v_mov_b64 v[54:55], 0
  v_mov_b64 v[56:57], 0
  v_mov_b64 v[58:59], 0
  v_mov_b64 v[60:61], 0
  v_mov_b64 v[62:63], 0
  v_mov_b64 v[64:65], 0
  v_mov_b64 v[66:67], 0
  v_mov_b64 v[68:69], 0
  v_mov_b64 v[70:71], 0
  v_mov_b64 v[72:73], 0
  v_mov_b64 v[74:75], 0
  v_mov_b64 v[76:77], 0
  v_mov_b64 v[78:79], 0
  v_mov_b64 v[80:81], 0
  v_mov_b64 v[82:83], 0
  v_mov_b64 v[84:85], 0
  v_mov_b64 v[86:87], 0
  v_mov_b64 v[88:89], 0
  v_mov_b64 v[90:91], 0
  v_mov_b64 v[92:93], 0
  v_mov_b64 v[94:95], 0
  s_cmp_lg_u32 s84, 1
  s_cbranch_scc1 L_only_2
  s_barrier
  s_add_u32 m0, s90, 8448
  s_add_u32 s51, s46, s47
  buffer_load_dwordx4 v251, s[36:39], s51 offen nt lds
  s_add_u32 m0, s90, 8480
  s_nop 0
  buffer_load_dwordx4 v251, s[36:39], s51 offen offset:1024 nt lds
  s_xor_b32 s47, s47, s50
  s_cselect_b32 s31, 0, 8192
  s_add_u32 s46, s46, s31
  s_and_b32 s31, s46, s50
  s_add_u32 s46, s46, s31
  s_add_u32 s90, s90, 16896
  s_cmp_eq_u32 s90, s49
  s_cselect_b32 s31, 67584, 0
  s_sub_u32 s90, s90, s31
  s_add_u32 m0, s48, 0
  s_add_u32 s51, s44, s45
  buffer_load_dwordx4 v251, s[32:35], s51 offen nt lds
  s_add_u32 m0, s48, 32
  s_nop 0
  buffer_load_dwordx4 v251, s[32:35], s51 offen offset:1024 nt lds
  s_xor_b32 s45, s45, s50
  s_cselect_b32 s31, 0, 8192
  s_add_u32 s44, s44, s31
  s_and_b32 s31, s44, s50
  s_add_u32 s44, s44, s31
  s_add_u32 s48, s48, 16896
  s_cmp_eq_u32 s48, s49
  s_cselect_b32 s31, 67584, 0
  s_sub_u32 s48, s48, s31
L_only_2:
  s_mov_b32 s62, 0
  s_mov_b32 s63, 0
  s_barrier
  s_cmp_lg_u32 s84, 1
  s_cbranch_scc1 L_only_3
  s_add_u32 m0, s90, 8448
  s_add_u32 s51, s46, s47
  buffer_load_dwordx4 v251, s[36:39], s51 offen nt lds
  s_add_u32 m0, s90, 8480
  s_nop 0
  buffer_load_dwordx4 v251, s[36:39], s51 offen offset:1024 nt lds
  s_xor_b32 s47, s47, s50
  s_cselect_b32 s31, 0, 8192
  s_add_u32 s46, s46, s31
  s_and_b32 s31, s46, s50
  s_add_u32 s46, s46, s31
  s_add_u32 s90, s90, 16896
  s_cmp_eq_u32 s90, s49
  s_cselect_b32 s31, 67584, 0
  s_sub_u32 s90, s90, s31
  s_add_u32 m0, s48, 0
  s_add_u32 s51, s44, s45
  buffer_load_dwordx4 v251, s[32:35], s51 offen nt lds
  s_add_u32 m0, s48, 32
  s_nop 0
  buffer_load_dwordx4 v251, s[32:35], s51 offen offset:1024 nt lds
  s_xor_b32 s45, s45, s50
  s_cselect_b32 s31, 0, 8192
  s_add_u32 s44, s44, s31
  s_and_b32 s31, s44, s50
  s_add_u32 s44, s44, s31
  s_add_u32 s48, s48, 16896
  s_cmp_eq_u32 s48, s49
  s_cselect_b32 s31, 67584, 0
  s_sub_u32 s48, s48, s31
L_only_3:
  s_lshl_b32 s65, s60, 7
  s_lshl_b32 s66, s60, 19
  s_add_u32 m0, s62, s68
  s_add_u32 s66, s66, s61
  buffer_load_dwordx4 v224, s[72:75], s65 offen offset:0 lds
  buffer_load_dwordx4 v225, s[72:75], s65 offen offset:1024 lds
  buffer_load_dwordx4 v226, s[72:75], s65 offen offset:2048 lds
  s_add_u32 m0, s62, s69
  s_nop 0
  buffer_load_dwordx4 v227, s[76:79], s66 offen offset:0 lds
  buffer_load_dwordx4 v228, s[76:79], s66 offen offset:1024 lds
  buffer_load_dwordx4 v229, s[76:79], s66 offen offset:2048 lds
  buffer_load_dwordx4 v230, s[76:79], s66 offen offset:3072 lds
  s_add_u32 m0, s62, s69
  s_add_u32 m0, m0, 16384
  s_add_u32 s66, s66, 256
  buffer_load_dwordx4 v227, s[76:79], s66 offen offset:0 lds
  buffer_load_dwordx4 v228, s[76:79], s66 offen offset:1024 lds
  buffer_load_dwordx4 v229, s[76:79], s66 offen offset:2048 lds
  buffer_load_dwordx4 v230, s[76:79], s66 offen offset:3072 lds
  s_add_u32 s60, s60, 1
  s_cmp_eq_u32 s60, 9
  s_cselect_b32 s60, 0, s60
  s_mov_b32 s62, 45056
  s_cmp_lg_u32 s84, 1
  s_cbranch_scc1 L_vw_4
  s_waitcnt vmcnt(20)
L_vw_4:
  s_barrier
  s_add_u32 m0, s90, 8448
  s_add_u32 s51, s46, s47
  buffer_load_dwordx4 v251, s[36:39], s51 offen nt lds
  s_add_u32 m0, s90, 8480
  s_nop 0
  buffer_load_dwordx4 v251, s[36:39], s51 offen offset:1024 nt lds
  s_xor_b32 s47, s47, s50
  s_cselect_b32 s31, 0, 8192
  s_add_u32 s46, s46, s31
  s_and_b32 s31, s46, s50
  s_add_u32 s46, s46, s31
  s_add_u32 s90, s90, 16896
  s_cmp_eq_u32 s90, s49
  s_cselect_b32 s31, 67584, 0
  s_sub_u32 s90, s90, s31
  s_add_u32 m0, s48, 0
  s_add_u32 s51, s44, s45
  buffer_load_dwordx4 v251, s[32:35], s51 offen nt lds
  s_add_u32 m0, s48, 32
  s_nop 0
  buffer_load_dwordx4 v251, s[32:35], s51 offen offset:1024 nt lds
  s_xor_b32 s45, s45, s50
  s_cselect_b32 s31, 0, 8192
  s_add_u32 s44, s44, s31
  s_and_b32 s31, s44, s50
  s_add_u32 s44, s44, s31
  s_add_u32 s48, s48, 16896
  s_cmp_eq_u32 s48, s49
  s_cselect_b32 s31, 67584, 0
  s_sub_u32 s48, s48, s31
  s_waitcnt vmcnt(19)
  s_cmp_lg_u32 s84, 0
  s_cbranch_scc1 L_vw_5
  s_waitcnt vmcnt(0)
L_vw_5:
  s_barrier
  s_add_u32 m0, s90, 8448
  s_add_u32 s51, s46, s47
  buffer_load_dwordx4 v251, s[36:39], s51 offen nt lds
  s_add_u32 m0, s90, 8480
  s_nop 0
  buffer_load_dwordx4 v251, s[36:39], s51 offen offset:1024 nt lds
  s_xor_b32 s47, s47, s50
  s_cselect_b32 s31, 0, 8192
  s_add_u32 s46, s46, s31
  s_and_b32 s31, s46, s50
  s_add_u32 s46, s46, s31
  s_add_u32 s90, s90, 16896
  s_cmp_eq_u32 s90, s49
  s_cselect_b32 s31, 67584, 0
  s_sub_u32 s90, s90, s31
  s_add_u32 m0, s48, 0
  s_add_u32 s51, s44, s45
  buffer_load_dwordx4 v251, s[32:35], s51 offen nt lds
  s_add_u32 m0, s48, 32
  s_nop 0
  buffer_load_dwordx4 v251, s[32:35], s51 offen offset:1024 nt lds
  s_xor_b32 s45, s45, s50
  s_cselect_b32 s31, 0, 8192
  s_add_u32 s44, s44, s31
  s_and_b32 s31, s44, s50
  s_add_u32 s44, s44, s31
  s_add_u32 s48, s48, 16896
  s_cmp_eq_u32 s48, s49
  s_cselect_b32 s31, 67584, 0
  s_sub_u32 s48, s48, s31
  s_lshl_b32 s65, s60, 7
  s_lshl_b32 s66, s60, 19
  s_add_u32 m0, s62, s68
  s_add_u32 s66, s66, s61
  buffer_load_dwordx4 v224, s[72:75], s65 offen offset:0 lds
  buffer_load_dwordx4 v225, s[72:75], s65 offen offset:1024 lds
  buffer_load_dwordx4 v226, s[72:75], s65 offen offset:2048 lds
  s_add_u32 m0, s62, s69
  s_nop 0
  buffer_load_dwordx4 v227, s[76:79], s66 offen offset:0 lds
  buffer_load_dwordx4 v228, s[76:79], s66 offen offset:1024 lds
  buffer_load_dwordx4 v229, s[76:79], s66 offen offset:2048 lds
  buffer_load_dwordx4 v230, s[76:79], s66 offen offset:3072 lds
  s_add_u32 m0, s62, s69
  s_add_u32 m0, m0, 16384
  s_add_u32 s66, s66, 256
  buffer_load_dwordx4 v227, s[76:79], s66 offen offset:0 lds
  buffer_load_dwordx4 v228, s[76:79], s66 offen offset:1024 lds
  buffer_load_dwordx4 v229, s[76:79], s66 offen offset:2048 lds
  buffer_load_dwordx4 v230, s[76:79], s66 offen offset:3072 lds
  s_add_u32 s60, s60, 1
  s_cmp_eq_u32 s60, 9
  s_cselect_b32 s60, 0, s60
  s_mov_b32 s62, 0
  s_mov_b32 s64, 7
L_lp_27:
  s_waitcnt vmcnt(19)
  s_cmp_lg_u32 s84, 0
  s_cbranch_scc1 L_vw_28
  s_waitcnt vmcnt(11)
L_vw_28:
  s_barrier
  s_add_u32 m0, s90, 8448
  s_add_u32 s51, s46, s47
  buffer_load_dwordx4 v251, s[36:39], s51 offen nt lds
  s_add_u32 m0, s90, 8480
  s_nop 0
  buffer_load_dwordx4 v251, s[36:39], s51 offen offset:1024 nt lds
  s_xor_b32 s47, s47, s50
  s_cselect_b32 s31, 0, 8192
  s_add_u32 s46, s46, s31
  s_and_b32 s31, s46, s50
  s_add_u32 s46, s46, s31
  s_add_u32 s90, s90, 16896
  s_cmp_eq_u32 s90, s49
  s_cselect_b32 s31, 67584, 0
  s_sub_u32 s90, s90, s31
  s_add_u32 m0, s48, 0
  s_add_u32 s51, s44, s45
  buffer_load_dwordx4 v251, s[32:35], s51 offen nt lds
  s_add_u32 m0, s48, 32
  s_nop 0
  buffer_load_dwordx4 v251, s[32:35], s51 offen offset:1024 nt lds
  s_xor_b32 s45, s45, s50
  s_cselect_b32 s31, 0, 8192
  s_add_u32 s44, s44, s31
  s_and_b32 s31, s44, s50
  s_add_u32 s44, s44, s31
  s_add_u32 s48, s48, 16896
  s_cmp_eq_u32 s48, s49
  s_cselect_b32 s31, 67584, 0
  s_sub_u32 s48, s48, s31
  v_add_u32 v238, s63, v233
  v_add_u32 v239, s63, v234
  v_add_u32 v236, s63, v231
  v_add_u32 v237, s63, v232
  ds_read_b64_tr_b16 v[192:193], v238 offset:0
  ds_read_b64_tr_b16 v[194:195], v238 offset:1024
  ds_read_b64_tr_b16 v[196:197], v239 offset:0
  ds_read_b64_tr_b16 v[198:199], v239 offset:1024
  ds_read_b128 v[96:99], v236 offset:0
  ds_read_b128 v[100:103], v236 offset:2048
  ds_read_b128 v[104:107], v236 offset:4096
  ds_read_b128 v[108:111], v236 offset:6144
  ds_read_b128 v[112:115], v236 offset:8192
  ds_read_b128 v[116:119], v236 offset:10240
  s_waitcnt lgkmcnt(5)
  v_mfma_f32_16x16x32_bf16 v[0:3], v[192:195], v[96:99], v[0:3]
  ds_read_b64_tr_b16 v[200:201], v238 offset:8192
  v_mfma_f32_16x16x32_bf16 v[4:7], v[196:199], v[96:99], v[4:7]
  ds_read_b64_tr_b16 v[202:203], v238 offset:9216
  s_waitcnt lgkmcnt(6)
  v_mfma_f32_16x16x32_bf16 v[8:11], v[192:195], v[100:103], v[8:11]
  ds_read_b64_tr_b16 v[204:205], v239 offset:8192
  v_mfma_f32_16x16x32_bf16 v[12:15], v[196:199], v[100:103], v[12:15]
  ds_read_b64_tr_b16 v[206:207], v239 offset:9216
  s_waitcnt lgkmcnt(7)
  v_mfma_f32_16x16x32_bf16 v[16:19], v[192:195], v[104:107], v[16:19]
  ds_read_b128 v[120:123], v237 offset:0
  v_mfma_f32_16x16x32_bf16 v[20:23], v[196:199], v[104:107], v[20:23]
  ds_read_b128 v[124:127], v237 offset:2048
  s_waitcnt lgkmcnt(8)
  v_mfma_f32_16x16x32_bf16 v[24:27], v[192:195], v[108:111], v[24:27]
  ds_read_b128 v[128:131], v237 offset:4096
  v_mfma_f32_16x16x32_bf16 v[28:31], v[196:199], v[108:111], v[28:31]
  ds_read_b128 v[132:135], v237 offset:6144
  s_waitcnt lgkmcnt(9)
  v_mfma_f32_16x16x32_bf16 v[32:35], v[192:195], v[112:115], v[32:35]
  ds_read_b128 v[136:139], v237 offset:8192
  v_mfma_f32_16x16x32_bf16 v[36:39], v[196:199], v[112:115], v[36:39]
  ds_read_b128 v[140:143], v237 offset:10240
  s_waitcnt lgkmcnt(10)
  v_mfma_f32_16x16x32_bf16 v[40:43], v[192:195], v[116:119], v[40:43]
  ds_read_b64_tr_b16 v[208:209], v238 offset:16384
  v_mfma_f32_16x16x32_bf16 v[44:47], v[196:199], v[116:119], v[44:47]
  ds_read_b64_tr_b16 v[210:211], v238 offset:17408
  s_cmp_lg_u32 s84, 1
  s_cbranch_scc1 L_only_29
  s_waitcnt vmcnt(8)
  s_barrier
  s_add_u32 m0, s90, 8448
  s_add_u32 s51, s46, s47
  buffer_load_dwordx4 v251, s[36:39], s51 offen nt lds
  s_add_u32 m0, s90, 8480
  s_nop 0
  buffer_load_dwordx4 v251, s[36:39], s51 offen offset:1024 nt lds
  s_xor_b32 s47, s47, s50
  s_cselect_b32 s31, 0, 8192
  s_add_u32 s46, s46, s31
  s_and_b32 s31, s46, s50
  s_add_u32 s46, s46, s31
  s_add_u32 s90, s90, 16896
  s_cmp_eq_u32 s90, s49
  s_cselect_b32 s31, 67584, 0
  s_sub_u32 s90, s90, s31
  s_add_u32 m0, s48, 0
  s_add_u32 s51, s44, s45
  buffer_load_dwordx4 v251, s[32:35], s51 offen nt lds
  s_add_u32 m0, s48, 32
  s_nop 0
  buffer_load_dwordx4 v251, s[32:35], s51 offen offset:1024 nt lds
  s_xor_b32 s45, s45, s50
  s_cselect_b32 s31, 0, 8192
  s_add_u32 s44, s44, s31
  s_and_b32 s31, s44, s50
  s_add_u32 s44, s44, s31
  s_add_u32 s48, s48, 16896
  s_cmp_eq_u32 s48, s49
  s_cselect_b32 s31, 67584, 0
  s_sub_u32 s48, s48, s31
L_only_29:
  s_waitcnt lgkmcnt(7)
  v_mfma_f32_16x16x32_bf16 v[0:3], v[200:203], v[120:123], v[0:3]
  ds_read_b64_tr_b16 v[212:213], v239 offset:16384
  v_mfma_f32_16x16x32_bf16 v[4:7], v[204:207], v[120:123], v[4:7]
  ds_read_b64_tr_b16 v[214:215], v239 offset:17408
  s_waitcnt lgkmcnt(8)
  v_mfma_f32_16x16x32_bf16 v[8:11], v[200:203], v[124:127], v[8:11]
  ds_read_b64_tr_b16 v[216:217], v238 offset:24576
  v_mfma_f32_16x16x32_bf16 v[12:15], v[204:207], v[124:127], v[12:15]
  ds_read_b64_tr_b16 v[218:219], v238 offset:25600
  s_waitcnt lgkmcnt(9)
  v_mfma_f32_16x16x32_bf16 v[16:19], v[200:203], v[128:131], v[16:19]
  ds_read_b64_tr_b16 v[220:221], v239 offset:24576
  v_mfma_f32_16x16x32_bf16 v[20:23], v[204:207], v[128:131], v[20:23]
  ds_read_b64_tr_b16 v[222:223], v239 offset:25600
  s_waitcnt lgkmcnt(10)
  v_mfma_f32_16x16x32_bf16 v[24:27], v[200:203], v[132:135], v[24:27]
  v_mfma_f32_16x16x32_bf16 v[28:31], v[204:207], v[132:135], v[28:31]
  s_waitcnt lgkmcnt(9)
  v_mfma_f32_16x16x32_bf16 v[32:35], v[200:203], v[136:139], v[32:35]
  v_mfma_f32_16x16x32_bf16 v[36:39], v[204:207], v[136:139], v[36:39]
  s_waitcnt lgkmcnt(8)
  v_mfma_f32_16x16x32_bf16 v[40:43], v[200:203], v[140:143], v[40:43]
  v_mfma_f32_16x16x32_bf16 v[44:47], v[204:207], v[140:143], v[44:47]
  s_waitcnt lgkmcnt(0)
  s_waitcnt vmcnt(8)
  s_cmp_lg_u32 s84, 0
  s_cbranch_scc1 L_vw_30
  s_waitcnt vmcnt(0)
L_vw_30:
  s_barrier
  s_add_u32 m0, s90, 8448
  s_add_u32 s51, s46, s47
  buffer_load_dwordx4 v251, s[36:39], s51 offen nt lds
  s_add_u32 m0, s90, 8480
  s_nop 0
  buffer_load_dwordx4 v251, s[36:39], s51 offen offset:1024 nt lds
  s_xor_b32 s47, s47, s50
  s_cselect_b32 s31, 0, 8192
  s_add_u32 s46, s46, s31
  s_and_b32 s31, s46, s50
  s_add_u32 s46, s46, s31
  s_add_u32 s90, s90, 16896
  s_cmp_eq_u32 s90, s49
  s_cselect_b32 s31, 67584, 0
  s_sub_u32 s90, s90, s31
  v_mfma_f32_16x16x32_bf16 v[48:51], v[208:211], v[96:99], v[48:51]
  s_add_u32 m0, s48, 0
  s_add_u32 s51, s44, s45
  buffer_load_dwordx4 v251, s[32:35], s51 offen nt lds
  s_add_u32 m0, s48, 32
  s_nop 0
  buffer_load_dwordx4 v251, s[32:35], s51 offen offset:1024 nt lds
  s_xor_b32 s45, s45, s50
  s_cselect_b32 s31, 0, 8192
  s_add_u32 s44, s44, s31
  s_and_b32 s31, s44, s50
  s_add_u32 s44, s44, s31
  s_add_u32 s48, s48, 16896
  s_cmp_eq_u32 s48, s49
  s_cselect_b32 s31, 67584, 0
  s_sub_u32 s48, s48, s31
  v_mfma_f32_16x16x32_bf16 v[52:55], v[212:215], v[96:99], v[52:55]
  s_lshl_b32 s65, s60, 7
  s_lshl_b32 s66, s60, 19
  s_add_u32 m0, s62, s68
  s_add_u32 s66, s66, s61
  buffer_load_dwordx4 v224, s[72:75], s65 offen offset:0 lds
  buffer_load_dwordx4 v225, s[72:75], s65 offen offset:1024 lds
  v_mfma_f32_16x16x32_bf16 v[56:59], v[208:211], v[100:103], v[56:59]
  buffer_load_dwordx4 v226, s[72:75], s65 offen offset:2048 lds
  s_add_u32 m0, s62, s69
  s_nop 0
  buffer_load_dwordx4 v227, s[76:79], s66 offen offset:0 lds
  v_mfma_f32_16x16x32_bf16 v[60:63], v[212:215], v[100:103], v[60:63]
  buffer_load_dwordx4 v228, s[76:79], s66 offen offset:1024 lds
  buffer_load_dwordx4 v229, s[76:79], s66 offen offset:2048 lds
  v_mfma_f32_16x16x32_bf16 v[64:67], v[208:211], v[104:107], v[64:67]
  buffer_load_dwordx4 v230, s[76:79], s66 offen offset:3072 lds
  s_add_u32 m0, s62, s69
  s_add_u32 m0, m0, 16384
  s_add_u32 s66, s66, 256
  buffer_load_dwordx4 v227, s[76:79], s66 offen offset:0 lds
  v_mfma_f32_16x16x32_bf16 v[68:71], v[212:215], v[104:107], v[68:71]
  buffer_load_dwordx4 v228, s[76:79], s66 offen offset:1024 lds
  buffer_load_dwordx4 v229, s[76:79], s66 offen offset:2048 lds
  v_mfma_f32_16x16x32_bf16 v[72:75], v[208:211], v[108:111], v[72:75]
  buffer_load_dwordx4 v230, s[76:79], s66 offen offset:3072 lds
  s_add_u32 s60, s60, 1
  s_cmp_eq_u32 s60, 9
  s_cselect_b32 s60, 0, s60
  v_mfma_f32_16x16x32_bf16 v[76:79], v[212:215], v[108:111], v[76:79]
  v_mfma_f32_16x16x32_bf16 v[80:83], v[208:211], v[112:115], v[80:83]
  v_mfma_f32_16x16x32_bf16 v[84:87], v[212:215], v[112:115], v[84:87]
  v_mfma_f32_16x16x32_bf16 v[88:91], v[208:211], v[116:119], v[88:91]
  v_mfma_f32_16x16x32_bf16 v[92:95], v[212:215], v[116:119], v[92:95]
  v_mfma_f32_16x16x32_bf16 v[48:51], v[216:219], v[120:123], v[48:51]
  v_mfma_f32_16x16x32_bf16 v[52:55], v[220:223], v[120:123], v[52:55]
  v_mfma_f32_16x16x32_bf16 v[56:59], v[216:219], v[124:127], v[56:59]
  v_mfma_f32_16x16x32_bf16 v[60:63], v[220:223], v[124:127], v[60:63]
  v_mfma_f32_16x16x32_bf16 v[64:67], v[216:219], v[128:131], v[64:67]
  v_mfma_f32_16x16x32_bf16 v[68:71], v[220:223], v[128:131], v[68:71]
  v_mfma_f32_16x16x32_bf16 v[72:75], v[216:219], v[132:135], v[72:75]
  v_mfma_f32_16x16x32_bf16 v[76:79], v[220:223], v[132:135], v[76:79]
  v_mfma_f32_16x16x32_bf16 v[80:83], v[216:219], v[136:139], v[80:83]
  v_mfma_f32_16x16x32_bf16 v[84:87], v[220:223], v[136:139], v[84:87]
  v_mfma_f32_16x16x32_bf16 v[88:91], v[216:219], v[140:143], v[88:91]
  v_mfma_f32_16x16x32_bf16 v[92:95], v[220:223], v[140:143], v[92:95]
  s_cmp_lg_u32 s84, 1
  s_cbranch_scc1 L_only_31
  s_waitcnt vmcnt(19)
  s_barrier
  s_add_u32 m0, s90, 8448
  s_add_u32 s51, s46, s47
  buffer_load_dwordx4 v251, s[36:39], s51 offen nt lds
  s_add_u32 m0, s90, 8480
  s_nop 0
  buffer_load_dwordx4 v251, s[36:39], s51 offen offset:1024 nt lds
  s_xor_b32 s47, s47, s50
  s_cselect_b32 s31, 0, 8192
  s_add_u32 s46, s46, s31
  s_and_b32 s31, s46, s50
  s_add_u32 s46, s46, s31
  s_add_u32 s90, s90, 16896
  s_cmp_eq_u32 s90, s49
  s_cselect_b32 s31, 67584, 0
  s_sub_u32 s90, s90, s31
  s_add_u32 m0, s48, 0
  s_add_u32 s51, s44, s45
  buffer_load_dwordx4 v251, s[32:35], s51 offen nt lds
  s_add_u32 m0, s48, 32
  s_nop 0
  buffer_load_dwordx4 v251, s[32:35], s51 offen offset:1024 nt lds
  s_xor_b32 s45, s45, s50
  s_cselect_b32 s31, 0, 8192
  s_add_u32 s44, s44, s31
  s_and_b32 s31, s44, s50
  s_add_u32 s44, s44, s31
  s_add_u32 s48, s48, 16896
  s_cmp_eq_u32 s48, s49
  s_cselect_b32 s31, 67584, 0
  s_sub_u32 s48, s48, s31
L_only_31:
  s_cmp_lg_u32 s84, 1
  s_cbranch_scc1 L_only_32
  s_waitcnt vmcnt(19)
  s_barrier
  s_add_u32 m0, s90, 8448
  s_add_u32 s51, s46, s47
  buffer_load_dwordx4 v251, s[36:39], s51 offen nt lds
  s_add_u32 m0, s90, 8480
  s_nop 0
  buffer_load_dwordx4 v251, s[36:39], s51 offen offset:1024 nt lds
  s_xor_b32 s47, s47, s50
  s_cselect_b32 s31, 0, 8192
  s_add_u32 s46, s46, s31
  s_and_b32 s31, s46, s50
  s_add_u32 s46, s46, s31
  s_add_u32 s90, s90, 16896
  s_cmp_eq_u32 s90, s49
  s_cselect_b32 s31, 67584, 0
  s_sub_u32 s90, s90, s31
  s_add_u32 m0, s48, 0
  s_add_u32 s51, s44, s45
  buffer_load_dwordx4 v251, s[32:35], s51 offen nt lds
  s_add_u32 m0, s48, 32
  s_nop 0
  buffer_load_dwordx4 v251, s[32:35], s51 offen offset:1024 nt lds
  s_xor_b32 s45, s45, s50
  s_cselect_b32 s31, 0, 8192
  s_add_u32 s44, s44, s31
  s_and_b32 s31, s44, s50
  s_add_u32 s44, s44, s31
  s_add_u32 s48, s48, 16896
  s_cmp_eq_u32 s48, s49
  s_cselect_b32 s31, 67584, 0
  s_sub_u32 s48, s48, s31
L_only_32:
  s_sub_u32 s62, 45056, s62
  s_sub_u32 s63, 45056, s63
  s_sub_u32 s64, s64, 1
  s_cmp_lg_u32 s64, 0
  s_cbranch_scc1 L_lp_27
  s_mov_b32 s64, 2
L_lp_57:
  s_waitcnt vmcnt(8)
  s_cmp_lg_u32 s84, 0
  s_cbranch_scc1 L_vw_58
  s_waitcnt vmcnt(0)
L_vw_58:
  s_barrier
  s_add_u32 m0, s90, 8448
  s_add_u32 s51, s46, s47
  buffer_load_dwordx4 v251, s[36:39], s51 offen nt lds
  s_add_u32 m0, s90, 8480
  s_nop 0
  buffer_load_dwordx4 v251, s[36:39], s51 offen offset:1024 nt lds
  s_xor_b32 s47, s47, s50
  s_cselect_b32 s31, 0, 8192
  s_add_u32 s46, s46, s31
  s_and_b32 s31, s46, s50
  s_add_u32 s46, s46, s31
  s_add_u32 s90, s90, 16896
  s_cmp_eq_u32 s90, s49
  s_cselect_b32 s31, 67584, 0
  s_sub_u32 s90, s90, s31
  s_add_u32 m0, s48, 0
  s_add_u32 s51, s44, s45
  buffer_load_dwordx4 v251, s[32:35], s51 offen nt lds
  s_add_u32 m0, s48, 32
  s_nop 0
  buffer_load_dwordx4 v251, s[32:35], s51 offen offset:1024 nt lds
  s_xor_b32 s45, s45, s50
  s_cselect_b32 s31, 0, 8192
  s_add_u32 s44, s44, s31
  s_and_b32 s31, s44, s50
  s_add_u32 s44, s44, s31
  s_add_u32 s48, s48, 16896
  s_cmp_eq_u32 s48, s49
  s_cselect_b32 s31, 67584, 0
  s_sub_u32 s48, s48, s31
  v_add_u32 v238, s63, v233
  v_add_u32 v239, s63, v234
  v_add_u32 v236, s63, v231
  v_add_u32 v237, s63, v232
  ds_read_b64_tr_b16 v[192:193], v238 offset:0
  ds_read_b64_tr_b16 v[194:195], v238 offset:1024
  ds_read_b64_tr_b16 v[196:197], v239 offset:0
  ds_read_b64_tr_b16 v[198:199], v239 offset:1024
  ds_read_b128 v[96:99], v236 offset:0
  ds_read_b128 v[100:103], v236 offset:2048
  ds_read_b128 v[104:107], v236 offset:4096
  ds_read_b128 v[108:111], v236 offset:6144
  ds_read_b128 v[112:115], v236 offset:8192
  ds_read_b128 v[116:119], v236 offset:10240
  s_waitcnt lgkmcnt(5)
  v_mfma_f32_16x16x32_bf16 v[0:3], v[192:195], v[96:99], v[0:3]
  ds_read_b64_tr_b16 v[200:201], v238 offset:8192
  v_mfma_f32_16x16x32_bf16 v[4:7], v[196:199], v[96:99], v[4:7]
  ds_read_b64_tr_b16 v[202:203], v238 offset:9216
  s_waitcnt lgkmcnt(6)
  v_mfma_f32_16x16x32_bf16 v[8:11], v[192:195], v[100:103], v[8:11]
  ds_read_b64_tr_b16 v[204:205], v239 offset:8192
  v_mfma_f32_16x16x32_bf16 v[12:15], v[196:199], v[100:103], v[12:15]
  ds_read_b64_tr_b16 v[206:207], v239 offset:9216
  s_waitcnt lgkmcnt(7)
  v_mfma_f32_16x16x32_bf16 v[16:19], v[192:195], v[104:107], v[16:19]
  ds_read_b128 v[120:123], v237 offset:0
  v_mfma_f32_16x16x32_bf16 v[20:23], v[196:199], v[104:107], v[20:23]
  ds_read_b128 v[124:127], v237 offset:2048
  s_waitcnt lgkmcnt(8)
  v_mfma_f32_16x16x32_bf16 v[24:27], v[192:195], v[108:111], v[24:27]
  ds_read_b128 v[128:131], v237 offset:4096
  v_mfma_f32_16x16x32_bf16 v[28:31], v[196:199], v[108:111], v[28:31]
  ds_read_b128 v[132:135], v237 offset:6144
  s_waitcnt lgkmcnt(9)
  v_mfma_f32_16x16x32_bf16 v[32:35], v[192:195], v[112:115], v[32:35]
  ds_read_b128 v[136:139], v237 offset:8192
  v_mfma_f32_16x16x32_bf16 v[36:39], v[196:199], v[112:115], v[36:39]
  ds_read_b128 v[140:143], v237 offset:10240
  s_waitcnt lgkmcnt(10)
  v_mfma_f32_16x16x32_bf16 v[40:43], v[192:195], v[116:119], v[40:43]
  ds_read_b64_tr_b16 v[208:209], v238 offset:16384
  v_mfma_f32_16x16x32_bf16 v[44:47], v[196:199], v[116:119], v[44:47]
  ds_read_b64_tr_b16 v[210:211], v238 offset:17408
  s_cmp_lg_u32 s84, 1
  s_cbranch_scc1 L_only_59
  s_waitcnt vmcnt(8)
  s_barrier
  s_add_u32 m0, s90, 8448
  s_add_u32 s51, s46, s47
  buffer_load_dwordx4 v251, s[36:39], s51 offen nt lds
  s_add_u32 m0, s90, 8480
  s_nop 0
  buffer_load_dwordx4 v251, s[36:39], s51 offen offset:1024 nt lds
  s_xor_b32 s47, s47, s50
  s_cselect_b32 s31, 0, 8192
  s_add_u32 s46, s46, s31
  s_and_b32 s31, s46, s50
  s_add_u32 s46, s46, s31
  s_add_u32 s90, s90, 16896
  s_cmp_eq_u32 s90, s49
  s_cselect_b32 s31, 67584, 0
  s_sub_u32 s90, s90, s31
  s_add_u32 m0, s48, 0
  s_add_u32 s51, s44, s45
  buffer_load_dwordx4 v251, s[32:35], s51 offen nt lds
  s_add_u32 m0, s48, 32
  s_nop 0
  buffer_load_dwordx4 v251, s[32:35], s51 offen offset:1024 nt lds
  s_xor_b32 s45, s45, s50
  s_cselect_b32 s31, 0, 8192
  s_add_u32 s44, s44, s31
  s_and_b32 s31, s44, s50
  s_add_u32 s44, s44, s31
  s_add_u32 s48, s48, 16896
  s_cmp_eq_u32 s48, s49
  s_cselect_b32 s31, 67584, 0
  s_sub_u32 s48, s48, s31
L_only_59:
  s_waitcnt lgkmcnt(7)
  v_mfma_f32_16x16x32_bf16 v[0:3], v[200:203], v[120:123], v[0:3]
  ds_read_b64_tr_b16 v[212:213], v239 offset:16384
  v_mfma_f32_16x16x32_bf16 v[4:7], v[204:207], v[120:123], v[4:7]
  ds_read_b64_tr_b16 v[214:215], v239 offset:17408
  s_waitcnt lgkmcnt(8)
  v_mfma_f32_16x16x32_bf16 v[8:11], v[200:203], v[124:127], v[8:11]
  ds_read_b64_tr_b16 v[216:217], v238 offset:24576
  v_mfma_f32_16x16x32_bf16 v[12:15], v[204:207], v[124:127], v[12:15]
  ds_read_b64_tr_b16 v[218:219], v238 offset:25600
  s_waitcnt lgkmcnt(9)
  v_mfma_f32_16x16x32_bf16 v[16:19], v[200:203], v[128:131], v[16:19]
  ds_read_b64_tr_b16 v[220:221], v239 offset:24576
  v_mfma_f32_16x16x32_bf16 v[20:23], v[204:207], v[128:131], v[20:23]
  ds_read_b64_tr_b16 v[222:223], v239 offset:25600
  s_waitcnt lgkmcnt(10)
  v_mfma_f32_16x16x32_bf16 v[24:27], v[200:203], v[132:135], v[24:27]
  v_mfma_f32_16x16x32_bf16 v[28:31], v[204:207], v[132:135], v[28:31]
  s_waitcnt lgkmcnt(9)
  v_mfma_f32_16x16x32_bf16 v[32:35], v[200:203], v[136:139], v[32:35]
  v_mfma_f32_16x16x32_bf16 v[36:39], v[204:207], v[136:139], v[36:39]
  s_waitcnt lgkmcnt(8)
  v_mfma_f32_16x16x32_bf16 v[40:43], v[200:203], v[140:143], v[40:43]
  v_mfma_f32_16x16x32_bf16 v[44:47], v[204:207], v[140:143], v[44:47]
  s_waitcnt lgkmcnt(0)
  s_waitcnt vmcnt(8)
  s_cmp_lg_u32 s84, 0
  s_cbranch_scc1 L_vw_60
  s_waitcnt vmcnt(0)
L_vw_60:
  s_barrier
  s_add_u32 m0, s90, 8448
  s_add_u32 s51, s46, s47
  buffer_load_dwordx4 v251, s[36:39], s51 offen nt lds
  s_add_u32 m0, s90, 8480
  s_nop 0
  buffer_load_dwordx4 v251, s[36:39], s51 offen offset:1024 nt lds
  s_xor_b32 s47, s47, s50
  s_cselect_b32 s31, 0, 8192
  s_add_u32 s46, s46, s31
  s_and_b32 s31, s46, s50
  s_add_u32 s46, s46, s31
  s_add_u32 s90, s90, 16896
  s_cmp_eq_u32 s90, s49
  s_cselect_b32 s31, 67584, 0
  s_sub_u32 s90, s90, s31
  v_mfma_f32_16x16x32_bf16 v[48:51], v[208:211], v[96:99], v[48:51]
  s_add_u32 m0, s48, 0
  s_add_u32 s51, s44, s45
  buffer_load_dwordx4 v251, s[32:35], s51 offen nt lds
  s_add_u32 m0, s48, 32
  s_nop 0
  buffer_load_dwordx4 v251, s[32:35], s51 offen offset:1024 nt lds
  s_xor_b32 s45, s45, s50
  s_cselect_b32 s31, 0, 8192
  s_add_u32 s44, s44, s31
  s_and_b32 s31, s44, s50
  s_add_u32 s44, s44, s31
  s_add_u32 s48, s48, 16896
  s_cmp_eq_u32 s48, s49
  s_cselect_b32 s31, 67584, 0
  s_sub_u32 s48, s48, s31
  v_mfma_f32_16x16x32_bf16 v[52:55], v[212:215], v[96:99], v[52:55]
  v_mfma_f32_16x16x32_bf16 v[56:59], v[208:211], v[100:103], v[56:59]
  v_mfma_f32_16x16x32_bf16 v[60:63], v[212:215], v[100:103], v[60:63]
  v_mfma_f32_16x16x32_bf16 v[64:67], v[208:211], v[104:107], v[64:67]
  v_mfma_f32_16x16x32_bf16 v[68:71], v[212:215], v[104:107], v[68:71]
  v_mfma_f32_16x16x32_bf16 v[72:75], v[208:211], v[108:111], v[72:75]
  v_mfma_f32_16x16x32_bf16 v[76:79], v[212:215], v[108:111], v[76:79]
  v_mfma_f32_16x16x32_bf16 v[80:83], v[208:211], v[112:115], v[80:83]
  v_mfma_f32_16x16x32_bf16 v[84:87], v[212:215], v[112:115], v[84:87]
  v_mfma_f32_16x16x32_bf16 v[88:91], v[208:211], v[116:119], v[88:91]
  v_mfma_f32_16x16x32_bf16 v[92:95], v[212:215], v[116:119], v[92:95]
  v_mfma_f32_16x16x32_bf16 v[48:51], v[216:219], v[120:123], v[48:51]
  v_mfma_f32_16x16x32_bf16 v[52:55], v[220:223], v[120:123], v[52:55]
  v_mfma_f32_16x16x32_bf16 v[56:59], v[216:219], v[124:127], v[56:59]
  v_mfma_f32_16x16x32_bf16 v[60:63], v[220:223], v[124:127], v[60:63]
  v_mfma_f32_16x16x32_bf16 v[64:67], v[216:219], v[128:131], v[64:67]
  v_mfma_f32_16x16x32_bf16 v[68:71], v[220:223], v[128:131], v[68:71]
  v_mfma_f32_16x16x32_bf16 v[72:75], v[216:219], v[132:135], v[72:75]
  v_mfma_f32_16x16x32_bf16 v[76:79], v[220:223], v[132:135], v[76:79]
  v_mfma_f32_16x16x32_bf16 v[80:83], v[216:219], v[136:139], v[80:83]
  v_mfma_f32_16x16x32_bf16 v[84:87], v[220:223], v[136:139], v[84:87]
  v_mfma_f32_16x16x32_bf16 v[88:91], v[216:219], v[140:143], v[88:91]
  v_mfma_f32_16x16x32_bf16 v[92:95], v[220:223], v[140:143], v[92:95]
  s_cmp_lg_u32 s84, 1
  s_cbranch_scc1 L_only_61
  s_waitcnt vmcnt(8)
  s_barrier
  s_add_u32 m0, s90, 8448
  s_add_u32 s51, s46, s47
  buffer_load_dwordx4 v251, s[36:39], s51 offen nt lds
  s_add_u32 m0, s90, 8480
  s_nop 0
  buffer_load_dwordx4 v251, s[36:39], s51 offen offset:1024 nt lds
  s_xor_b32 s47, s47, s50
  s_cselect_b32 s31, 0, 8192
  s_add_u32 s46, s46, s31
  s_and_b32 s31, s46, s50
  s_add_u32 s46, s46, s31
  s_add_u32 s90, s90, 16896
  s_cmp_eq_u32 s90, s49
  s_cselect_b32 s31, 67584, 0
  s_sub_u32 s90, s90, s31
  s_add_u32 m0, s48, 0
  s_add_u32 s51, s44, s45
  buffer_load_dwordx4 v251, s[32:35], s51 offen nt lds
  s_add_u32 m0, s48, 32
  s_nop 0
  buffer_load_dwordx4 v251, s[32:35], s51 offen offset:1024 nt lds
  s_xor_b32 s45, s45, s50
  s_cselect_b32 s31, 0, 8192
  s_add_u32 s44, s44, s31
  s_and_b32 s31, s44, s50
  s_add_u32 s44, s44, s31
  s_add_u32 s48, s48, 16896
  s_cmp_eq_u32 s48, s49
  s_cselect_b32 s31, 67584, 0
  s_sub_u32 s48, s48, s31
L_only_61:
  s_cmp_lg_u32 s84, 1
  s_cbranch_scc1 L_only_62
  s_waitcnt vmcnt(8)
  s_barrier
  s_add_u32 m0, s90, 8448
  s_add_u32 s51, s46, s47
  buffer_load_dwordx4 v251, s[36:39], s51 offen nt lds
  s_add_u32 m0, s90, 8480
  s_nop 0
  buffer_load_dwordx4 v251, s[36:39], s51 offen offset:1024 nt lds
  s_xor_b32 s47, s47, s50
  s_cselect_b32 s31, 0, 8192
  s_add_u32 s46, s46, s31
  s_and_b32 s31, s46, s50
  s_add_u32 s46, s46, s31
  s_add_u32 s90, s90, 16896
  s_cmp_eq_u32 s90, s49
  s_cselect_b32 s31, 67584, 0
  s_sub_u32 s90, s90, s31
  s_add_u32 m0, s48, 0
  s_add_u32 s51, s44, s45
  buffer_load_dwordx4 v251, s[32:35], s51 offen nt lds
  s_add_u32 m0, s48, 32
  s_nop 0
  buffer_load_dwordx4 v251, s[32:35], s51 offen offset:1024 nt lds
  s_xor_b32 s45, s45, s50
  s_cselect_b32 s31, 0, 8192
  s_add_u32 s44, s44, s31
  s_and_b32 s31, s44, s50
  s_add_u32 s44, s44, s31
  s_add_u32 s48, s48, 16896
  s_cmp_eq_u32 s48, s49
  s_cselect_b32 s31, 67584, 0
  s_sub_u32 s48, s48, s31
L_only_62:
  s_sub_u32 s62, 45056, s62
  s_sub_u32 s63, 45056, s63
  s_sub_u32 s64, s64, 1
  s_cmp_lg_u32 s64, 0
  s_cbranch_scc1 L_lp_57
  s_cmp_lg_u32 s84, 1
  s_cbranch_scc1 L_only_66
  s_waitcnt vmcnt(8)
  s_barrier
  s_add_u32 m0, s90, 8448
  s_add_u32 s51, s46, s47
  buffer_load_dwordx4 v251, s[36:39], s51 offen nt lds
  s_add_u32 m0, s90, 8480
  s_nop 0
  buffer_load_dwordx4 v251, s[36:39], s51 offen offset:1024 nt lds
  s_xor_b32 s47, s47, s50
  s_cselect_b32 s31, 0, 8192
  s_add_u32 s46, s46, s31
  s_and_b32 s31, s46, s50
  s_add_u32 s46, s46, s31
  s_add_u32 s90, s90, 16896
  s_cmp_eq_u32 s90, s49
  s_cselect_b32 s31, 67584, 0
  s_sub_u32 s90, s90, s31
  s_add_u32 m0, s48, 0
  s_add_u32 s51, s44, s45
  buffer_load_dwordx4 v251, s[32:35], s51 offen nt lds
  s_add_u32 m0, s48, 32
  s_nop 0
  buffer_load_dwordx4 v251, s[32:35], s51 offen offset:1024 nt lds
  s_xor_b32 s45, s45, s50
  s_cselect_b32 s31, 0, 8192
  s_add_u32 s44, s44, s31
  s_and_b32 s31, s44, s50
  s_add_u32 s44, s44, s31
  s_add_u32 s48, s48, 16896
  s_cmp_eq_u32 s48, s49
  s_cselect_b32 s31, 67584, 0
  s_sub_u32 s48, s48, s31
L_only_66:
  v_pk_mul_f32 v[0:1], v[0:1], s[54:55]
  v_pk_mul_f32 v[2:3], v[2:3], s[54:55]
  v_cvt_pk_bf16_f32 v144, v0, v1
  v_pk_mul_f32 v[4:5], v[4:5], s[54:55]
  v_cvt_pk_bf16_f32 v145, v2, v3
  v_pk_mul_f32 v[6:7], v[6:7], s[54:55]
  v_cvt_pk_bf16_f32 v146, v4, v5
  v_pk_mul_f32 v[8:9], v[8:9], s[54:55]
  v_cvt_pk_bf16_f32 v147, v6, v7
  v_pk_mul_f32 v[10:11], v[10:11], s[54:55]
  v_cvt_pk_bf16_f32 v148, v8, v9
  v_pk_mul_f32 v[12:13], v[12:13], s[54:55]
  v_cvt_pk_bf16_f32 v149, v10, v11
  v_pk_mul_f32 v[14:15], v[14:15], s[54:55]
  v_cvt_pk_bf16_f32 v150, v12, v13
  v_pk_mul_f32 v[16:17], v[16:17], s[54:55]
  v_cvt_pk_bf16_f32 v151, v14, v15
  v_pk_mul_f32 v[18:19], v[18:19], s[54:55]
  v_cvt_pk_bf16_f32 v152, v16, v17
  v_pk_mul_f32 v[20:21], v[20:21], s[54:55]
  v_cvt_pk_bf16_f32 v153, v18, v19
  v_pk_mul_f32 v[22:23], v[22:23], s[54:55]
  v_cvt_pk_bf16_f32 v154, v20, v21
  v_pk_mul_f32 v[24:25], v[24:25], s[54:55]
  v_cvt_pk_bf16_f32 v155, v22, v23
  v_pk_mul_f32 v[26:27], v[26:27], s[54:55]
  v_cvt_pk_bf16_f32 v156, v24, v25
  v_pk_mul_f32 v[28:29], v[28:29], s[54:55]
  v_cvt_pk_bf16_f32 v157, v26, v27
  v_pk_mul_f32 v[30:31], v[30:31], s[54:55]
  v_cvt_pk_bf16_f32 v158, v28, v29
  v_pk_mul_f32 v[32:33], v[32:33], s[54:55]
  v_cvt_pk_bf16_f32 v159, v30, v31
  v_pk_mul_f32 v[34:35], v[34:35], s[54:55]
  v_cvt_pk_bf16_f32 v160, v32, v33
  v_pk_mul_f32 v[36:37], v[36:37], s[54:55]
  v_cvt_pk_bf16_f32 v161, v34, v35
  v_pk_mul_f32 v[38:39], v[38:39], s[54:55]
  v_cvt_pk_bf16_f32 v162, v36, v37
  v_pk_mul_f32 v[40:41], v[40:41], s[54:55]
  v_cvt_pk_bf16_f32 v163, v38, v39
  v_pk_mul_f32 v[42:43], v[42:43], s[54:55]
  v_cvt_pk_bf16_f32 v164, v40, v41
  v_pk_mul_f32 v[44:45], v[44:45], s[54:55]
  v_cvt_pk_bf16_f32 v165, v42, v43
  v_pk_mul_f32 v[46:47], v[46:47], s[54:55]
  v_cvt_pk_bf16_f32 v166, v44, v45
  v_cvt_pk_bf16_f32 v167, v46, v47
  s_waitcnt vmcnt(8)
  s_cmp_lg_u32 s84, 0
  s_cbranch_scc1 L_vw_67
  s_waitcnt vmcnt(0)
L_vw_67:
  s_barrier
  s_add_u32 m0, s90, 8448
  s_add_u32 s51, s46, s47
  buffer_load_dwordx4 v251, s[36:39], s51 offen nt lds
  s_add_u32 m0, s90, 8480
  s_nop 0
  buffer_load_dwordx4 v251, s[36:39], s51 offen offset:1024 nt lds
  s_xor_b32 s47, s47, s50
  s_cselect_b32 s31, 0, 8192
  s_add_u32 s46, s46, s31
  s_and_b32 s31, s46, s50
  s_add_u32 s46, s46, s31
  s_add_u32 s90, s90, 16896
  s_cmp_eq_u32 s90, s49
  s_cselect_b32 s31, 67584, 0
  s_sub_u32 s90, s90, s31
  s_add_u32 m0, s48, 0
  s_add_u32 s51, s44, s45
  buffer_load_dwordx4 v251, s[32:35], s51 offen nt lds
  s_add_u32 m0, s48, 32
  s_nop 0
  buffer_load_dwordx4 v251, s[32:35], s51 offen offset:1024 nt lds
  s_xor_b32 s45, s45, s50
  s_cselect_b32 s31, 0, 8192
  s_add_u32 s44, s44, s31
  s_and_b32 s31, s44, s50
  s_add_u32 s44, s44, s31
  s_add_u32 s48, s48, 16896
  s_cmp_eq_u32 s48, s49
  s_cselect_b32 s31, 67584, 0
  s_sub_u32 s48, s48, s31
  ds_write_b64 v241, v[144:145] offset:0
  ds_write_b64 v241, v[146:147] offset:32
  ds_write_b64 v241, v[148:149] offset:4352
  ds_write_b64 v241, v[150:151] offset:4384
  ds_write_b64 v241, v[152:153] offset:8704
  ds_write_b64 v241, v[154:155] offset:8736
  ds_write_b64 v241, v[156:157] offset:13056
  ds_write_b64 v241, v[158:159] offset:13088
  ds_write_b64 v241, v[160:161] offset:17408
  ds_write_b64 v241, v[162:163] offset:17440
  ds_write_b64 v241, v[164:165] offset:21760
  ds_write_b64 v241, v[166:167] offset:21792
  s_cmp_lg_u32 s84, 1
  s_cbranch_scc1 L_only_68
  s_waitcnt vmcnt(8)
  s_barrier
  s_add_u32 m0, s90, 8448
  s_add_u32 s51, s46, s47
  buffer_load_dwordx4 v251, s[36:39], s51 offen nt lds
  s_add_u32 m0, s90, 8480
  s_nop 0
  buffer_load_dwordx4 v251, s[36:39], s51 offen offset:1024 nt lds
  s_xor_b32 s47, s47, s50
  s_cselect_b32 s31, 0, 8192
  s_add_u32 s46, s46, s31
  s_and_b32 s31, s46, s50
  s_add_u32 s46, s46, s31
  s_add_u32 s90, s90, 16896
  s_cmp_eq_u32 s90, s49
  s_cselect_b32 s31, 67584, 0
  s_sub_u32 s90, s90, s31
  s_add_u32 m0, s48, 0
  s_add_u32 s51, s44, s45
  buffer_load_dwordx4 v251, s[32:35], s51 offen nt lds
  s_add_u32 m0, s48, 32
  s_nop 0
  buffer_load_dwordx4 v251, s[32:35], s51 offen offset:1024 nt lds
  s_xor_b32 s45, s45, s50
  s_cselect_b32 s31, 0, 8192
  s_add_u32 s44, s44, s31
  s_and_b32 s31, s44, s50
  s_add_u32 s44, s44, s31
  s_add_u32 s48, s48, 16896
  s_cmp_eq_u32 s48, s49
  s_cselect_b32 s31, 67584, 0
  s_sub_u32 s48, s48, s31
L_only_68:
  v_pk_mul_f32 v[48:49], v[48:49], s[54:55]
  v_pk_mul_f32 v[50:51], v[50:51], s[54:55]
  v_cvt_pk_bf16_f32 v168, v48, v49
  v_pk_mul_f32 v[52:53], v[52:53], s[54:55]
  v_cvt_pk_bf16_f32 v169, v50, v51
  v_pk_mul_f32 v[54:55], v[54:55], s[54:55]
  v_cvt_pk_bf16_f32 v170, v52, v53
  v_pk_mul_f32 v[56:57], v[56:57], s[54:55]
  v_cvt_pk_bf16_f32 v171, v54, v55
  v_pk_mul_f32 v[58:59], v[58:59], s[54:55]
  v_cvt_pk_bf16_f32 v172, v56, v57
  v_pk_mul_f32 v[60:61], v[60:61], s[54:55]
  v_cvt_pk_bf16_f32 v173, v58, v59
  v_pk_mul_f32 v[62:63], v[62:63], s[54:55]
  v_cvt_pk_bf16_f32 v174, v60, v61
  v_pk_mul_f32 v[64:65], v[64:65], s[54:55]
  v_cvt_pk_bf16_f32 v175, v62, v63
  v_pk_mul_f32 v[66:67], v[66:67], s[54:55]
  v_cvt_pk_bf16_f32 v176, v64, v65
  v_pk_mul_f32 v[68:69], v[68:69], s[54:55]
  v_cvt_pk_bf16_f32 v177, v66, v67
  v_pk_mul_f32 v[70:71], v[70:71], s[54:55]
  v_cvt_pk_bf16_f32 v178, v68, v69
  v_pk_mul_f32 v[72:73], v[72:73], s[54:55]
  v_cvt_pk_bf16_f32 v179, v70, v71
  v_pk_mul_f32 v[74:75], v[74:75], s[54:55]
  v_cvt_pk_bf16_f32 v180, v72, v73
  v_pk_mul_f32 v[76:77], v[76:77], s[54:55]
  v_cvt_pk_bf16_f32 v181, v74, v75
  v_pk_mul_f32 v[78:79], v[78:79], s[54:55]
  v_cvt_pk_bf16_f32 v182, v76, v77
  v_pk_mul_f32 v[80:81], v[80:81], s[54:55]
  v_cvt_pk_bf16_f32 v183, v78, v79
  v_pk_mul_f32 v[82:83], v[82:83], s[54:55]
  v_cvt_pk_bf16_f32 v184, v80, v81
  v_pk_mul_f32 v[84:85], v[84:85], s[54:55]
  v_cvt_pk_bf16_f32 v185, v82, v83
  v_pk_mul_f32 v[86:87], v[86:87], s[54:55]
  v_cvt_pk_bf16_f32 v186, v84, v85
  v_pk_mul_f32 v[88:89], v[88:89], s[54:55]
  v_cvt_pk_bf16_f32 v187, v86, v87
  v_pk_mul_f32 v[90:91], v[90:91], s[54:55]
  v_cvt_pk_bf16_f32 v188, v88, v89
  v_pk_mul_f32 v[92:93], v[92:93], s[54:55]
  v_cvt_pk_bf16_f32 v189, v90, v91
  v_pk_mul_f32 v[94:95], v[94:95], s[54:55]
  v_cvt_pk_bf16_f32 v190, v92, v93
  v_cvt_pk_bf16_f32 v191, v94, v95
  s_cmp_lg_u32 s84, 1
  s_cbranch_scc1 L_only_69
  s_waitcnt vmcnt(8)
  s_barrier
  s_add_u32 m0, s90, 8448
  s_add_u32 s51, s46, s47
  buffer_load_dwordx4 v251, s[36:39], s51 offen nt lds
  s_add_u32 m0, s90, 8480
  s_nop 0
  buffer_load_dwordx4 v251, s[36:39], s51 offen offset:1024 nt lds
  s_xor_b32 s47, s47, s50
  s_cselect_b32 s31, 0, 8192
  s_add_u32 s46, s46, s31
  s_and_b32 s31, s46, s50
  s_add_u32 s46, s46, s31
  s_add_u32 s90, s90, 16896
  s_cmp_eq_u32 s90, s49
  s_cselect_b32 s31, 67584, 0
  s_sub_u32 s90, s90, s31
  s_add_u32 m0, s48, 0
  s_add_u32 s51, s44, s45
  buffer_load_dwordx4 v251, s[32:35], s51 offen nt lds
  s_add_u32 m0, s48, 32
  s_nop 0
  buffer_load_dwordx4 v251, s[32:35], s51 offen offset:1024 nt lds
  s_xor_b32 s45, s45, s50
  s_cselect_b32 s31, 0, 8192
  s_add_u32 s44, s44, s31
  s_and_b32 s31, s44, s50
  s_add_u32 s44, s44, s31
  s_add_u32 s48, s48, 16896
  s_cmp_eq_u32 s48, s49
  s_cselect_b32 s31, 67584, 0
  s_sub_u32 s48, s48, s31
L_only_69:
  ds_write_b64 v241, v[168:169] offset:26112
  ds_write_b64 v241, v[170:171] offset:26144
  ds_write_b64 v241, v[172:173] offset:30464
  ds_write_b64 v241, v[174:175] offset:30496
  ds_write_b64 v241, v[176:177] offset:34816
  ds_write_b64 v241, v[178:179] offset:34848
  ds_write_b64 v241, v[180:181] offset:39168
  ds_write_b64 v241, v[182:183] offset:39200
  ds_write_b64 v241, v[184:185] offset:43520
  ds_write_b64 v241, v[186:187] offset:43552
  ds_write_b64 v241, v[188:189] offset:47872
  ds_write_b64 v241, v[190:191] offset:47904
  s_waitcnt lgkmcnt(0)
  s_waitcnt vmcnt(8)
  s_cmp_lg_u32 s84, 0
  s_cbranch_scc1 L_vw_70
  s_waitcnt vmcnt(0)
L_vw_70:
  s_barrier
  s_add_u32 m0, s90, 8448
  s_add_u32 s51, s46, s47
  buffer_load_dwordx4 v251, s[36:39], s51 offen nt lds
  s_add_u32 m0, s90, 8480
  s_nop 0
  buffer_load_dwordx4 v251, s[36:39], s51 offen offset:1024 nt lds
  s_xor_b32 s47, s47, s50
  s_cselect_b32 s31, 0, 8192
  s_add_u32 s46, s46, s31
  s_and_b32 s31, s46, s50
  s_add_u32 s46, s46, s31
  s_add_u32 s90, s90, 16896
  s_cmp_eq_u32 s90, s49
  s_cselect_b32 s31, 67584, 0
  s_sub_u32 s90, s90, s31
  s_add_u32 m0, s48, 0
  s_add_u32 s51, s44, s45
  buffer_load_dwordx4 v251, s[32:35], s51 offen nt lds
  s_add_u32 m0, s48, 32
  s_nop 0
  buffer_load_dwordx4 v251, s[32:35], s51 offen offset:1024 nt lds
  s_xor_b32 s45, s45, s50
  s_cselect_b32 s31, 0, 8192
  s_add_u32 s44, s44, s31
  s_and_b32 s31, s44, s50
  s_add_u32 s44, s44, s31
  s_add_u32 s48, s48, 16896
  s_cmp_eq_u32 s48, s49
  s_cselect_b32 s31, 67584, 0
  s_sub_u32 s48, s48, s31
  v_add_u32 v252, 1, v252
  s_mov_b32 s72, s12
  s_and_b32 s73, s13, 0xffff
  s_mov_b32 s74, 4718592
  s_mov_b32 s75, 0x20000
  s_lshl_b32 s31, s84, 4
  s_add_u32 s31, s31, s71
  s_mul_i32 s31, s31, 884736
  s_add_u32 s76, s28, s31
  s_addc_u32 s77, s29, 0
  s_and_b32 s77, s77, 0xffff
  s_mov_b32 s78, 884736
  s_mov_b32 s79, 0x20000
  s_lshl_b32 s31, s70, 3
  s_add_u32 s31, s31, s30
  s_mul_i32 s61, s31, 73728
  s_mul_i32 s65, s70, 110592
  s_add_u32 s65, s65, s68
  s_lshl_b32 s69, s30, 13
  s_mov_b32 s53, s60
  v_lshrrev_b32 v1, 3, v250
  v_and_b32 v2, 7, v250
  v_bfe_u32 v3, v250, 4, 2
  v_lshlrev_b32 v3, 1, v3
  v_xor_b32 v2, v2, v3
  v_mul_u32_u24 v1, 1152, v1
  v_lshl_add_u32 v244, v2, 4, v1
  s_mov_b32 s80, s24
  s_and_b32 s81, s25, 0xffff
  s_mov_b32 s82, 3538944
  s_mov_b32 s83, 0x20000
  v_bfe_u32 v1, v250, 1, 1
  s_lshr_b32 s31, s30, 1
  s_lshl_b32 s31, s31, 2
  v_add_u32 v1, s31, v1
  v_bfe_u32 v2, v250, 3, 2
  v_lshlrev_b32 v2, 1, v2
  v_xor_b32 v1, v1, v2
  v_lshrrev_b32 v2, 2, v250
  v_lshlrev_b32 v2, 7, v2
  v_and_b32 v3, 1, v250
  v_lshl_add_u32 v2, v3, 3, v2
  v_lshl_add_u32 v245, v1, 4, v2
  v_xor_b32 v1, 2, v1
  v_lshl_add_u32 v253, v1, 4, v2
  s_mul_i32 s64, s84, 3
  s_add_u32 s64, s64, 9
L_lp_71:
  s_waitcnt vmcnt(8)
  s_cmp_lg_u32 s84, 0
  s_cbranch_scc1 L_vw_72
  s_waitcnt vmcnt(0)
L_vw_72:
  s_barrier
  s_add_u32 m0, s90, 8448
  s_add_u32 s51, s46, s47
  buffer_load_dwordx4 v251, s[36:39], s51 offen nt lds
  s_add_u32 m0, s90, 8480
  s_nop 0
  buffer_load_dwordx4 v251, s[36:39], s51 offen offset:1024 nt lds
  s_xor_b32 s47, s47, s50
  s_cselect_b32 s31, 0, 8192
  s_add_u32 s46, s46, s31
  s_and_b32 s31, s46, s50
  s_add_u32 s46, s46, s31
  s_add_u32 s90, s90, 16896
  s_cmp_eq_u32 s90, s49
  s_cselect_b32 s31, 67584, 0
  s_sub_u32 s90, s90, s31
  s_add_u32 m0, s48, 0
  s_add_u32 s51, s44, s45
  buffer_load_dwordx4 v251, s[32:35], s51 offen nt lds
  s_add_u32 m0, s48, 32
  s_nop 0
  buffer_load_dwordx4 v251, s[32:35], s51 offen offset:1024 nt lds
  s_xor_b32 s45, s45, s50
  s_cselect_b32 s31, 0, 8192
  s_add_u32 s44, s44, s31
  s_and_b32 s31, s44, s50
  s_add_u32 s44, s44, s31
  s_add_u32 s48, s48, 16896
  s_cmp_eq_u32 s48, s49
  s_cselect_b32 s31, 67584, 0
  s_sub_u32 s48, s48, s31
  s_sub_u32 s64, s64, 1
  s_cmp_lg_u32 s64, 0
  s_cbranch_scc1 L_lp_71
  s_waitcnt vmcnt(8)
  s_cmp_lg_u32 s84, 0
  s_cbranch_scc1 L_vw_73
  s_waitcnt vmcnt(0)
L_vw_73:
  s_barrier
  s_add_u32 m0, s90, 8448
  s_add_u32 s51, s46, s47
  buffer_load_dwordx4 v251, s[36:39], s51 offen nt lds
  s_add_u32 m0, s90, 8480
  s_nop 0
  buffer_load_dwordx4 v251, s[36:39], s51 offen offset:1024 nt lds
  s_xor_b32 s47, s47, s50
  s_cselect_b32 s31, 0, 8192
  s_add_u32 s46, s46, s31
  s_and_b32 s31, s46, s50
  s_add_u32 s46, s46, s31
  s_add_u32 s90, s90, 16896
  s_cmp_eq_u32 s90, s49
  s_cselect_b32 s31, 67584, 0
  s_sub_u32 s90, s90, s31
  s_add_u32 m0, s48, 0
  s_add_u32 s51, s44, s45
  buffer_load_dwordx4 v251, s[32:35], s51 offen nt lds
  s_add_u32 m0, s48, 32
  s_nop 0
  buffer_load_dwordx4 v251, s[32:35], s51 offen offset:1024 nt lds
  s_xor_b32 s45, s45, s50
  s_cselect_b32 s31, 0, 8192
  s_add_u32 s44, s44, s31
  s_and_b32 s31, s44, s50
  s_add_u32 s44, s44, s31
  s_add_u32 s48, s48, 16896
  s_cmp_eq_u32 s48, s49
  s_cselect_b32 s31, 67584, 0
  s_sub_u32 s48, s48, s31
  s_and_b32 s31, s30, 1
  s_mul_i32 s31, s31, 24576
  v_add_u32 v228, s31, v251
  ds_read_b128 v[0:3], v228 offset:0
  ds_read_b128 v[4:7], v228 offset:1024
  ds_read_b128 v[8:11], v228 offset:2048
  ds_read_b128 v[12:15], v228 offset:3072
  ds_read_b128 v[16:19], v228 offset:4096
  ds_read_b128 v[20:23], v228 offset:5120
  ds_read_b128 v[24:27], v228 offset:6144
  ds_read_b128 v[28:31], v228 offset:7168
  ds_read_b128 v[32:35], v228 offset:8192
  ds_read_b128 v[36:39], v228 offset:9216
  ds_read_b128 v[40:43], v228 offset:10240
  ds_read_b128 v[44:47], v228 offset:11264
  ds_read_b128 v[48:51], v228 offset:12288
  ds_read_b128 v[52:55], v228 offset:13312
  ds_read_b128 v[56:59], v228 offset:14336
  s_waitcnt lgkmcnt(7)
  ds_read_b128 v[60:63], v228 offset:15360
  ds_read_b128 v[64:67], v228 offset:16384
  ds_read_b128 v[68:71], v228 offset:17408
  ds_read_b128 v[72:75], v228 offset:18432
  ds_read_b128 v[76:79], v228 offset:19456
  ds_read_b128 v[80:83], v228 offset:20480
  ds_read_b128 v[84:87], v228 offset:21504
  ds_read_b128 v[88:91], v228 offset:22528
  s_waitcnt lgkmcnt(7)
  ds_read_b128 v[92:95], v228 offset:23552
  s_waitcnt lgkmcnt(0)
  s_cmp_lg_u32 s84, 1
  s_cbranch_scc1 L_only_74
  s_mov_b32 s64, 3
L_lp_75:
  s_waitcnt vmcnt(8)
  s_barrier
  s_add_u32 m0, s90, 8448
  s_add_u32 s51, s46, s47
  buffer_load_dwordx4 v251, s[36:39], s51 offen nt lds
  s_add_u32 m0, s90, 8480
  s_nop 0
  buffer_load_dwordx4 v251, s[36:39], s51 offen offset:1024 nt lds
  s_xor_b32 s47, s47, s50
  s_cselect_b32 s31, 0, 8192
  s_add_u32 s46, s46, s31
  s_and_b32 s31, s46, s50
  s_add_u32 s46, s46, s31
  s_add_u32 s90, s90, 16896
  s_cmp_eq_u32 s90, s49
  s_cselect_b32 s31, 67584, 0
  s_sub_u32 s90, s90, s31
  s_add_u32 m0, s48, 0
  s_add_u32 s51, s44, s45
  buffer_load_dwordx4 v251, s[32:35], s51 offen nt lds
  s_add_u32 m0, s48, 32
  s_nop 0
  buffer_load_dwordx4 v251, s[32:35], s51 offen offset:1024 nt lds
  s_xor_b32 s45, s45, s50
  s_cselect_b32 s31, 0, 8192
  s_add_u32 s44, s44, s31
  s_and_b32 s31, s44, s50
  s_add_u32 s44, s44, s31
  s_add_u32 s48, s48, 16896
  s_cmp_eq_u32 s48, s49
  s_cselect_b32 s31, 67584, 0
  s_sub_u32 s48, s48, s31
  s_sub_u32 s64, s64, 1
  s_cmp_lg_u32 s64, 0
  s_cbranch_scc1 L_lp_75
L_only_74:
  s_mov_b32 s62, 0
  s_mov_b32 s63, 32768
  s_mov_b32 s52, 0
  s_waitcnt vmcnt(8)
  s_cmp_lg_u32 s84, 0
  s_cbranch_scc1 L_vw_76
  s_waitcnt vmcnt(0)
L_vw_76:
  s_barrier
  s_add_u32 m0, s90, 8448
  s_add_u32 s51, s46, s47
  buffer_load_dwordx4 v251, s[36:39], s51 offen nt lds
  s_add_u32 m0, s90, 8480
  s_nop 0
  buffer_load_dwordx4 v251, s[36:39], s51 offen offset:1024 nt lds
  s_xor_b32 s47, s47, s50
  s_cselect_b32 s31, 0, 8192
  s_add_u32 s46, s46, s31
  s_and_b32 s31, s46, s50
  s_add_u32 s46, s46, s31
  s_add_u32 s90, s90, 16896
  s_cmp_eq_u32 s90, s49
  s_cselect_b32 s31, 67584, 0
  s_sub_u32 s90, s90, s31
  s_add_u32 m0, s48, 0
  s_add_u32 s51, s44, s45
  buffer_load_dwordx4 v251, s[32:35], s51 offen nt lds
  s_add_u32 m0, s48, 32
  s_nop 0
  buffer_load_dwordx4 v251, s[32:35], s51 offen offset:1024 nt lds
  s_xor_b32 s45, s45, s50
  s_cselect_b32 s31, 0, 8192
  s_add_u32 s44, s44, s31
  s_and_b32 s31, s44, s50
  s_add_u32 s44, s44, s31
  s_add_u32 s48, s48, 16896
  s_cmp_eq_u32 s48, s49
  s_cselect_b32 s31, 67584, 0
  s_sub_u32 s48, s48, s31
  s_lshl_b32 s67, s60, 7
  s_add_u32 m0, s62, s69
  s_add_u32 s67, s67, s61
  buffer_load_dwordx4 v244, s[72:75], s67 offen lds
  s_add_u32 m0, m0, 1024
  s_add_u32 s67, s67, 9216
  buffer_load_dwordx4 v244, s[72:75], s67 offen lds
  s_add_u32 m0, m0, 1024
  s_add_u32 s67, s67, 9216
  buffer_load_dwordx4 v244, s[72:75], s67 offen lds
  s_add_u32 m0, m0, 1024
  s_add_u32 s67, s67, 9216
  buffer_load_dwordx4 v244, s[72:75], s67 offen lds
  s_add_u32 m0, s62, s69
  s_add_u32 m0, m0, 4096
  s_add_u32 s67, s67, 9216
  buffer_load_dwordx4 v244, s[72:75], s67 offen lds
  s_add_u32 m0, m0, 1024
  s_add_u32 s67, s67, 9216
  buffer_load_dwordx4 v244, s[72:75], s67 offen lds
  s_add_u32 m0, m0, 1024
  s_add_u32 s67, s67, 9216
  buffer_load_dwordx4 v244, s[72:75], s67 offen lds
  s_add_u32 m0, m0, 1024
  s_add_u32 s67, s67, 9216
  buffer_load_dwordx4 v244, s[72:75], s67 offen lds
  s_add_u32 s60, s60, 1
  s_cmp_eq_u32 s60, 9
  s_cselect_b32 s60, 0, s60
  s_waitcnt vmcnt(16)
  s_cmp_lg_u32 s84, 0
  s_cbranch_scc1 L_vw_77
  s_waitcnt vmcnt(8)
L_vw_77:
  s_barrier
  s_add_u32 m0, s90, 8448
  s_add_u32 s51, s46, s47
  buffer_load_dwordx4 v251, s[36:39], s51 offen nt lds
  s_add_u32 m0, s90, 8480
  s_nop 0
  buffer_load_dwordx4 v251, s[36:39], s51 offen offset:1024 nt lds
  s_xor_b32 s47, s47, s50
  s_cselect_b32 s31, 0, 8192
  s_add_u32 s46, s46, s31
  s_and_b32 s31, s46, s50
  s_add_u32 s46, s46, s31
  s_add_u32 s90, s90, 16896
  s_cmp_eq_u32 s90, s49
  s_cselect_b32 s31, 67584, 0
  s_sub_u32 s90, s90, s31
  s_add_u32 m0, s48, 0
  s_add_u32 s51, s44, s45
  buffer_load_dwordx4 v251, s[32:35], s51 offen nt lds
  s_add_u32 m0, s48, 32
  s_nop 0
  buffer_load_dwordx4 v251, s[32:35], s51 offen offset:1024 nt lds
  s_xor_b32 s45, s45, s50
  s_cselect_b32 s31, 0, 8192
  s_add_u32 s44, s44, s31
  s_and_b32 s31, s44, s50
  s_add_u32 s44, s44, s31
  s_add_u32 s48, s48, 16896
  s_cmp_eq_u32 s48, s49
  s_cselect_b32 s31, 67584, 0
  s_sub_u32 s48, s48, s31
  s_cmp_lg_u32 s84, 1
  s_cbranch_scc1 L_only_78
  s_waitcnt vmcnt(16)
  s_barrier
  s_add_u32 m0, s90, 8448
  s_add_u32 s51, s46, s47
  buffer_load_dwordx4 v251, s[36:39], s51 offen nt lds
  s_add_u32 m0, s90, 8480
  s_nop 0
  buffer_load_dwordx4 v251, s[36:39], s51 offen offset:1024 nt lds
  s_xor_b32 s47, s47, s50
  s_cselect_b32 s31, 0, 8192
  s_add_u32 s46, s46, s31
  s_and_b32 s31, s46, s50
  s_add_u32 s46, s46, s31
  s_add_u32 s90, s90, 16896
  s_cmp_eq_u32 s90, s49
  s_cselect_b32 s31, 67584, 0
  s_sub_u32 s90, s90, s31
  s_add_u32 m0, s48, 0
  s_add_u32 s51, s44, s45
  buffer_load_dwordx4 v251, s[32:35], s51 offen nt lds
  s_add_u32 m0, s48, 32
  s_nop 0
  buffer_load_dwordx4 v251, s[32:35], s51 offen offset:1024 nt lds
  s_xor_b32 s45, s45, s50
  s_cselect_b32 s31, 0, 8192
  s_add_u32 s44, s44, s31
  s_and_b32 s31, s44, s50
  s_add_u32 s44, s44, s31
  s_add_u32 s48, s48, 16896
  s_cmp_eq_u32 s48, s49
  s_cselect_b32 s31, 67584, 0
  s_sub_u32 s48, s48, s31
L_only_78:
  s_mov_b32 s64, 8
L_lp_103:
  s_sub_u32 s62, 32768, s62
  s_waitcnt vmcnt(8)
  s_cmp_lg_u32 s84, 0
  s_cbranch_scc1 L_vw_104
  s_waitcnt vmcnt(0)
L_vw_104:
  s_barrier
  ds_read_b64_tr_b16 v[228:229], v245 offset:0
  ds_read_b64_tr_b16 v[230:231], v245 offset:2048
  ds_read_b64_tr_b16 v[232:233], v245 offset:4096
  ds_read_b64_tr_b16 v[234:235], v245 offset:6144
  ds_read_b64_tr_b16 v[236:237], v245 offset:8192
  ds_read_b64_tr_b16 v[238:239], v245 offset:10240
  ds_read_b64_tr_b16 v[240:241], v245 offset:12288
  ds_read_b64_tr_b16 v[242:243], v245 offset:14336
  s_add_u32 m0, s90, 8448
  s_add_u32 s51, s46, s47
  buffer_load_dwordx4 v251, s[36:39], s51 offen nt lds
  s_add_u32 m0, s90, 8480
  s_nop 0
  buffer_load_dwordx4 v251, s[36:39], s51 offen offset:1024 nt lds
  s_xor_b32 s47, s47, s50
  s_cselect_b32 s31, 0, 8192
  s_add_u32 s46, s46, s31
  s_and_b32 s31, s46, s50
  s_add_u32 s46, s46, s31
  s_add_u32 s90, s90, 16896
  s_cmp_eq_u32 s90, s49
  s_cselect_b32 s31, 67584, 0
  s_sub_u32 s90, s90, s31
  s_add_u32 m0, s48, 0
  s_add_u32 s51, s44, s45
  buffer_load_dwordx4 v251, s[32:35], s51 offen nt lds
  s_add_u32 m0, s48, 32
  s_nop 0
  buffer_load_dwordx4 v251, s[32:35], s51 offen offset:1024 nt lds
  s_xor_b32 s45, s45, s50
  s_cselect_b32 s31, 0, 8192
  s_add_u32 s44, s44, s31
  s_and_b32 s31, s44, s50
  s_add_u32 s44, s44, s31
  s_add_u32 s48, s48, 16896
  s_cmp_eq_u32 s48, s49
  s_cselect_b32 s31, 67584, 0
  s_sub_u32 s48, s48, s31
  s_waitcnt lgkmcnt(6)
  v_mfma_f32_16x16x32_bf16 v[204:207], v[228:231], v[0:3], 0
  s_lshl_b32 s67, s60, 7
  s_add_u32 m0, s62, s69
  s_add_u32 s67, s67, s61
  buffer_load_dwordx4 v244, s[72:75], s67 offen lds
  v_mfma_f32_16x16x32_bf16 v[208:211], v[228:231], v[32:35], 0
  s_add_u32 m0, m0, 1024
  s_add_u32 s67, s67, 9216
  buffer_load_dwordx4 v244, s[72:75], s67 offen lds
  v_mfma_f32_16x16x32_bf16 v[212:215], v[228:231], v[64:67], 0
  ds_read_b64_tr_b16 v[228:229], v245 offset:16384
  s_add_u32 m0, m0, 1024
  s_add_u32 s67, s67, 9216
  buffer_load_dwordx4 v244, s[72:75], s67 offen lds
  s_waitcnt lgkmcnt(5)
  v_mfma_f32_16x16x32_bf16 v[204:207], v[232:235], v[4:7], v[204:207]
  ds_read_b64_tr_b16 v[230:231], v245 offset:18432
  s_add_u32 m0, m0, 1024
  s_add_u32 s67, s67, 9216
  buffer_load_dwordx4 v244, s[72:75], s67 offen lds
  v_mfma_f32_16x16x32_bf16 v[208:211], v[232:235], v[36:39], v[208:211]
  s_add_u32 m0, s62, s69
  s_add_u32 m0, m0, 4096
  s_add_u32 s67, s67, 9216
  buffer_load_dwordx4 v244, s[72:75], s67 offen lds
  v_mfma_f32_16x16x32_bf16 v[212:215], v[232:235], v[68:71], v[212:215]
  ds_read_b64_tr_b16 v[232:233], v245 offset:20480
  s_add_u32 m0, m0, 1024
  s_add_u32 s67, s67, 9216
  buffer_load_dwordx4 v244, s[72:75], s67 offen lds
  s_waitcnt lgkmcnt(5)
  v_mfma_f32_16x16x32_bf16 v[204:207], v[236:239], v[8:11], v[204:207]
  ds_read_b64_tr_b16 v[234:235], v245 offset:22528
  s_add_u32 m0, m0, 1024
  s_add_u32 s67, s67, 9216
  buffer_load_dwordx4 v244, s[72:75], s67 offen lds
  v_mfma_f32_16x16x32_bf16 v[208:211], v[236:239], v[40:43], v[208:211]
  s_add_u32 m0, m0, 1024
  s_add_u32 s67, s67, 9216
  buffer_load_dwordx4 v244, s[72:75], s67 offen lds
  s_add_u32 s60, s60, 1
  s_cmp_eq_u32 s60, 9
  s_cselect_b32 s60, 0, s60
  v_mfma_f32_16x16x32_bf16 v[212:215], v[236:239], v[72:75], v[212:215]
  ds_read_b64_tr_b16 v[236:237], v245 offset:24576
  s_waitcnt lgkmcnt(5)
  v_mfma_f32_16x16x32_bf16 v[204:207], v[240:243], v[12:15], v[204:207]
  ds_read_b64_tr_b16 v[238:239], v245 offset:26624
  v_mfma_f32_16x16x32_bf16 v[208:211], v[240:243], v[44:47], v[208:211]
  v_mfma_f32_16x16x32_bf16 v[212:215], v[240:243], v[76:79], v[212:215]
  ds_read_b64_tr_b16 v[240:241], v245 offset:28672
  s_waitcnt lgkmcnt(5)
  v_mfma_f32_16x16x32_bf16 v[204:207], v[228:231], v[16:19], v[204:207]
  ds_read_b64_tr_b16 v[242:243], v245 offset:30720
  v_mfma_f32_16x16x32_bf16 v[208:211], v[228:231], v[48:51], v[208:211]
  v_mfma_f32_16x16x32_bf16 v[212:215], v[228:231], v[80:83], v[212:215]
  ds_read_b64_tr_b16 v[228:229], v253 offset:0
  s_waitcnt lgkmcnt(5)
  v_mfma_f32_16x16x32_bf16 v[204:207], v[232:235], v[20:23], v[204:207]
  ds_read_b64_tr_b16 v[230:231], v253 offset:2048
  v_mfma_f32_16x16x32_bf16 v[208:211], v[232:235], v[52:55], v[208:211]
  v_mfma_f32_16x16x32_bf16 v[212:215], v[232:235], v[84:87], v[212:215]
  ds_read_b64_tr_b16 v[232:233], v253 offset:4096
  s_waitcnt lgkmcnt(5)
  v_mfma_f32_16x16x32_bf16 v[204:207], v[236:239], v[24:27], v[204:207]
  ds_read_b64_tr_b16 v[234:235], v253 offset:6144
  v_mfma_f32_16x16x32_bf16 v[208:211], v[236:239], v[56:59], v[208:211]
  v_mfma_f32_16x16x32_bf16 v[212:215], v[236:239], v[88:91], v[212:215]
  ds_read_b64_tr_b16 v[236:237], v253 offset:8192
  s_waitcnt lgkmcnt(5)
  v_mfma_f32_16x16x32_bf16 v[204:207], v[240:243], v[28:31], v[204:207]
  ds_read_b64_tr_b16 v[238:239], v253 offset:10240
  v_mfma_f32_16x16x32_bf16 v[208:211], v[240:243], v[60:63], v[208:211]
  v_mfma_f32_16x16x32_bf16 v[212:215], v[240:243], v[92:95], v[212:215]
  ds_read_b64_tr_b16 v[240:241], v253 offset:12288
  s_cmp_lg_u32 s84, 1
  s_cbranch_scc1 L_only_105
  s_waitcnt vmcnt(16)
  s_barrier
  s_add_u32 m0, s90, 8448
  s_add_u32 s51, s46, s47
  buffer_load_dwordx4 v251, s[36:39], s51 offen nt lds
  s_add_u32 m0, s90, 8480
  s_nop 0
  buffer_load_dwordx4 v251, s[36:39], s51 offen offset:1024 nt lds
  s_xor_b32 s47, s47, s50
  s_cselect_b32 s31, 0, 8192
  s_add_u32 s46, s46, s31
  s_and_b32 s31, s46, s50
  s_add_u32 s46, s46, s31
  s_add_u32 s90, s90, 16896
  s_cmp_eq_u32 s90, s49
  s_cselect_b32 s31, 67584, 0
  s_sub_u32 s90, s90, s31
  s_add_u32 m0, s48, 0
  s_add_u32 s51, s44, s45
  buffer_load_dwordx4 v251, s[32:35], s51 offen nt lds
  s_add_u32 m0, s48, 32
  s_nop 0
  buffer_load_dwordx4 v251, s[32:35], s51 offen offset:1024 nt lds
  s_xor_b32 s45, s45, s50
  s_cselect_b32 s31, 0, 8192
  s_add_u32 s44, s44, s31
  s_and_b32 s31, s44, s50
  s_add_u32 s44, s44, s31
  s_add_u32 s48, s48, 16896
  s_cmp_eq_u32 s48, s49
  s_cselect_b32 s31, 67584, 0
  s_sub_u32 s48, s48, s31
L_only_105:
  s_cmp_lg_u32 s84, 1
  s_cbranch_scc1 L_only_106
  s_waitcnt vmcnt(16)
  s_barrier
  s_add_u32 m0, s90, 8448
  s_add_u32 s51, s46, s47
  buffer_load_dwordx4 v251, s[36:39], s51 offen nt lds
  s_add_u32 m0, s90, 8480
  s_nop 0
  buffer_load_dwordx4 v251, s[36:39], s51 offen offset:1024 nt lds
  s_xor_b32 s47, s47, s50
  s_cselect_b32 s31, 0, 8192
  s_add_u32 s46, s46, s31
  s_and_b32 s31, s46, s50
  s_add_u32 s46, s46, s31
  s_add_u32 s90, s90, 16896
  s_cmp_eq_u32 s90, s49
  s_cselect_b32 s31, 67584, 0
  s_sub_u32 s90, s90, s31
  s_add_u32 m0, s48, 0
  s_add_u32 s51, s44, s45
  buffer_load_dwordx4 v251, s[32:35], s51 offen nt lds
  s_add_u32 m0, s48, 32
  s_nop 0
  buffer_load_dwordx4 v251, s[32:35], s51 offen offset:1024 nt lds
  s_xor_b32 s45, s45, s50
  s_cselect_b32 s31, 0, 8192
  s_add_u32 s44, s44, s31
  s_and_b32 s31, s44, s50
  s_add_u32 s44, s44, s31
  s_add_u32 s48, s48, 16896
  s_cmp_eq_u32 s48, s49
  s_cselect_b32 s31, 67584, 0
  s_sub_u32 s48, s48, s31
L_only_106:
  s_waitcnt vmcnt(16)
  s_cmp_lg_u32 s84, 0
  s_cbranch_scc1 L_vw_107
  s_waitcnt vmcnt(8)
L_vw_107:
  s_barrier
  s_add_u32 m0, s90, 8448
  s_add_u32 s51, s46, s47
  buffer_load_dwordx4 v251, s[36:39], s51 offen nt lds
  s_add_u32 m0, s90, 8480
  s_nop 0
  buffer_load_dwordx4 v251, s[36:39], s51 offen offset:1024 nt lds
  s_xor_b32 s47, s47, s50
  s_cselect_b32 s31, 0, 8192
  s_add_u32 s46, s46, s31
  s_and_b32 s31, s46, s50
  s_add_u32 s46, s46, s31
  s_add_u32 s90, s90, 16896
  s_cmp_eq_u32 s90, s49
  s_cselect_b32 s31, 67584, 0
  s_sub_u32 s90, s90, s31
  s_add_u32 m0, s48, 0
  s_add_u32 s51, s44, s45
  buffer_load_dwordx4 v251, s[32:35], s51 offen nt lds
  s_add_u32 m0, s48, 32
  s_nop 0
  buffer_load_dwordx4 v251, s[32:35], s51 offen offset:1024 nt lds
  s_xor_b32 s45, s45, s50
  s_cselect_b32 s31, 0, 8192
  s_add_u32 s44, s44, s31
  s_and_b32 s31, s44, s50
  s_add_u32 s44, s44, s31
  s_add_u32 s48, s48, 16896
  s_cmp_eq_u32 s48, s49
  s_cselect_b32 s31, 67584, 0
  s_sub_u32 s48, s48, s31
  s_waitcnt lgkmcnt(5)
  v_mfma_f32_16x16x32_bf16 v[216:219], v[228:231], v[0:3], 0
  ds_read_b64_tr_b16 v[242:243], v253 offset:14336
  v_mfma_f32_16x16x32_bf16 v[220:223], v[228:231], v[32:35], 0
  v_mfma_f32_16x16x32_bf16 v[224:227], v[228:231], v[64:67], 0
  ds_read_b64_tr_b16 v[228:229], v253 offset:16384
  s_waitcnt lgkmcnt(5)
  v_mfma_f32_16x16x32_bf16 v[216:219], v[232:235], v[4:7], v[216:219]
  ds_read_b64_tr_b16 v[230:231], v253 offset:18432
  v_mfma_f32_16x16x32_bf16 v[220:223], v[232:235], v[36:39], v[220:223]
  v_mfma_f32_16x16x32_bf16 v[224:227], v[232:235], v[68:71], v[224:227]
  ds_read_b64_tr_b16 v[232:233], v253 offset:20480
  s_waitcnt lgkmcnt(5)
  v_mfma_f32_16x16x32_bf16 v[216:219], v[236:239], v[8:11], v[216:219]
  ds_read_b64_tr_b16 v[234:235], v253 offset:22528
  v_mfma_f32_16x16x32_bf16 v[220:223], v[236:239], v[40:43], v[220:223]
  v_mfma_f32_16x16x32_bf16 v[224:227], v[236:239], v[72:75], v[224:227]
  ds_read_b64_tr_b16 v[236:237], v253 offset:24576
  s_waitcnt lgkmcnt(5)
  v_mfma_f32_16x16x32_bf16 v[216:219], v[240:243], v[12:15], v[216:219]
  ds_read_b64_tr_b16 v[238:239], v253 offset:26624
  v_mfma_f32_16x16x32_bf16 v[220:223], v[240:243], v[44:47], v[220:223]
  v_mfma_f32_16x16x32_bf16 v[224:227], v[240:243], v[76:79], v[224:227]
  ds_read_b64_tr_b16 v[240:241], v253 offset:28672
  s_cmp_lg_u32 s84, 1
  s_cbranch_scc1 L_only_108
  s_waitcnt vmcnt(8)
  s_barrier
  s_add_u32 m0, s90, 8448
  s_add_u32 s51, s46, s47
  buffer_load_dwordx4 v251, s[36:39], s51 offen nt lds
  s_add_u32 m0, s90, 8480
  s_nop 0
  buffer_load_dwordx4 v251, s[36:39], s51 offen offset:1024 nt lds
  s_xor_b32 s47, s47, s50
  s_cselect_b32 s31, 0, 8192
  s_add_u32 s46, s46, s31
  s_and_b32 s31, s46, s50
  s_add_u32 s46, s46, s31
  s_add_u32 s90, s90, 16896
  s_cmp_eq_u32 s90, s49
  s_cselect_b32 s31, 67584, 0
  s_sub_u32 s90, s90, s31
  s_add_u32 m0, s48, 0
  s_add_u32 s51, s44, s45
  buffer_load_dwordx4 v251, s[32:35], s51 offen nt lds
  s_add_u32 m0, s48, 32
  s_nop 0
  buffer_load_dwordx4 v251, s[32:35], s51 offen offset:1024 nt lds
  s_xor_b32 s45, s45, s50
  s_cselect_b32 s31, 0, 8192
  s_add_u32 s44, s44, s31
  s_and_b32 s31, s44, s50
  s_add_u32 s44, s44, s31
  s_add_u32 s48, s48, 16896
  s_cmp_eq_u32 s48, s49
  s_cselect_b32 s31, 67584, 0
  s_sub_u32 s48, s48, s31
L_only_108:
  s_waitcnt lgkmcnt(5)
  v_mfma_f32_16x16x32_bf16 v[216:219], v[228:231], v[16:19], v[216:219]
  ds_read_b64_tr_b16 v[242:243], v253 offset:30720
  v_mfma_f32_16x16x32_bf16 v[220:223], v[228:231], v[48:51], v[220:223]
  v_mfma_f32_16x16x32_bf16 v[224:227], v[228:231], v[80:83], v[224:227]
  s_waitcnt lgkmcnt(4)
  v_mfma_f32_16x16x32_bf16 v[216:219], v[232:235], v[20:23], v[216:219]
  v_mfma_f32_16x16x32_bf16 v[220:223], v[232:235], v[52:55], v[220:223]
  v_mfma_f32_16x16x32_bf16 v[224:227], v[232:235], v[84:87], v[224:227]
  s_waitcnt lgkmcnt(2)
  v_mfma_f32_16x16x32_bf16 v[216:219], v[236:239], v[24:27], v[216:219]
  v_mfma_f32_16x16x32_bf16 v[220:223], v[236:239], v[56:59], v[220:223]
  v_mfma_f32_16x16x32_bf16 v[224:227], v[236:239], v[88:91], v[224:227]
  s_waitcnt lgkmcnt(0)
  v_mfma_f32_16x16x32_bf16 v[216:219], v[240:243], v[28:31], v[216:219]
  v_mfma_f32_16x16x32_bf16 v[220:223], v[240:243], v[60:63], v[220:223]
  v_mfma_f32_16x16x32_bf16 v[224:227], v[240:243], v[92:95], v[224:227]
  v_add_u32 v245, s63, v245
  v_add_u32 v253, s63, v253
  s_sub_u32 s63, 0, s63
  s_set_gpr_idx_on s52, gpr_idx(DST)
  v_cvt_pk_bf16_f32 v96, v204, v205
  v_cvt_pk_bf16_f32 v97, v206, v207
  v_cvt_pk_bf16_f32 v100, v208, v209
  v_cvt_pk_bf16_f32 v101, v210, v211
  v_cvt_pk_bf16_f32 v104, v212, v213
  v_cvt_pk_bf16_f32 v105, v214, v215
  v_cvt_pk_bf16_f32 v98, v216, v217
  v_cvt_pk_bf16_f32 v99, v218, v219
  v_cvt_pk_bf16_f32 v102, v220, v221
  v_cvt_pk_bf16_f32 v103, v222, v223
  v_cvt_pk_bf16_f32 v106, v224, v225
  v_cvt_pk_bf16_f32 v107, v226, v227
  s_set_gpr_idx_off
  s_add_u32 s52, s52, 12
  s_sub_u32 s64, s64, 1
  s_cmp_lg_u32 s64, 0
  s_cbranch_scc1 L_lp_103
  s_sub_u32 s62, 32768, s62
  s_waitcnt vmcnt(8)
  s_cmp_lg_u32 s84, 0
  s_cbranch_scc1 L_vw_130
  s_waitcnt vmcnt(0)
L_vw_130:
  s_barrier
  ds_read_b64_tr_b16 v[228:229], v245 offset:0
  ds_read_b64_tr_b16 v[230:231], v245 offset:2048
  ds_read_b64_tr_b16 v[232:233], v245 offset:4096
  ds_read_b64_tr_b16 v[234:235], v245 offset:6144
  ds_read_b64_tr_b16 v[236:237], v245 offset:8192
  ds_read_b64_tr_b16 v[238:239], v245 offset:10240
  ds_read_b64_tr_b16 v[240:241], v245 offset:12288
  ds_read_b64_tr_b16 v[242:243], v245 offset:14336
  s_add_u32 m0, s90, 8448
  s_add_u32 s51, s46, s47
  buffer_load_dwordx4 v251, s[36:39], s51 offen nt lds
  s_add_u32 m0, s90, 8480
  s_nop 0
  buffer_load_dwordx4 v251, s[36:39], s51 offen offset:1024 nt lds
  s_xor_b32 s47, s47, s50
  s_cselect_b32 s31, 0, 8192
  s_add_u32 s46, s46, s31
  s_and_b32 s31, s46, s50
  s_add_u32 s46, s46, s31
  s_add_u32 s90, s90, 16896
  s_cmp_eq_u32 s90, s49
  s_cselect_b32 s31, 67584, 0
  s_sub_u32 s90, s90, s31
  s_add_u32 m0, s48, 0
  s_add_u32 s51, s44, s45
  buffer_load_dwordx4 v251, s[32:35], s51 offen nt lds
  s_add_u32 m0, s48, 32
  s_nop 0
  buffer_load_dwordx4 v251, s[32:35], s51 offen offset:1024 nt lds
  s_xor_b32 s45, s45, s50
  s_cselect_b32 s31, 0, 8192
  s_add_u32 s44, s44, s31
  s_and_b32 s31, s44, s50
  s_add_u32 s44, s44, s31
  s_add_u32 s48, s48, 16896
  s_cmp_eq_u32 s48, s49
  s_cselect_b32 s31, 67584, 0
  s_sub_u32 s48, s48, s31
  s_waitcnt lgkmcnt(6)
  v_mfma_f32_16x16x32_bf16 v[204:207], v[228:231], v[0:3], 0
  v_mfma_f32_16x16x32_bf16 v[208:211], v[228:231], v[32:35], 0
  v_mfma_f32_16x16x32_bf16 v[212:215], v[228:231], v[64:67], 0
  ds_read_b64_tr_b16 v[228:229], v245 offset:16384
  s_waitcnt lgkmcnt(5)
  v_mfma_f32_16x16x32_bf16 v[204:207], v[232:235], v[4:7], v[204:207]
  ds_read_b64_tr_b16 v[230:231], v245 offset:18432
  v_mfma_f32_16x16x32_bf16 v[208:211], v[232:235], v[36:39], v[208:211]
  v_mfma_f32_16x16x32_bf16 v[212:215], v[232:235], v[68:71], v[212:215]
  ds_read_b64_tr_b16 v[232:233], v245 offset:20480
  s_waitcnt lgkmcnt(5)
  v_mfma_f32_16x16x32_bf16 v[204:207], v[236:239], v[8:11], v[204:207]
  ds_read_b64_tr_b16 v[234:235], v245 offset:22528
  v_mfma_f32_16x16x32_bf16 v[208:211], v[236:239], v[40:43], v[208:211]
  v_mfma_f32_16x16x32_bf16 v[212:215], v[236:239], v[72:75], v[212:215]
  ds_read_b64_tr_b16 v[236:237], v245 offset:24576
  s_waitcnt lgkmcnt(5)
  v_mfma_f32_16x16x32_bf16 v[204:207], v[240:243], v[12:15], v[204:207]
  ds_read_b64_tr_b16 v[238:239], v245 offset:26624
  v_mfma_f32_16x16x32_bf16 v[208:211], v[240:243], v[44:47], v[208:211]
  v_mfma_f32_16x16x32_bf16 v[212:215], v[240:243], v[76:79], v[212:215]
  ds_read_b64_tr_b16 v[240:241], v245 offset:28672
  s_waitcnt lgkmcnt(5)
  v_mfma_f32_16x16x32_bf16 v[204:207], v[228:231], v[16:19], v[204:207]
  ds_read_b64_tr_b16 v[242:243], v245 offset:30720
  v_mfma_f32_16x16x32_bf16 v[208:211], v[228:231], v[48:51], v[208:211]
  v_mfma_f32_16x16x32_bf16 v[212:215], v[228:231], v[80:83], v[212:215]
  ds_read_b64_tr_b16 v[228:229], v253 offset:0
  s_waitcnt lgkmcnt(5)
  v_mfma_f32_16x16x32_bf16 v[204:207], v[232:235], v[20:23], v[204:207]
  ds_read_b64_tr_b16 v[230:231], v253 offset:2048
  v_mfma_f32_16x16x32_bf16 v[208:211], v[232:235], v[52:55], v[208:211]
  v_mfma_f32_16x16x32_bf16 v[212:215], v[232:235], v[84:87], v[212:215]
  ds_read_b64_tr_b16 v[232:233], v253 offset:4096
  s_waitcnt lgkmcnt(5)
  v_mfma_f32_16x16x32_bf16 v[204:207], v[236:239], v[24:27], v[204:207]
  ds_read_b64_tr_b16 v[234:235], v253 offset:6144
  v_mfma_f32_16x16x32_bf16 v[208:211], v[236:239], v[56:59], v[208:211]
  v_mfma_f32_16x16x32_bf16 v[212:215], v[236:239], v[88:91], v[212:215]
  ds_read_b64_tr_b16 v[236:237], v253 offset:8192
  s_waitcnt lgkmcnt(5)
  v_mfma_f32_16x16x32_bf16 v[204:207], v[240:243], v[28:31], v[204:207]
  ds_read_b64_tr_b16 v[238:239], v253 offset:10240
  v_mfma_f32_16x16x32_bf16 v[208:211], v[240:243], v[60:63], v[208:211]
  v_mfma_f32_16x16x32_bf16 v[212:215], v[240:243], v[92:95], v[212:215]
  ds_read_b64_tr_b16 v[240:241], v253 offset:12288
  s_cmp_lg_u32 s84, 1
  s_cbranch_scc1 L_only_131
  s_waitcnt vmcnt(8)
  s_barrier
  s_add_u32 m0, s90, 8448
  s_add_u32 s51, s46, s47
  buffer_load_dwordx4 v251, s[36:39], s51 offen nt lds
  s_add_u32 m0, s90, 8480
  s_nop 0
  buffer_load_dwordx4 v251, s[36:39], s51 offen offset:1024 nt lds
  s_xor_b32 s47, s47, s50
  s_cselect_b32 s31, 0, 8192
  s_add_u32 s46, s46, s31
  s_and_b32 s31, s46, s50
  s_add_u32 s46, s46, s31
  s_add_u32 s90, s90, 16896
  s_cmp_eq_u32 s90, s49
  s_cselect_b32 s31, 67584, 0
  s_sub_u32 s90, s90, s31
  s_add_u32 m0, s48, 0
  s_add_u32 s51, s44, s45
  buffer_load_dwordx4 v251, s[32:35], s51 offen nt lds
  s_add_u32 m0, s48, 32
  s_nop 0
  buffer_load_dwordx4 v251, s[32:35], s51 offen offset:1024 nt lds
  s_xor_b32 s45, s45, s50
  s_cselect_b32 s31, 0, 8192
  s_add_u32 s44, s44, s31
  s_and_b32 s31, s44, s50
  s_add_u32 s44, s44, s31
  s_add_u32 s48, s48, 16896
  s_cmp_eq_u32 s48, s49
  s_cselect_b32 s31, 67584, 0
  s_sub_u32 s48, s48, s31
L_only_131:
  s_cmp_lg_u32 s84, 1
  s_cbranch_scc1 L_only_132
  s_waitcnt vmcnt(8)
  s_barrier
  s_add_u32 m0, s90, 8448
  s_add_u32 s51, s46, s47
  buffer_load_dwordx4 v251, s[36:39], s51 offen nt lds
  s_add_u32 m0, s90, 8480
  s_nop 0
  buffer_load_dwordx4 v251, s[36:39], s51 offen offset:1024 nt lds
  s_xor_b32 s47, s47, s50
  s_cselect_b32 s31, 0, 8192
  s_add_u32 s46, s46, s31
  s_and_b32 s31, s46, s50
  s_add_u32 s46, s46, s31
  s_add_u32 s90, s90, 16896
  s_cmp_eq_u32 s90, s49
  s_cselect_b32 s31, 67584, 0
  s_sub_u32 s90, s90, s31
  s_add_u32 m0, s48, 0
  s_add_u32 s51, s44, s45
  buffer_load_dwordx4 v251, s[32:35], s51 offen nt lds
  s_add_u32 m0, s48, 32
  s_nop 0
  buffer_load_dwordx4 v251, s[32:35], s51 offen offset:1024 nt lds
  s_xor_b32 s45, s45, s50
  s_cselect_b32 s31, 0, 8192
  s_add_u32 s44, s44, s31
  s_and_b32 s31, s44, s50
  s_add_u32 s44, s44, s31
  s_add_u32 s48, s48, 16896
  s_cmp_eq_u32 s48, s49
  s_cselect_b32 s31, 67584, 0
  s_sub_u32 s48, s48, s31
L_only_132:
  s_waitcnt vmcnt(8)
  s_cmp_lg_u32 s84, 0
  s_cbranch_scc1 L_vw_133
  s_waitcnt vmcnt(0)
L_vw_133:
  s_barrier
  s_add_u32 m0, s90, 8448
  s_add_u32 s51, s46, s47
  buffer_load_dwordx4 v251, s[36:39], s51 offen nt lds
  s_add_u32 m0, s90, 8480
  s_nop 0
  buffer_load_dwordx4 v251, s[36:39], s51 offen offset:1024 nt lds
  s_xor_b32 s47, s47, s50
  s_cselect_b32 s31, 0, 8192
  s_add_u32 s46, s46, s31
  s_and_b32 s31, s46, s50
  s_add_u32 s46, s46, s31
  s_add_u32 s90, s90, 16896
  s_cmp_eq_u32 s90, s49
  s_cselect_b32 s31, 67584, 0
  s_sub_u32 s90, s90, s31
  s_add_u32 m0, s48, 0
  s_add_u32 s51, s44, s45
  buffer_load_dwordx4 v251, s[32:35], s51 offen nt lds
  s_add_u32 m0, s48, 32
  s_nop 0
  buffer_load_dwordx4 v251, s[32:35], s51 offen offset:1024 nt lds
  s_xor_b32 s45, s45, s50
  s_cselect_b32 s31, 0, 8192
  s_add_u32 s44, s44, s31
  s_and_b32 s31, s44, s50
  s_add_u32 s44, s44, s31
  s_add_u32 s48, s48, 16896
  s_cmp_eq_u32 s48, s49
  s_cselect_b32 s31, 67584, 0
  s_sub_u32 s48, s48, s31
  s_waitcnt lgkmcnt(5)
  v_mfma_f32_16x16x32_bf16 v[216:219], v[228:231], v[0:3], 0
  ds_read_b64_tr_b16 v[242:243], v253 offset:14336
  v_mfma_f32_16x16x32_bf16 v[220:223], v[228:231], v[32:35], 0
  v_mfma_f32_16x16x32_bf16 v[224:227], v[228:231], v[64:67], 0
  ds_read_b64_tr_b16 v[228:229], v253 offset:16384
  s_waitcnt lgkmcnt(5)
  v_mfma_f32_16x16x32_bf16 v[216:219], v[232:235], v[4:7], v[216:219]
  ds_read_b64_tr_b16 v[230:231], v253 offset:18432
  v_mfma_f32_16x16x32_bf16 v[220:223], v[232:235], v[36:39], v[220:223]
  v_mfma_f32_16x16x32_bf16 v[224:227], v[232:235], v[68:71], v[224:227]
  ds_read_b64_tr_b16 v[232:233], v253 offset:20480
  s_waitcnt lgkmcnt(5)
  v_mfma_f32_16x16x32_bf16 v[216:219], v[236:239], v[8:11], v[216:219]
  ds_read_b64_tr_b16 v[234:235], v253 offset:22528
  v_mfma_f32_16x16x32_bf16 v[220:223], v[236:239], v[40:43], v[220:223]
  v_mfma_f32_16x16x32_bf16 v[224:227], v[236:239], v[72:75], v[224:227]
  ds_read_b64_tr_b16 v[236:237], v253 offset:24576
  s_waitcnt lgkmcnt(5)
  v_mfma_f32_16x16x32_bf16 v[216:219], v[240:243], v[12:15], v[216:219]
  ds_read_b64_tr_b16 v[238:239], v253 offset:26624
  v_mfma_f32_16x16x32_bf16 v[220:223], v[240:243], v[44:47], v[220:223]
  v_mfma_f32_16x16x32_bf16 v[224:227], v[240:243], v[76:79], v[224:227]
  ds_read_b64_tr_b16 v[240:241], v253 offset:28672
  s_cmp_lg_u32 s84, 1
  s_cbranch_scc1 L_only_134
  s_waitcnt vmcnt(8)
  s_barrier
  s_add_u32 m0, s90, 8448
  s_add_u32 s51, s46, s47
  buffer_load_dwordx4 v251, s[36:39], s51 offen nt lds
  s_add_u32 m0, s90, 8480
  s_nop 0
  buffer_load_dwordx4 v251, s[36:39], s51 offen offset:1024 nt lds
  s_xor_b32 s47, s47, s50
  s_cselect_b32 s31, 0, 8192
  s_add_u32 s46, s46, s31
  s_and_b32 s31, s46, s50
  s_add_u32 s46, s46, s31
  s_add_u32 s90, s90, 16896
  s_cmp_eq_u32 s90, s49
  s_cselect_b32 s31, 67584, 0
  s_sub_u32 s90, s90, s31
  s_add_u32 m0, s48, 0
  s_add_u32 s51, s44, s45
  buffer_load_dwordx4 v251, s[32:35], s51 offen nt lds
  s_add_u32 m0, s48, 32
  s_nop 0
  buffer_load_dwordx4 v251, s[32:35], s51 offen offset:1024 nt lds
  s_xor_b32 s45, s45, s50
  s_cselect_b32 s31, 0, 8192
  s_add_u32 s44, s44, s31
  s_and_b32 s31, s44, s50
  s_add_u32 s44, s44, s31
  s_add_u32 s48, s48, 16896
  s_cmp_eq_u32 s48, s49
  s_cselect_b32 s31, 67584, 0
  s_sub_u32 s48, s48, s31
L_only_134:
  s_waitcnt lgkmcnt(5)
  v_mfma_f32_16x16x32_bf16 v[216:219], v[228:231], v[16:19], v[216:219]
  ds_read_b64_tr_b16 v[242:243], v253 offset:30720
  v_mfma_f32_16x16x32_bf16 v[220:223], v[228:231], v[48:51], v[220:223]
  v_mfma_f32_16x16x32_bf16 v[224:227], v[228:231], v[80:83], v[224:227]
  s_waitcnt lgkmcnt(4)
  v_mfma_f32_16x16x32_bf16 v[216:219], v[232:235], v[20:23], v[216:219]
  v_mfma_f32_16x16x32_bf16 v[220:223], v[232:235], v[52:55], v[220:223]
  v_mfma_f32_16x16x32_bf16 v[224:227], v[232:235], v[84:87], v[224:227]
  s_waitcnt lgkmcnt(2)
  v_mfma_f32_16x16x32_bf16 v[216:219], v[236:239], v[24:27], v[216:219]
  v_mfma_f32_16x16x32_bf16 v[220:223], v[236:239], v[56:59], v[220:223]
  v_mfma_f32_16x16x32_bf16 v[224:227], v[236:239], v[88:91], v[224:227]
  s_waitcnt lgkmcnt(0)
  v_mfma_f32_16x16x32_bf16 v[216:219], v[240:243], v[28:31], v[216:219]
  v_mfma_f32_16x16x32_bf16 v[220:223], v[240:243], v[60:63], v[220:223]
  v_mfma_f32_16x16x32_bf16 v[224:227], v[240:243], v[92:95], v[224:227]
  v_add_u32 v245, s63, v245
  v_add_u32 v253, s63, v253
  s_sub_u32 s63, 0, s63
  s_set_gpr_idx_on s52, gpr_idx(DST)
  v_cvt_pk_bf16_f32 v96, v204, v205
  v_cvt_pk_bf16_f32 v97, v206, v207
  v_cvt_pk_bf16_f32 v100, v208, v209
  v_cvt_pk_bf16_f32 v101, v210, v211
  v_cvt_pk_bf16_f32 v104, v212, v213
  v_cvt_pk_bf16_f32 v105, v214, v215
  v_cvt_pk_bf16_f32 v98, v216, v217
  v_cvt_pk_bf16_f32 v99, v218, v219
  v_cvt_pk_bf16_f32 v102, v220, v221
  v_cvt_pk_bf16_f32 v103, v222, v223
  v_cvt_pk_bf16_f32 v106, v224, v225
  v_cvt_pk_bf16_f32 v107, v226, v227
  s_set_gpr_idx_off
  s_add_u32 s52, s52, 12
  v_add_u32 v245, 28672, v245
  v_add_u32 v253, 28672, v253
  v_lshlrev_b32 v204, 16, v96
  v_and_b32 v205, 0xffff0000, v96
  v_lshlrev_b32 v206, 16, v97
  v_and_b32 v207, 0xffff0000, v97
  v_lshlrev_b32 v208, 16, v100
  v_and_b32 v209, 0xffff0000, v100
  v_lshlrev_b32 v210, 16, v101
  v_and_b32 v211, 0xffff0000, v101
  v_lshlrev_b32 v212, 16, v104
  v_and_b32 v213, 0xffff0000, v104
  v_lshlrev_b32 v214, 16, v105
  v_and_b32 v215, 0xffff0000, v105
  v_lshlrev_b32 v216, 16, v98
  v_and_b32 v217, 0xffff0000, v98
  v_lshlrev_b32 v218, 16, v99
  v_and_b32 v219, 0xffff0000, v99
  v_lshlrev_b32 v220, 16, v102
  v_and_b32 v221, 0xffff0000, v102
  v_lshlrev_b32 v222, 16, v103
  v_and_b32 v223, 0xffff0000, v103
  v_lshlrev_b32 v224, 16, v106
  v_and_b32 v225, 0xffff0000, v106
  v_lshlrev_b32 v226, 16, v107
  v_and_b32 v227, 0xffff0000, v107
  s_cmp_lg_u32 s84, 0
  s_cbranch_scc1 L_only_135
  s_add_u32 m0, s90, 8448
  s_add_u32 s51, s46, s47
  buffer_load_dwordx4 v251, s[36:39], s51 offen nt lds
  s_add_u32 m0, s90, 8480
  s_nop 0
  buffer_load_dwordx4 v251, s[36:39], s51 offen offset:1024 nt lds
  s_xor_b32 s47, s47, s50
  s_cselect_b32 s31, 0, 8192
  s_add_u32 s46, s46, s31
  s_and_b32 s31, s46, s50
  s_add_u32 s46, s46, s31
  s_add_u32 s90, s90, 16896
  s_cmp_eq_u32 s90, s49
  s_cselect_b32 s31, 67584, 0
  s_sub_u32 s90, s90, s31
  s_add_u32 m0, s48, 0
  s_add_u32 s51, s44, s45
  buffer_load_dwordx4 v251, s[32:35], s51 offen nt lds
  s_add_u32 m0, s48, 32
  s_nop 0
  buffer_load_dwordx4 v251, s[32:35], s51 offen offset:1024 nt lds
  s_xor_b32 s45, s45, s50
  s_cselect_b32 s31, 0, 8192
  s_add_u32 s44, s44, s31
  s_and_b32 s31, s44, s50
  s_add_u32 s44, s44, s31
  s_add_u32 s48, s48, 16896
  s_cmp_eq_u32 s48, s49
  s_cselect_b32 s31, 67584, 0
  s_sub_u32 s48, s48, s31
L_only_135:
  s_mov_b32 s64, 7
L_lp_136:
  s_waitcnt vmcnt(8)
  s_cmp_lg_u32 s84, 0
  s_cbranch_scc1 L_vw_137
  s_waitcnt vmcnt(4)
L_vw_137:
  s_barrier
  s_add_u32 m0, s90, 8448
  s_add_u32 s51, s46, s47
  buffer_load_dwordx4 v251, s[36:39], s51 offen nt lds
  s_add_u32 m0, s90, 8480
  s_nop 0
  buffer_load_dwordx4 v251, s[36:39], s51 offen offset:1024 nt lds
  s_xor_b32 s47, s47, s50
  s_cselect_b32 s31, 0, 8192
  s_add_u32 s46, s46, s31
  s_and_b32 s31, s46, s50
  s_add_u32 s46, s46, s31
  s_add_u32 s90, s90, 16896
  s_cmp_eq_u32 s90, s49
  s_cselect_b32 s31, 67584, 0
  s_sub_u32 s90, s90, s31
  s_add_u32 m0, s48, 0
  s_add_u32 s51, s44, s45
  buffer_load_dwordx4 v251, s[32:35], s51 offen nt lds
  s_add_u32 m0, s48, 32
  s_nop 0
  buffer_load_dwordx4 v251, s[32:35], s51 offen offset:1024 nt lds
  s_xor_b32 s45, s45, s50
  s_cselect_b32 s31, 0, 8192
  s_add_u32 s44, s44, s31
  s_and_b32 s31, s44, s50
  s_add_u32 s44, s44, s31
  s_add_u32 s48, s48, 16896
  s_cmp_eq_u32 s48, s49
  s_cselect_b32 s31, 67584, 0
  s_sub_u32 s48, s48, s31
  s_sub_u32 s64, s64, 1
  s_cmp_lg_u32 s64, 0
  s_cbranch_scc1 L_lp_136
  s_waitcnt vmcnt(8)
  s_cmp_lg_u32 s84, 0
  s_cbranch_scc1 L_vw_138
  s_waitcnt vmcnt(4)
L_vw_138:
  s_barrier
  s_add_u32 m0, s90, 8448
  s_add_u32 s51, s46, s47
  buffer_load_dwordx4 v251, s[36:39], s51 offen nt lds
  s_add_u32 m0, s90, 8480
  s_nop 0
  buffer_load_dwordx4 v251, s[36:39], s51 offen offset:1024 nt lds
  s_xor_b32 s47, s47, s50
  s_cselect_b32 s31, 0, 8192
  s_add_u32 s46, s46, s31
  s_and_b32 s31, s46, s50
  s_add_u32 s46, s46, s31
  s_add_u32 s90, s90, 16896
  s_cmp_eq_u32 s90, s49
  s_cselect_b32 s31, 67584, 0
  s_sub_u32 s90, s90, s31
  s_add_u32 m0, s48, 0
  s_add_u32 s51, s44, s45
  buffer_load_dwordx4 v251, s[32:35], s51 offen nt lds
  s_add_u32 m0, s48, 32
  s_nop 0
  buffer_load_dwordx4 v251, s[32:35], s51 offen offset:1024 nt lds
  s_xor_b32 s45, s45, s50
  s_cselect_b32 s31, 0, 8192
  s_add_u32 s44, s44, s31
  s_and_b32 s31, s44, s50
  s_add_u32 s44, s44, s31
  s_add_u32 s48, s48, 16896
  s_cmp_eq_u32 s48, s49
  s_cselect_b32 s31, 67584, 0
  s_sub_u32 s48, s48, s31
  s_add_u32 s61, s61, 294912
  s_mov_b32 s62, 61440
  s_lshl_b32 s67, s60, 7
  s_add_u32 m0, s62, s69
  s_add_u32 s67, s67, s61
  buffer_load_dwordx4 v244, s[72:75], s67 offen lds
  s_add_u32 m0, m0, 1024
  s_add_u32 s67, s67, 9216
  buffer_load_dwordx4 v244, s[72:75], s67 offen lds
  s_add_u32 m0, m0, 1024
  s_add_u32 s67, s67, 9216
  buffer_load_dwordx4 v244, s[72:75], s67 offen lds
  s_add_u32 m0, m0, 1024
  s_add_u32 s67, s67, 9216
  buffer_load_dwordx4 v244, s[72:75], s67 offen lds
  s_add_u32 m0, s62, s69
  s_add_u32 m0, m0, 4096
  s_add_u32 s67, s67, 9216
  buffer_load_dwordx4 v244, s[72:75], s67 offen lds
  s_add_u32 m0, m0, 1024
  s_add_u32 s67, s67, 9216
  buffer_load_dwordx4 v244, s[72:75], s67 offen lds
  s_add_u32 m0, m0, 1024
  s_add_u32 s67, s67, 9216
  buffer_load_dwordx4 v244, s[72:75], s67 offen lds
  s_add_u32 m0, m0, 1024
  s_add_u32 s67, s67, 9216
  buffer_load_dwordx4 v244, s[72:75], s67 offen lds
  s_add_u32 s60, s60, 1
  s_cmp_eq_u32 s60, 9
  s_cselect_b32 s60, 0, s60
  s_mov_b32 s64, 3
L_lp_139:
  s_waitcnt vmcnt(16)
  s_cmp_lg_u32 s84, 0
  s_cbranch_scc1 L_vw_140
  s_waitcnt vmcnt(4)
L_vw_140:
  s_barrier
  s_add_u32 m0, s90, 8448
  s_add_u32 s51, s46, s47
  buffer_load_dwordx4 v251, s[36:39], s51 offen nt lds
  s_add_u32 m0, s90, 8480
  s_nop 0
  buffer_load_dwordx4 v251, s[36:39], s51 offen offset:1024 nt lds
  s_xor_b32 s47, s47, s50
  s_cselect_b32 s31, 0, 8192
  s_add_u32 s46, s46, s31
  s_and_b32 s31, s46, s50
  s_add_u32 s46, s46, s31
  s_add_u32 s90, s90, 16896
  s_cmp_eq_u32 s90, s49
  s_cselect_b32 s31, 67584, 0
  s_sub_u32 s90, s90, s31
  s_add_u32 m0, s48, 0
  s_add_u32 s51, s44, s45
  buffer_load_dwordx4 v251, s[32:35], s51 offen nt lds
  s_add_u32 m0, s48, 32
  s_nop 0
  buffer_load_dwordx4 v251, s[32:35], s51 offen offset:1024 nt lds
  s_xor_b32 s45, s45, s50
  s_cselect_b32 s31, 0, 8192
  s_add_u32 s44, s44, s31
  s_and_b32 s31, s44, s50
  s_add_u32 s44, s44, s31
  s_add_u32 s48, s48, 16896
  s_cmp_eq_u32 s48, s49
  s_cselect_b32 s31, 67584, 0
  s_sub_u32 s48, s48, s31
  s_sub_u32 s64, s64, 1
  s_cmp_lg_u32 s64, 0
  s_cbranch_scc1 L_lp_139
  s_and_b32 s31, s30, 1
  s_mul_i32 s31, s31, 24576
  v_add_u32 v244, s31, v251
  s_waitcnt vmcnt(0)
  s_barrier
  ds_read_b64_tr_b16 v[228:229], v245 offset:0
  ds_read_b64_tr_b16 v[230:231], v245 offset:2048
  ds_read_b128 v[0:3], v244 offset:0
  ds_read_b128 v[32:35], v244 offset:8192
  ds_read_b128 v[64:67], v244 offset:16384
  ds_read_b64_tr_b16 v[232:233], v245 offset:4096
  ds_read_b64_tr_b16 v[234:235], v245 offset:6144
  ds_read_b128 v[4:7], v244 offset:1024
  ds_read_b128 v[36:39], v244 offset:9216
  ds_read_b128 v[68:71], v244 offset:17408
  ds_read_b64_tr_b16 v[236:237], v245 offset:8192
  ds_read_b64_tr_b16 v[238:239], v245 offset:10240
  ds_read_b128 v[8:11], v244 offset:2048
  ds_read_b128 v[40:43], v244 offset:10240
  ds_read_b128 v[72:75], v244 offset:18432
  s_waitcnt lgkmcnt(7)
  ds_read_b64_tr_b16 v[240:241], v245 offset:12288
  ds_read_b64_tr_b16 v[242:243], v245 offset:14336
  ds_read_b128 v[12:15], v244 offset:3072
  ds_read_b128 v[44:47], v244 offset:11264
  ds_read_b128 v[76:79], v244 offset:19456
  ds_read_b128 v[16:19], v244 offset:4096
  ds_read_b128 v[48:51], v244 offset:12288
  ds_read_b128 v[80:83], v244 offset:20480
  s_waitcnt lgkmcnt(7)
  ds_read_b128 v[20:23], v244 offset:5120
  ds_read_b128 v[52:55], v244 offset:13312
  ds_read_b128 v[84:87], v244 offset:21504
  ds_read_b128 v[24:27], v244 offset:6144
  ds_read_b128 v[56:59], v244 offset:14336
  ds_read_b128 v[88:91], v244 offset:22528
  ds_read_b128 v[28:31], v244 offset:7168
  ds_read_b128 v[60:63], v244 offset:15360
  s_waitcnt lgkmcnt(7)
  ds_read_b128 v[92:95], v244 offset:23552
  v_mfma_f32_16x16x32_bf16 v[204:207], v[228:231], v[0:3], v[204:207]
  v_mfma_f32_16x16x32_bf16 v[208:211], v[228:231], v[32:35], v[208:211]
  v_mfma_f32_16x16x32_bf16 v[212:215], v[228:231], v[64:67], v[212:215]
  ds_read_b64_tr_b16 v[228:229], v245 offset:16384
  v_mfma_f32_16x16x32_bf16 v[204:207], v[232:235], v[4:7], v[204:207]
  ds_read_b64_tr_b16 v[230:231], v245 offset:18432
  v_mfma_f32_16x16x32_bf16 v[208:211], v[232:235], v[36:39], v[208:211]
  v_mfma_f32_16x16x32_bf16 v[212:215], v[232:235], v[68:71], v[212:215]
  ds_read_b64_tr_b16 v[232:233], v245 offset:20480
  v_mfma_f32_16x16x32_bf16 v[204:207], v[236:239], v[8:11], v[204:207]
  ds_read_b64_tr_b16 v[234:235], v245 offset:22528
  v_mfma_f32_16x16x32_bf16 v[208:211], v[236:239], v[40:43], v[208:211]
  v_mfma_f32_16x16x32_bf16 v[212:215], v[236:239], v[72:75], v[212:215]
  ds_read_b64_tr_b16 v[236:237], v245 offset:24576
  v_mfma_f32_16x16x32_bf16 v[204:207], v[240:243], v[12:15], v[204:207]
  ds_read_b64_tr_b16 v[238:239], v245 offset:26624
  v_mfma_f32_16x16x32_bf16 v[208:211], v[240:243], v[44:47], v[208:211]
  v_mfma_f32_16x16x32_bf16 v[212:215], v[240:243], v[76:79], v[212:215]
  ds_read_b64_tr_b16 v[240:241], v245 offset:28672
  s_waitcnt lgkmcnt(5)
  v_mfma_f32_16x16x32_bf16 v[204:207], v[228:231], v[16:19], v[204:207]
  ds_read_b64_tr_b16 v[242:243], v245 offset:30720
  v_mfma_f32_16x16x32_bf16 v[208:211], v[228:231], v[48:51], v[208:211]
  v_mfma_f32_16x16x32_bf16 v[212:215], v[228:231], v[80:83], v[212:215]
  ds_read_b64_tr_b16 v[228:229], v253 offset:0
  s_waitcnt lgkmcnt(5)
  v_mfma_f32_16x16x32_bf16 v[204:207], v[232:235], v[20:23], v[204:207]
  ds_read_b64_tr_b16 v[230:231], v253 offset:2048
  v_mfma_f32_16x16x32_bf16 v[208:211], v[232:235], v[52:55], v[208:211]
  v_mfma_f32_16x16x32_bf16 v[212:215], v[232:235], v[84:87], v[212:215]
  ds_read_b64_tr_b16 v[232:233], v253 offset:4096
  s_waitcnt lgkmcnt(5)
  v_mfma_f32_16x16x32_bf16 v[204:207], v[236:239], v[24:27], v[204:207]
  ds_read_b64_tr_b16 v[234:235], v253 offset:6144
  v_mfma_f32_16x16x32_bf16 v[208:211], v[236:239], v[56:59], v[208:211]
  v_mfma_f32_16x16x32_bf16 v[212:215], v[236:239], v[88:91], v[212:215]
  ds_read_b64_tr_b16 v[236:237], v253 offset:8192
  s_waitcnt lgkmcnt(5)
  v_mfma_f32_16x16x32_bf16 v[204:207], v[240:243], v[28:31], v[204:207]
  ds_read_b64_tr_b16 v[238:239], v253 offset:10240
  v_mfma_f32_16x16x32_bf16 v[208:211], v[240:243], v[60:63], v[208:211]
  v_mfma_f32_16x16x32_bf16 v[212:215], v[240:243], v[92:95], v[212:215]
  ds_read_b64_tr_b16 v[240:241], v253 offset:12288
  s_waitcnt lgkmcnt(5)
  v_mfma_f32_16x16x32_bf16 v[216:219], v[228:231], v[0:3], v[216:219]
  ds_read_b64_tr_b16 v[242:243], v253 offset:14336
  v_mfma_f32_16x16x32_bf16 v[220:223], v[228:231], v[32:35], v[220:223]
  s_barrier
  v_mfma_f32_16x16x32_bf16 v[224:227], v[228:231], v[64:67], v[224:227]
  ds_read_b64_tr_b16 v[228:229], v253 offset:16384
  s_waitcnt lgkmcnt(5)
  v_mfma_f32_16x16x32_bf16 v[216:219], v[232:235], v[4:7], v[216:219]
  ds_read_b64_tr_b16 v[230:231], v253 offset:18432
  v_cvt_pk_bf16_f32 v96, v204, v205
  v_mfma_f32_16x16x32_bf16 v[220:223], v[232:235], v[36:39], v[220:223]
  v_cvt_pk_bf16_f32 v97, v206, v207
  v_cvt_pk_bf16_f32 v100, v208, v209
  v_mfma_f32_16x16x32_bf16 v[224:227], v[232:235], v[68:71], v[224:227]
  ds_read_b64_tr_b16 v[232:233], v253 offset:20480
  s_waitcnt lgkmcnt(5)
  v_mfma_f32_16x16x32_bf16 v[216:219], v[236:239], v[8:11], v[216:219]
  ds_read_b64_tr_b16 v[234:235], v253 offset:22528
  v_cvt_pk_bf16_f32 v101, v210, v211
  v_mfma_f32_16x16x32_bf16 v[220:223], v[236:239], v[40:43], v[220:223]
  v_cvt_pk_bf16_f32 v104, v212, v213
  v_cvt_pk_bf16_f32 v105, v214, v215
  v_mfma_f32_16x16x32_bf16 v[224:227], v[236:239], v[72:75], v[224:227]
  ds_read_b64_tr_b16 v[236:237], v253 offset:24576
  s_waitcnt lgkmcnt(5)
  v_mfma_f32_16x16x32_bf16 v[216:219], v[240:243], v[12:15], v[216:219]
  ds_read_b64_tr_b16 v[238:239], v253 offset:26624
  v_lshlrev_b32 v204, 16, v108
  v_mfma_f32_16x16x32_bf16 v[220:223], v[240:243], v[44:47], v[220:223]
  v_and_b32 v205, 0xffff0000, v108
  v_lshlrev_b32 v206, 16, v109
  v_mfma_f32_16x16x32_bf16 v[224:227], v[240:243], v[76:79], v[224:227]
  ds_read_b64_tr_b16 v[240:241], v253 offset:28672
  s_waitcnt lgkmcnt(5)
  v_mfma_f32_16x16x32_bf16 v[216:219], v[228:231], v[16:19], v[216:219]
  ds_read_b64_tr_b16 v[242:243], v253 offset:30720
  v_and_b32 v207, 0xffff0000, v109
  v_mfma_f32_16x16x32_bf16 v[220:223], v[228:231], v[48:51], v[220:223]
  v_lshlrev_b32 v208, 16, v112
  v_and_b32 v209, 0xffff0000, v112
  v_mfma_f32_16x16x32_bf16 v[224:227], v[228:231], v[80:83], v[224:227]
  v_add_u32 v245, 32768, v245
  ds_read_b64_tr_b16 v[228:229], v245 offset:0
  s_waitcnt lgkmcnt(5)
  v_mfma_f32_16x16x32_bf16 v[216:219], v[232:235], v[20:23], v[216:219]
  ds_read_b64_tr_b16 v[230:231], v245 offset:2048
  v_lshlrev_b32 v210, 16, v113
  v_mfma_f32_16x16x32_bf16 v[220:223], v[232:235], v[52:55], v[220:223]
  v_and_b32 v211, 0xffff0000, v113
  v_lshlrev_b32 v212, 16, v116
  v_mfma_f32_16x16x32_bf16 v[224:227], v[232:235], v[84:87], v[224:227]
  ds_read_b64_tr_b16 v[232:233], v245 offset:4096
  s_waitcnt lgkmcnt(5)
  v_mfma_f32_16x16x32_bf16 v[216:219], v[236:239], v[24:27], v[216:219]
  ds_read_b64_tr_b16 v[234:235], v245 offset:6144
  v_and_b32 v213, 0xffff0000, v116
  v_mfma_f32_16x16x32_bf16 v[220:223], v[236:239], v[56:59], v[220:223]
  v_lshlrev_b32 v214, 16, v117
  v_and_b32 v215, 0xffff0000, v117
  v_mfma_f32_16x16x32_bf16 v[224:227], v[236:239], v[88:91], v[224:227]
  ds_read_b64_tr_b16 v[236:237], v245 offset:8192
  s_waitcnt lgkmcnt(5)
  v_mfma_f32_16x16x32_bf16 v[216:219], v[240:243], v[28:31], v[216:219]
  ds_read_b64_tr_b16 v[238:239], v245 offset:10240
  v_mfma_f32_16x16x32_bf16 v[220:223], v[240:243], v[60:63], v[220:223]
  v_mfma_f32_16x16x32_bf16 v[224:227], v[240:243], v[92:95], v[224:227]
  ds_read_b64_tr_b16 v[240:241], v245 offset:12288
  s_waitcnt lgkmcnt(5)
  v_mfma_f32_16x16x32_bf16 v[204:207], v[228:231], v[0:3], v[204:207]
  ds_read_b64_tr_b16 v[242:243], v245 offset:14336
  v_mfma_f32_16x16x32_bf16 v[208:211], v[228:231], v[32:35], v[208:211]
  v_mfma_f32_16x16x32_bf16 v[212:215], v[228:231], v[64:67], v[212:215]
  ds_read_b64_tr_b16 v[228:229], v245 offset:16384
  s_waitcnt lgkmcnt(5)
  v_mfma_f32_16x16x32_bf16 v[204:207], v[232:235], v[4:7], v[204:207]
  ds_read_b64_tr_b16 v[230:231], v245 offset:18432
  v_cvt_pk_bf16_f32 v98, v216, v217
  v_mfma_f32_16x16x32_bf16 v[208:211], v[232:235], v[36:39], v[208:211]
  v_cvt_pk_bf16_f32 v99, v218, v219
  v_cvt_pk_bf16_f32 v102, v220, v221
  v_mfma_f32_16x16x32_bf16 v[212:215], v[232:235], v[68:71], v[212:215]
  ds_read_b64_tr_b16 v[232:233], v245 offset:20480
  s_waitcnt lgkmcnt(5)
  v_mfma_f32_16x16x32_bf16 v[204:207], v[236:239], v[8:11], v[204:207]
  ds_read_b64_tr_b16 v[234:235], v245 offset:22528
  v_cvt_pk_bf16_f32 v103, v222, v223
  v_mfma_f32_16x16x32_bf16 v[208:211], v[236:239], v[40:43], v[208:211]
  v_cvt_pk_bf16_f32 v106, v224, v225
  v_cvt_pk_bf16_f32 v107, v226, v227
  v_mfma_f32_16x16x32_bf16 v[212:215], v[236:239], v[72:75], v[212:215]
  ds_read_b64_tr_b16 v[236:237], v245 offset:24576
  s_waitcnt lgkmcnt(5)
  v_mfma_f32_16x16x32_bf16 v[204:207], v[240:243], v[12:15], v[204:207]
  ds_read_b64_tr_b16 v[238:239], v245 offset:26624
  v_permlane16_swap_b32 v96, v98
  v_mfma_f32_16x16x32_bf16 v[208:211], v[240:243], v[44:47], v[208:211]
  v_permlane16_swap_b32 v97, v99
  v_permlane16_swap_b32 v100, v102
  v_mfma_f32_16x16x32_bf16 v[212:215], v[240:243], v[76:79], v[212:215]
  ds_read_b64_tr_b16 v[240:241], v245 offset:28672
  s_waitcnt lgkmcnt(5)
  v_mfma_f32_16x16x32_bf16 v[204:207], v[228:231], v[16:19], v[204:207]
  ds_read_b64_tr_b16 v[242:243], v245 offset:30720
  v_permlane16_swap_b32 v101, v103
  v_mfma_f32_16x16x32_bf16 v[208:211], v[228:231], v[48:51], v[208:211]
  v_permlane16_swap_b32 v104, v106
  v_permlane16_swap_b32 v105, v107
  v_mfma_f32_16x16x32_bf16 v[212:215], v[228:231], v[80:83], v[212:215]
  v_add_u32 v253, 32768, v253
  ds_read_b64_tr_b16 v[228:229], v253 offset:0
  s_waitcnt lgkmcnt(5)
  v_mfma_f32_16x16x32_bf16 v[204:207], v[232:235], v[20:23], v[204:207]
  ds_read_b64_tr_b16 v[230:231], v253 offset:2048
  v_lshlrev_b32 v216, 16, v110
  v_and_b32 v217, 0xffff0000, v110
  v_mfma_f32_16x16x32_bf16 v[208:211], v[232:235], v[52:55], v[208:211]
  v_lshlrev_b32 v218, 16, v111
  v_and_b32 v219, 0xffff0000, v111
  s_mul_i32 s66, s53, 12288
  s_add_u32 s66, s66, s65
  buffer_store_dwordx4 v[96:99], v251, s[76:79], s66 offen offset:0 sc1
  v_mfma_f32_16x16x32_bf16 v[212:215], v[232:235], v[84:87], v[212:215]
  ds_read_b64_tr_b16 v[232:233], v253 offset:4096
  s_waitcnt lgkmcnt(5)
  v_mfma_f32_16x16x32_bf16 v[204:207], v[236:239], v[24:27], v[204:207]
  ds_read_b64_tr_b16 v[234:235], v253 offset:6144
  v_lshlrev_b32 v220, 16, v114
  v_and_b32 v221, 0xffff0000, v114
  v_mfma_f32_16x16x32_bf16 v[208:211], v[236:239], v[56:59], v[208:211]
  v_lshlrev_b32 v222, 16, v115
  v_and_b32 v223, 0xffff0000, v115
  buffer_store_dwordx4 v[100:103], v251, s[76:79], s66 offen offset:1024 sc1
  v_mfma_f32_16x16x32_bf16 v[212:215], v[236:239], v[88:91], v[212:215]
  ds_read_b64_tr_b16 v[236:237], v253 offset:8192
  s_waitcnt lgkmcnt(5)
  v_mfma_f32_16x16x32_bf16 v[204:207], v[240:243], v[28:31], v[204:207]
  ds_read_b64_tr_b16 v[238:239], v253 offset:10240
  v_lshlrev_b32 v224, 16, v118
  v_and_b32 v225, 0xffff0000, v118
  v_mfma_f32_16x16x32_bf16 v[208:211], v[240:243], v[60:63], v[208:211]
  v_lshlrev_b32 v226, 16, v119
  v_and_b32 v227, 0xffff0000, v119
  buffer_store_dwordx4 v[104:107], v251, s[76:79], s66 offen offset:2048 sc1
  s_add_u32 s53, s53, 1
  s_cmp_eq_u32 s53, 9
  s_cselect_b32 s53, 0, s53
  v_mfma_f32_16x16x32_bf16 v[212:215], v[240:243], v[92:95], v[212:215]
  ds_read_b64_tr_b16 v[240:241], v253 offset:12288
  s_waitcnt lgkmcnt(5)
  v_mfma_f32_16x16x32_bf16 v[216:219], v[228:231], v[0:3], v[216:219]
  ds_read_b64_tr_b16 v[242:243], v253 offset:14336
  v_mfma_f32_16x16x32_bf16 v[220:223], v[228:231], v[32:35], v[220:223]
  s_barrier
  v_mfma_f32_16x16x32_bf16 v[224:227], v[228:231], v[64:67], v[224:227]
  ds_read_b64_tr_b16 v[228:229], v253 offset:16384
  s_waitcnt lgkmcnt(5)
  v_mfma_f32_16x16x32_bf16 v[216:219], v[232:235], v[4:7], v[216:219]
  ds_read_b64_tr_b16 v[230:231], v253 offset:18432
  v_cvt_pk_bf16_f32 v108, v204, v205
  v_mfma_f32_16x16x32_bf16 v[220:223], v[232:235], v[36:39], v[220:223]
  v_cvt_pk_bf16_f32 v109, v206, v207
  v_cvt_pk_bf16_f32 v112, v208, v209
  v_mfma_f32_16x16x32_bf16 v[224:227], v[232:235], v[68:71], v[224:227]
  ds_read_b64_tr_b16 v[232:233], v253 offset:20480
  s_waitcnt lgkmcnt(5)
  v_mfma_f32_16x16x32_bf16 v[216:219], v[236:239], v[8:11], v[216:219]
  ds_read_b64_tr_b16 v[234:235], v253 offset:22528
  v_cvt_pk_bf16_f32 v113, v210, v211
  v_mfma_f32_16x16x32_bf16 v[220:223], v[236:239], v[40:43], v[220:223]
  v_cvt_pk_bf16_f32 v116, v212, v213
  v_cvt_pk_bf16_f32 v117, v214, v215
  v_mfma_f32_16x16x32_bf16 v[224:227], v[236:239], v[72:75], v[224:227]
  ds_read_b64_tr_b16 v[236:237], v253 offset:24576
  s_waitcnt lgkmcnt(5)
  v_mfma_f32_16x16x32_bf16 v[216:219], v[240:243], v[12:15], v[216:219]
  ds_read_b64_tr_b16 v[238:239], v253 offset:26624
  v_lshlrev_b32 v204, 16, v120
  v_mfma_f32_16x16x32_bf16 v[220:223], v[240:243], v[44:47], v[220:223]
  v_and_b32 v205, 0xffff0000, v120
  v_lshlrev_b32 v206, 16, v121
  v_mfma_f32_16x16x32_bf16 v[224:227], v[240:243], v[76:79], v[224:227]
  ds_read_b64_tr_b16 v[240:241], v253 offset:28672
  s_waitcnt lgkmcnt(5)
  v_mfma_f32_16x16x32_bf16 v[216:219], v[228:231], v[16:19], v[216:219]
  ds_read_b64_tr_b16 v[242:243], v253 offset:30720
  v_and_b32 v207, 0xffff0000, v121
  v_mfma_f32_16x16x32_bf16 v[220:223], v[228:231], v[48:51], v[220:223]
  v_lshlrev_b32 v208, 16, v124
  v_and_b32 v209, 0xffff0000, v124
  v_mfma_f32_16x16x32_bf16 v[224:227], v[228:231], v[80:83], v[224:227]
  v_add_u32 v245, 32768, v245
  ds_read_b64_tr_b16 v[228:229], v245 offset:0
  s_waitcnt lgkmcnt(5)
  v_mfma_f32_16x16x32_bf16 v[216:219], v[232:235], v[20:23], v[216:219]
  ds_read_b64_tr_b16 v[230:231], v245 offset:2048
  v_lshlrev_b32 v210, 16, v125
  v_mfma_f32_16x16x32_bf16 v[220:223], v[232:235], v[52:55], v[220:223]
  v_and_b32 v211, 0xffff0000, v125
  v_lshlrev_b32 v212, 16, v128
  v_mfma_f32_16x16x32_bf16 v[224:227], v[232:235], v[84:87], v[224:227]
  ds_read_b64_tr_b16 v[232:233], v245 offset:4096
  s_waitcnt lgkmcnt(5)
  v_mfma_f32_16x16x32_bf16 v[216:219], v[236:239], v[24:27], v[216:219]
  ds_read_b64_tr_b16 v[234:235], v245 offset:6144
  v_and_b32 v213, 0xffff0000, v128
  v_mfma_f32_16x16x32_bf16 v[220:223], v[236:239], v[56:59], v[220:223]
  v_lshlrev_b32 v214, 16, v129
  v_and_b32 v215, 0xffff0000, v129
  v_mfma_f32_16x16x32_bf16 v[224:227], v[236:239], v[88:91], v[224:227]
  ds_read_b64_tr_b16 v[236:237], v245 offset:8192
  s_waitcnt lgkmcnt(5)
  v_mfma_f32_16x16x32_bf16 v[216:219], v[240:243], v[28:31], v[216:219]
  ds_read_b64_tr_b16 v[238:239], v245 offset:10240
  v_mfma_f32_16x16x32_bf16 v[220:223], v[240:243], v[60:63], v[220:223]
  v_mfma_f32_16x16x32_bf16 v[224:227], v[240:243], v[92:95], v[224:227]
  ds_read_b64_tr_b16 v[240:241], v245 offset:12288
  s_waitcnt lgkmcnt(5)
  v_mfma_f32_16x16x32_bf16 v[204:207], v[228:231], v[0:3], v[204:207]
  ds_read_b64_tr_b16 v[242:243], v245 offset:14336
  v_mfma_f32_16x16x32_bf16 v[208:211], v[228:231], v[32:35], v[208:211]
  v_mfma_f32_16x16x32_bf16 v[212:215], v[228:231], v[64:67], v[212:215]
  ds_read_b64_tr_b16 v[228:229], v245 offset:16384
  s_waitcnt lgkmcnt(5)
  v_mfma_f32_16x16x32_bf16 v[204:207], v[232:235], v[4:7], v[204:207]
  ds_read_b64_tr_b16 v[230:231], v245 offset:18432
  v_cvt_pk_bf16_f32 v110, v216, v217
  v_mfma_f32_16x16x32_bf16 v[208:211], v[232:235], v[36:39], v[208:211]
  v_cvt_pk_bf16_f32 v111, v218, v219
  v_cvt_pk_bf16_f32 v114, v220, v221
  v_mfma_f32_16x16x32_bf16 v[212:215], v[232:235], v[68:71], v[212:215]
  ds_read_b64_tr_b16 v[232:233], v245 offset:20480
  s_waitcnt lgkmcnt(5)
  v_mfma_f32_16x16x32_bf16 v[204:207], v[236:239], v[8:11], v[204:207]
  ds_read_b64_tr_b16 v[234:235], v245 offset:22528
  v_cvt_pk_bf16_f32 v115, v222, v223
  v_mfma_f32_16x16x32_bf16 v[208:211], v[236:239], v[40:43], v[208:211]
  v_cvt_pk_bf16_f32 v118, v224, v225
  v_cvt_pk_bf16_f32 v119, v226, v227
  v_mfma_f32_16x16x32_bf16 v[212:215], v[236:239], v[72:75], v[212:215]
  ds_read_b64_tr_b16 v[236:237], v245 offset:24576
  s_waitcnt lgkmcnt(5)
  v_mfma_f32_16x16x32_bf16 v[204:207], v[240:243], v[12:15], v[204:207]
  ds_read_b64_tr_b16 v[238:239], v245 offset:26624
  v_permlane16_swap_b32 v108, v110
  v_mfma_f32_16x16x32_bf16 v[208:211], v[240:243], v[44:47], v[208:211]
  v_permlane16_swap_b32 v109, v111
  v_permlane16_swap_b32 v112, v114
  v_mfma_f32_16x16x32_bf16 v[212:215], v[240:243], v[76:79], v[212:215]
  ds_read_b64_tr_b16 v[240:241], v245 offset:28672
  s_waitcnt lgkmcnt(5)
  v_mfma_f32_16x16x32_bf16 v[204:207], v[228:231], v[16:19], v[204:207]
  ds_read_b64_tr_b16 v[242:243], v245 offset:30720
  v_permlane16_swap_b32 v113, v115
  v_mfma_f32_16x16x32_bf16 v[208:211], v[228:231], v[48:51], v[208:211]
  v_permlane16_swap_b32 v116, v118
  v_permlane16_swap_b32 v117, v119
  v_mfma_f32_16x16x32_bf16 v[212:215], v[228:231], v[80:83], v[212:215]
  v_add_u32 v253, 32768, v253
  ds_read_b64_tr_b16 v[228:229], v253 offset:0
  s_waitcnt lgkmcnt(5)
  v_mfma_f32_16x16x32_bf16 v[204:207], v[232:235], v[20:23], v[204:207]
  ds_read_b64_tr_b16 v[230:231], v253 offset:2048
  v_lshlrev_b32 v216, 16, v122
  v_and_b32 v217, 0xffff0000, v122
  v_mfma_f32_16x16x32_bf16 v[208:211], v[232:235], v[52:55], v[208:211]
  v_lshlrev_b32 v218, 16, v123
  v_and_b32 v219, 0xffff0000, v123
  s_mul_i32 s66, s53, 12288
  s_add_u32 s66, s66, s65
  buffer_store_dwordx4 v[108:111], v251, s[76:79], s66 offen offset:0 sc1
  v_mfma_f32_16x16x32_bf16 v[212:215], v[232:235], v[84:87], v[212:215]
  ds_read_b64_tr_b16 v[232:233], v253 offset:4096
  s_waitcnt lgkmcnt(5)
  v_mfma_f32_16x16x32_bf16 v[204:207], v[236:239], v[24:27], v[204:207]
  ds_read_b64_tr_b16 v[234:235], v253 offset:6144
  v_lshlrev_b32 v220, 16, v126
  v_and_b32 v221, 0xffff0000, v126
  v_mfma_f32_16x16x32_bf16 v[208:211], v[236:239], v[56:59], v[208:211]
  v_lshlrev_b32 v222, 16, v127
  v_and_b32 v223, 0xffff0000, v127
  buffer_store_dwordx4 v[112:115], v251, s[76:79], s66 offen offset:1024 sc1
  v_mfma_f32_16x16x32_bf16 v[212:215], v[236:239], v[88:91], v[212:215]
  ds_read_b64_tr_b16 v[236:237], v253 offset:8192
  s_waitcnt lgkmcnt(5)
  v_mfma_f32_16x16x32_bf16 v[204:207], v[240:243], v[28:31], v[204:207]
  ds_read_b64_tr_b16 v[238:239], v253 offset:10240
  v_lshlrev_b32 v224, 16, v130
  v_and_b32 v225, 0xffff0000, v130
  v_mfma_f32_16x16x32_bf16 v[208:211], v[240:243], v[60:63], v[208:211]
  v_lshlrev_b32 v226, 16, v131
  v_and_b32 v227, 0xffff0000, v131
  buffer_store_dwordx4 v[116:119], v251, s[76:79], s66 offen offset:2048 sc1
  s_add_u32 s53, s53, 1
  s_cmp_eq_u32 s53, 9
  s_cselect_b32 s53, 0, s53
  v_mfma_f32_16x16x32_bf16 v[212:215], v[240:243], v[92:95], v[212:215]
  ds_read_b64_tr_b16 v[240:241], v253 offset:12288
  s_waitcnt lgkmcnt(5)
  v_mfma_f32_16x16x32_bf16 v[216:219], v[228:231], v[0:3], v[216:219]
  ds_read_b64_tr_b16 v[242:243], v253 offset:14336
  v_mfma_f32_16x16x32_bf16 v[220:223], v[228:231], v[32:35], v[220:223]
  s_barrier
  v_mfma_f32_16x16x32_bf16 v[224:227], v[228:231], v[64:67], v[224:227]
  ds_read_b64_tr_b16 v[228:229], v253 offset:16384
  s_waitcnt lgkmcnt(5)
  v_mfma_f32_16x16x32_bf16 v[216:219], v[232:235], v[4:7], v[216:219]
  ds_read_b64_tr_b16 v[230:231], v253 offset:18432
  v_cvt_pk_bf16_f32 v120, v204, v205
  v_mfma_f32_16x16x32_bf16 v[220:223], v[232:235], v[36:39], v[220:223]
  v_cvt_pk_bf16_f32 v121, v206, v207
  v_cvt_pk_bf16_f32 v124, v208, v209
  v_mfma_f32_16x16x32_bf16 v[224:227], v[232:235], v[68:71], v[224:227]
  ds_read_b64_tr_b16 v[232:233], v253 offset:20480
  s_waitcnt lgkmcnt(5)
  v_mfma_f32_16x16x32_bf16 v[216:219], v[236:239], v[8:11], v[216:219]
  ds_read_b64_tr_b16 v[234:235], v253 offset:22528
  v_cvt_pk_bf16_f32 v125, v210, v211
  v_mfma_f32_16x16x32_bf16 v[220:223], v[236:239], v[40:43], v[220:223]
  v_cvt_pk_bf16_f32 v128, v212, v213
  v_cvt_pk_bf16_f32 v129, v214, v215
  v_mfma_f32_16x16x32_bf16 v[224:227], v[236:239], v[72:75], v[224:227]
  ds_read_b64_tr_b16 v[236:237], v253 offset:24576
  s_waitcnt lgkmcnt(5)
  v_mfma_f32_16x16x32_bf16 v[216:219], v[240:243], v[12:15], v[216:219]
  ds_read_b64_tr_b16 v[238:239], v253 offset:26624
  v_lshlrev_b32 v204, 16, v132
  v_mfma_f32_16x16x32_bf16 v[220:223], v[240:243], v[44:47], v[220:223]
  v_and_b32 v205, 0xffff0000, v132
  v_lshlrev_b32 v206, 16, v133
  v_mfma_f32_16x16x32_bf16 v[224:227], v[240:243], v[76:79], v[224:227]
  ds_read_b64_tr_b16 v[240:241], v253 offset:28672
  s_waitcnt lgkmcnt(5)
  v_mfma_f32_16x16x32_bf16 v[216:219], v[228:231], v[16:19], v[216:219]
  ds_read_b64_tr_b16 v[242:243], v253 offset:30720
  v_and_b32 v207, 0xffff0000, v133
  v_mfma_f32_16x16x32_bf16 v[220:223], v[228:231], v[48:51], v[220:223]
  v_lshlrev_b32 v208, 16, v136
  v_and_b32 v209, 0xffff0000, v136
  v_mfma_f32_16x16x32_bf16 v[224:227], v[228:231], v[80:83], v[224:227]
  v_add_u32 v245, 4294868992, v245
  ds_read_b64_tr_b16 v[228:229], v245 offset:0
  s_waitcnt lgkmcnt(5)
  v_mfma_f32_16x16x32_bf16 v[216:219], v[232:235], v[20:23], v[216:219]
  ds_read_b64_tr_b16 v[230:231], v245 offset:2048
  v_lshlrev_b32 v210, 16, v137
  v_mfma_f32_16x16x32_bf16 v[220:223], v[232:235], v[52:55], v[220:223]
  v_and_b32 v211, 0xffff0000, v137
  v_lshlrev_b32 v212, 16, v140
  v_mfma_f32_16x16x32_bf16 v[224:227], v[232:235], v[84:87], v[224:227]
  ds_read_b64_tr_b16 v[232:233], v245 offset:4096
  s_waitcnt lgkmcnt(5)
  v_mfma_f32_16x16x32_bf16 v[216:219], v[236:239], v[24:27], v[216:219]
  ds_read_b64_tr_b16 v[234:235], v245 offset:6144
  v_and_b32 v213, 0xffff0000, v140
  v_mfma_f32_16x16x32_bf16 v[220:223], v[236:239], v[56:59], v[220:223]
  v_lshlrev_b32 v214, 16, v141
  v_and_b32 v215, 0xffff0000, v141
  v_mfma_f32_16x16x32_bf16 v[224:227], v[236:239], v[88:91], v[224:227]
  ds_read_b64_tr_b16 v[236:237], v245 offset:8192
  s_waitcnt lgkmcnt(5)
  v_mfma_f32_16x16x32_bf16 v[216:219], v[240:243], v[28:31], v[216:219]
  ds_read_b64_tr_b16 v[238:239], v245 offset:10240
  v_mfma_f32_16x16x32_bf16 v[220:223], v[240:243], v[60:63], v[220:223]
  v_mfma_f32_16x16x32_bf16 v[224:227], v[240:243], v[92:95], v[224:227]
  ds_read_b64_tr_b16 v[240:241], v245 offset:12288
  s_waitcnt lgkmcnt(5)
  v_mfma_f32_16x16x32_bf16 v[204:207], v[228:231], v[0:3], v[204:207]
  ds_read_b64_tr_b16 v[242:243], v245 offset:14336
  v_mfma_f32_16x16x32_bf16 v[208:211], v[228:231], v[32:35], v[208:211]
  v_mfma_f32_16x16x32_bf16 v[212:215], v[228:231], v[64:67], v[212:215]
  ds_read_b64_tr_b16 v[228:229], v245 offset:16384
  s_waitcnt lgkmcnt(5)
  v_mfma_f32_16x16x32_bf16 v[204:207], v[232:235], v[4:7], v[204:207]
  ds_read_b64_tr_b16 v[230:231], v245 offset:18432
  v_cvt_pk_bf16_f32 v122, v216, v217
  v_mfma_f32_16x16x32_bf16 v[208:211], v[232:235], v[36:39], v[208:211]
  v_cvt_pk_bf16_f32 v123, v218, v219
  v_cvt_pk_bf16_f32 v126, v220, v221
  v_mfma_f32_16x16x32_bf16 v[212:215], v[232:235], v[68:71], v[212:215]
  ds_read_b64_tr_b16 v[232:233], v245 offset:20480
  s_waitcnt lgkmcnt(5)
  v_mfma_f32_16x16x32_bf16 v[204:207], v[236:239], v[8:11], v[204:207]
  ds_read_b64_tr_b16 v[234:235], v245 offset:22528
  v_cvt_pk_bf16_f32 v127, v222, v223
  v_mfma_f32_16x16x32_bf16 v[208:211], v[236:239], v[40:43], v[208:211]
  v_cvt_pk_bf16_f32 v130, v224, v225
  v_cvt_pk_bf16_f32 v131, v226, v227
  v_mfma_f32_16x16x32_bf16 v[212:215], v[236:239], v[72:75], v[212:215]
  ds_read_b64_tr_b16 v[236:237], v245 offset:24576
  s_waitcnt lgkmcnt(5)
  v_mfma_f32_16x16x32_bf16 v[204:207], v[240:243], v[12:15], v[204:207]
  ds_read_b64_tr_b16 v[238:239], v245 offset:26624
  v_permlane16_swap_b32 v120, v122
  v_mfma_f32_16x16x32_bf16 v[208:211], v[240:243], v[44:47], v[208:211]
  v_permlane16_swap_b32 v121, v123
  v_permlane16_swap_b32 v124, v126
  v_mfma_f32_16x16x32_bf16 v[212:215], v[240:243], v[76:79], v[212:215]
  ds_read_b64_tr_b16 v[240:241], v245 offset:28672
  s_waitcnt lgkmcnt(5)
  v_mfma_f32_16x16x32_bf16 v[204:207], v[228:231], v[16:19], v[204:207]
  ds_read_b64_tr_b16 v[242:243], v245 offset:30720
  v_permlane16_swap_b32 v125, v127
  v_mfma_f32_16x16x32_bf16 v[208:211], v[228:231], v[48:51], v[208:211]
  v_permlane16_swap_b32 v128, v130
  v_permlane16_swap_b32 v129, v131
  v_mfma_f32_16x16x32_bf16 v[212:215], v[228:231], v[80:83], v[212:215]
  v_add_u32 v253, 4294868992, v253
  ds_read_b64_tr_b16 v[228:229], v253 offset:0
  s_waitcnt lgkmcnt(5)
  v_mfma_f32_16x16x32_bf16 v[204:207], v[232:235], v[20:23], v[204:207]
  ds_read_b64_tr_b16 v[230:231], v253 offset:2048
  v_lshlrev_b32 v216, 16, v134
  v_and_b32 v217, 0xffff0000, v134
  v_mfma_f32_16x16x32_bf16 v[208:211], v[232:235], v[52:55], v[208:211]
  v_lshlrev_b32 v218, 16, v135
  v_and_b32 v219, 0xffff0000, v135
  s_mul_i32 s66, s53, 12288
  s_add_u32 s66, s66, s65
  buffer_store_dwordx4 v[120:123], v251, s[76:79], s66 offen offset:0 sc1
  v_mfma_f32_16x16x32_bf16 v[212:215], v[232:235], v[84:87], v[212:215]
  ds_read_b64_tr_b16 v[232:233], v253 offset:4096
  s_waitcnt lgkmcnt(5)
  v_mfma_f32_16x16x32_bf16 v[204:207], v[236:239], v[24:27], v[204:207]
  ds_read_b64_tr_b16 v[234:235], v253 offset:6144
  v_lshlrev_b32 v220, 16, v138
  v_and_b32 v221, 0xffff0000, v138
  v_mfma_f32_16x16x32_bf16 v[208:211], v[236:239], v[56:59], v[208:211]
  v_lshlrev_b32 v222, 16, v139
  v_and_b32 v223, 0xffff0000, v139
  buffer_store_dwordx4 v[124:127], v251, s[76:79], s66 offen offset:1024 sc1
  v_mfma_f32_16x16x32_bf16 v[212:215], v[236:239], v[88:91], v[212:215]
  ds_read_b64_tr_b16 v[236:237], v253 offset:8192
  s_waitcnt lgkmcnt(5)
  v_mfma_f32_16x16x32_bf16 v[204:207], v[240:243], v[28:31], v[204:207]
  ds_read_b64_tr_b16 v[238:239], v253 offset:10240
  v_lshlrev_b32 v224, 16, v142
  v_and_b32 v225, 0xffff0000, v142
  v_mfma_f32_16x16x32_bf16 v[208:211], v[240:243], v[60:63], v[208:211]
  v_lshlrev_b32 v226, 16, v143
  v_and_b32 v227, 0xffff0000, v143
  buffer_store_dwordx4 v[128:131], v251, s[76:79], s66 offen offset:2048 sc1
  s_add_u32 s53, s53, 1
  s_cmp_eq_u32 s53, 9
  s_cselect_b32 s53, 0, s53
  v_mfma_f32_16x16x32_bf16 v[212:215], v[240:243], v[92:95], v[212:215]
  ds_read_b64_tr_b16 v[240:241], v253 offset:12288
  s_waitcnt lgkmcnt(5)
  v_mfma_f32_16x16x32_bf16 v[216:219], v[228:231], v[0:3], v[216:219]
  ds_read_b64_tr_b16 v[242:243], v253 offset:14336
  v_mfma_f32_16x16x32_bf16 v[220:223], v[228:231], v[32:35], v[220:223]
  s_barrier
  v_mfma_f32_16x16x32_bf16 v[224:227], v[228:231], v[64:67], v[224:227]
  ds_read_b64_tr_b16 v[228:229], v253 offset:16384
  s_waitcnt lgkmcnt(5)
  v_mfma_f32_16x16x32_bf16 v[216:219], v[232:235], v[4:7], v[216:219]
  ds_read_b64_tr_b16 v[230:231], v253 offset:18432
  v_cvt_pk_bf16_f32 v132, v204, v205
  v_mfma_f32_16x16x32_bf16 v[220:223], v[232:235], v[36:39], v[220:223]
  v_cvt_pk_bf16_f32 v133, v206, v207
  v_cvt_pk_bf16_f32 v136, v208, v209
  v_mfma_f32_16x16x32_bf16 v[224:227], v[232:235], v[68:71], v[224:227]
  ds_read_b64_tr_b16 v[232:233], v253 offset:20480
  s_waitcnt lgkmcnt(5)
  v_mfma_f32_16x16x32_bf16 v[216:219], v[236:239], v[8:11], v[216:219]
  ds_read_b64_tr_b16 v[234:235], v253 offset:22528
  v_cvt_pk_bf16_f32 v137, v210, v211
  v_mfma_f32_16x16x32_bf16 v[220:223], v[236:239], v[40:43], v[220:223]
  v_cvt_pk_bf16_f32 v140, v212, v213
  v_cvt_pk_bf16_f32 v141, v214, v215
  v_mfma_f32_16x16x32_bf16 v[224:227], v[236:239], v[72:75], v[224:227]
  ds_read_b64_tr_b16 v[236:237], v253 offset:24576
  s_waitcnt lgkmcnt(5)
  v_mfma_f32_16x16x32_bf16 v[216:219], v[240:243], v[12:15], v[216:219]
  ds_read_b64_tr_b16 v[238:239], v253 offset:26624
  v_lshlrev_b32 v204, 16, v144
  v_mfma_f32_16x16x32_bf16 v[220:223], v[240:243], v[44:47], v[220:223]
  v_and_b32 v205, 0xffff0000, v144
  v_lshlrev_b32 v206, 16, v145
  v_mfma_f32_16x16x32_bf16 v[224:227], v[240:243], v[76:79], v[224:227]
  ds_read_b64_tr_b16 v[240:241], v253 offset:28672
  s_waitcnt lgkmcnt(5)
  v_mfma_f32_16x16x32_bf16 v[216:219], v[228:231], v[16:19], v[216:219]
  ds_read_b64_tr_b16 v[242:243], v253 offset:30720
  v_and_b32 v207, 0xffff0000, v145
  v_mfma_f32_16x16x32_bf16 v[220:223], v[228:231], v[48:51], v[220:223]
  v_lshlrev_b32 v208, 16, v148
  v_and_b32 v209, 0xffff0000, v148
  v_mfma_f32_16x16x32_bf16 v[224:227], v[228:231], v[80:83], v[224:227]
  v_add_u32 v245, 32768, v245
  ds_read_b64_tr_b16 v[228:229], v245 offset:0
  s_waitcnt lgkmcnt(5)
  v_mfma_f32_16x16x32_bf16 v[216:219], v[232:235], v[20:23], v[216:219]
  ds_read_b64_tr_b16 v[230:231], v245 offset:2048
  v_lshlrev_b32 v210, 16, v149
  v_mfma_f32_16x16x32_bf16 v[220:223], v[232:235], v[52:55], v[220:223]
  v_and_b32 v211, 0xffff0000, v149
  v_lshlrev_b32 v212, 16, v152
  v_mfma_f32_16x16x32_bf16 v[224:227], v[232:235], v[84:87], v[224:227]
  ds_read_b64_tr_b16 v[232:233], v245 offset:4096
  s_waitcnt lgkmcnt(5)
  v_mfma_f32_16x16x32_bf16 v[216:219], v[236:239], v[24:27], v[216:219]
  ds_read_b64_tr_b16 v[234:235], v245 offset:6144
  v_and_b32 v213, 0xffff0000, v152
  v_mfma_f32_16x16x32_bf16 v[220:223], v[236:239], v[56:59], v[220:223]
  v_lshlrev_b32 v214, 16, v153
  v_and_b32 v215, 0xffff0000, v153
  v_mfma_f32_16x16x32_bf16 v[224:227], v[236:239], v[88:91], v[224:227]
  ds_read_b64_tr_b16 v[236:237], v245 offset:8192
  s_waitcnt lgkmcnt(5)
  v_mfma_f32_16x16x32_bf16 v[216:219], v[240:243], v[28:31], v[216:219]
  ds_read_b64_tr_b16 v[238:239], v245 offset:10240
  v_mfma_f32_16x16x32_bf16 v[220:223], v[240:243], v[60:63], v[220:223]
  v_mfma_f32_16x16x32_bf16 v[224:227], v[240:243], v[92:95], v[224:227]
  ds_read_b64_tr_b16 v[240:241], v245 offset:12288
  s_waitcnt lgkmcnt(5)
  v_mfma_f32_16x16x32_bf16 v[204:207], v[228:231], v[0:3], v[204:207]
  ds_read_b64_tr_b16 v[242:243], v245 offset:14336
  v_mfma_f32_16x16x32_bf16 v[208:211], v[228:231], v[32:35], v[208:211]
  v_mfma_f32_16x16x32_bf16 v[212:215], v[228:231], v[64:67], v[212:215]
  ds_read_b64_tr_b16 v[228:229], v245 offset:16384
  s_waitcnt lgkmcnt(5)
  v_mfma_f32_16x16x32_bf16 v[204:207], v[232:235], v[4:7], v[204:207]
  ds_read_b64_tr_b16 v[230:231], v245 offset:18432
  v_cvt_pk_bf16_f32 v134, v216, v217
  v_mfma_f32_16x16x32_bf16 v[208:211], v[232:235], v[36:39], v[208:211]
  v_cvt_pk_bf16_f32 v135, v218, v219
  v_cvt_pk_bf16_f32 v138, v220, v221
  v_mfma_f32_16x16x32_bf16 v[212:215], v[232:235], v[68:71], v[212:215]
  ds_read_b64_tr_b16 v[232:233], v245 offset:20480
  s_waitcnt lgkmcnt(5)
  v_mfma_f32_16x16x32_bf16 v[204:207], v[236:239], v[8:11], v[204:207]
  ds_read_b64_tr_b16 v[234:235], v245 offset:22528
  v_cvt_pk_bf16_f32 v139, v222, v223
  v_mfma_f32_16x16x32_bf16 v[208:211], v[236:239], v[40:43], v[208:211]
  v_cvt_pk_bf16_f32 v142, v224, v225
  v_cvt_pk_bf16_f32 v143, v226, v227
  v_mfma_f32_16x16x32_bf16 v[212:215], v[236:239], v[72:75], v[212:215]
  ds_read_b64_tr_b16 v[236:237], v245 offset:24576
  s_waitcnt lgkmcnt(5)
  v_mfma_f32_16x16x32_bf16 v[204:207], v[240:243], v[12:15], v[204:207]
  ds_read_b64_tr_b16 v[238:239], v245 offset:26624
  v_permlane16_swap_b32 v132, v134
  v_mfma_f32_16x16x32_bf16 v[208:211], v[240:243], v[44:47], v[208:211]
  v_permlane16_swap_b32 v133, v135
  v_permlane16_swap_b32 v136, v138
  v_mfma_f32_16x16x32_bf16 v[212:215], v[240:243], v[76:79], v[212:215]
  ds_read_b64_tr_b16 v[240:241], v245 offset:28672
  s_waitcnt lgkmcnt(5)
  v_mfma_f32_16x16x32_bf16 v[204:207], v[228:231], v[16:19], v[204:207]
  ds_read_b64_tr_b16 v[242:243], v245 offset:30720
  v_permlane16_swap_b32 v137, v139
  v_mfma_f32_16x16x32_bf16 v[208:211], v[228:231], v[48:51], v[208:211]
  v_permlane16_swap_b32 v140, v142
  v_permlane16_swap_b32 v141, v143
  v_mfma_f32_16x16x32_bf16 v[212:215], v[228:231], v[80:83], v[212:215]
  v_add_u32 v253, 32768, v253
  ds_read_b64_tr_b16 v[228:229], v253 offset:0
  s_waitcnt lgkmcnt(5)
  v_mfma_f32_16x16x32_bf16 v[204:207], v[232:235], v[20:23], v[204:207]
  ds_read_b64_tr_b16 v[230:231], v253 offset:2048
  v_lshlrev_b32 v216, 16, v146
  v_and_b32 v217, 0xffff0000, v146
  v_mfma_f32_16x16x32_bf16 v[208:211], v[232:235], v[52:55], v[208:211]
  v_lshlrev_b32 v218, 16, v147
  v_and_b32 v219, 0xffff0000, v147
  s_mul_i32 s66, s53, 12288
  s_add_u32 s66, s66, s65
  buffer_store_dwordx4 v[132:135], v251, s[76:79], s66 offen offset:0 sc1
  v_mfma_f32_16x16x32_bf16 v[212:215], v[232:235], v[84:87], v[212:215]
  ds_read_b64_tr_b16 v[232:233], v253 offset:4096
  s_waitcnt lgkmcnt(5)
  v_mfma_f32_16x16x32_bf16 v[204:207], v[236:239], v[24:27], v[204:207]
  ds_read_b64_tr_b16 v[234:235], v253 offset:6144
  v_lshlrev_b32 v220, 16, v150
  v_and_b32 v221, 0xffff0000, v150
  v_mfma_f32_16x16x32_bf16 v[208:211], v[236:239], v[56:59], v[208:211]
  v_lshlrev_b32 v222, 16, v151
  v_and_b32 v223, 0xffff0000, v151
  buffer_store_dwordx4 v[136:139], v251, s[76:79], s66 offen offset:1024 sc1
  v_mfma_f32_16x16x32_bf16 v[212:215], v[236:239], v[88:91], v[212:215]
  ds_read_b64_tr_b16 v[236:237], v253 offset:8192
  s_waitcnt lgkmcnt(5)
  v_mfma_f32_16x16x32_bf16 v[204:207], v[240:243], v[28:31], v[204:207]
  ds_read_b64_tr_b16 v[238:239], v253 offset:10240
  v_lshlrev_b32 v224, 16, v154
  v_and_b32 v225, 0xffff0000, v154
  v_mfma_f32_16x16x32_bf16 v[208:211], v[240:243], v[60:63], v[208:211]
  v_lshlrev_b32 v226, 16, v155
  v_and_b32 v227, 0xffff0000, v155
  buffer_store_dwordx4 v[140:143], v251, s[76:79], s66 offen offset:2048 sc1
  s_add_u32 s53, s53, 1
  s_cmp_eq_u32 s53, 9
  s_cselect_b32 s53, 0, s53
  v_mfma_f32_16x16x32_bf16 v[212:215], v[240:243], v[92:95], v[212:215]
  ds_read_b64_tr_b16 v[240:241], v253 offset:12288
  s_waitcnt lgkmcnt(5)
  v_mfma_f32_16x16x32_bf16 v[216:219], v[228:231], v[0:3], v[216:219]
  ds_read_b64_tr_b16 v[242:243], v253 offset:14336
  v_mfma_f32_16x16x32_bf16 v[220:223], v[228:231], v[32:35], v[220:223]
  s_barrier
  v_mfma_f32_16x16x32_bf16 v[224:227], v[228:231], v[64:67], v[224:227]
  ds_read_b64_tr_b16 v[228:229], v253 offset:16384
  s_waitcnt lgkmcnt(5)
  v_mfma_f32_16x16x32_bf16 v[216:219], v[232:235], v[4:7], v[216:219]
  ds_read_b64_tr_b16 v[230:231], v253 offset:18432
  v_cvt_pk_bf16_f32 v144, v204, v205
  v_mfma_f32_16x16x32_bf16 v[220:223], v[232:235], v[36:39], v[220:223]
  v_cvt_pk_bf16_f32 v145, v206, v207
  v_cvt_pk_bf16_f32 v148, v208, v209
  v_mfma_f32_16x16x32_bf16 v[224:227], v[232:235], v[68:71], v[224:227]
  ds_read_b64_tr_b16 v[232:233], v253 offset:20480
  s_waitcnt lgkmcnt(5)
  v_mfma_f32_16x16x32_bf16 v[216:219], v[236:239], v[8:11], v[216:219]
  ds_read_b64_tr_b16 v[234:235], v253 offset:22528
  v_cvt_pk_bf16_f32 v149, v210, v211
  v_mfma_f32_16x16x32_bf16 v[220:223], v[236:239], v[40:43], v[220:223]
  v_cvt_pk_bf16_f32 v152, v212, v213
  v_cvt_pk_bf16_f32 v153, v214, v215
  v_mfma_f32_16x16x32_bf16 v[224:227], v[236:239], v[72:75], v[224:227]
  ds_read_b64_tr_b16 v[236:237], v253 offset:24576
  s_waitcnt lgkmcnt(5)
  v_mfma_f32_16x16x32_bf16 v[216:219], v[240:243], v[12:15], v[216:219]
  ds_read_b64_tr_b16 v[238:239], v253 offset:26624
  v_lshlrev_b32 v204, 16, v156
  v_mfma_f32_16x16x32_bf16 v[220:223], v[240:243], v[44:47], v[220:223]
  v_and_b32 v205, 0xffff0000, v156
  v_lshlrev_b32 v206, 16, v157
  v_mfma_f32_16x16x32_bf16 v[224:227], v[240:243], v[76:79], v[224:227]
  ds_read_b64_tr_b16 v[240:241], v253 offset:28672
  s_waitcnt lgkmcnt(5)
  v_mfma_f32_16x16x32_bf16 v[216:219], v[228:231], v[16:19], v[216:219]
  ds_read_b64_tr_b16 v[242:243], v253 offset:30720
  v_and_b32 v207, 0xffff0000, v157
  v_mfma_f32_16x16x32_bf16 v[220:223], v[228:231], v[48:51], v[220:223]
  v_lshlrev_b32 v208, 16, v160
  v_and_b32 v209, 0xffff0000, v160
  v_mfma_f32_16x16x32_bf16 v[224:227], v[228:231], v[80:83], v[224:227]
  v_add_u32 v245, 32768, v245
  ds_read_b64_tr_b16 v[228:229], v245 offset:0
  s_waitcnt lgkmcnt(5)
  v_mfma_f32_16x16x32_bf16 v[216:219], v[232:235], v[20:23], v[216:219]
  ds_read_b64_tr_b16 v[230:231], v245 offset:2048
  v_lshlrev_b32 v210, 16, v161
  v_mfma_f32_16x16x32_bf16 v[220:223], v[232:235], v[52:55], v[220:223]
  v_and_b32 v211, 0xffff0000, v161
  v_lshlrev_b32 v212, 16, v164
  v_mfma_f32_16x16x32_bf16 v[224:227], v[232:235], v[84:87], v[224:227]
  ds_read_b64_tr_b16 v[232:233], v245 offset:4096
  s_waitcnt lgkmcnt(5)
  v_mfma_f32_16x16x32_bf16 v[216:219], v[236:239], v[24:27], v[216:219]
  ds_read_b64_tr_b16 v[234:235], v245 offset:6144
  v_and_b32 v213, 0xffff0000, v164
  v_mfma_f32_16x16x32_bf16 v[220:223], v[236:239], v[56:59], v[220:223]
  v_lshlrev_b32 v214, 16, v165
  v_and_b32 v215, 0xffff0000, v165
  v_mfma_f32_16x16x32_bf16 v[224:227], v[236:239], v[88:91], v[224:227]
  ds_read_b64_tr_b16 v[236:237], v245 offset:8192
  s_waitcnt lgkmcnt(5)
  v_mfma_f32_16x16x32_bf16 v[216:219], v[240:243], v[28:31], v[216:219]
  ds_read_b64_tr_b16 v[238:239], v245 offset:10240
  v_mfma_f32_16x16x32_bf16 v[220:223], v[240:243], v[60:63], v[220:223]
  v_mfma_f32_16x16x32_bf16 v[224:227], v[240:243], v[92:95], v[224:227]
  ds_read_b64_tr_b16 v[240:241], v245 offset:12288
  s_waitcnt lgkmcnt(5)
  v_mfma_f32_16x16x32_bf16 v[204:207], v[228:231], v[0:3], v[204:207]
  ds_read_b64_tr_b16 v[242:243], v245 offset:14336
  v_mfma_f32_16x16x32_bf16 v[208:211], v[228:231], v[32:35], v[208:211]
  v_mfma_f32_16x16x32_bf16 v[212:215], v[228:231], v[64:67], v[212:215]
  ds_read_b64_tr_b16 v[228:229], v245 offset:16384
  s_waitcnt lgkmcnt(5)
  v_mfma_f32_16x16x32_bf16 v[204:207], v[232:235], v[4:7], v[204:207]
  ds_read_b64_tr_b16 v[230:231], v245 offset:18432
  v_cvt_pk_bf16_f32 v146, v216, v217
  v_mfma_f32_16x16x32_bf16 v[208:211], v[232:235], v[36:39], v[208:211]
  v_cvt_pk_bf16_f32 v147, v218, v219
  v_cvt_pk_bf16_f32 v150, v220, v221
  v_mfma_f32_16x16x32_bf16 v[212:215], v[232:235], v[68:71], v[212:215]
  ds_read_b64_tr_b16 v[232:233], v245 offset:20480
  s_waitcnt lgkmcnt(5)
  v_mfma_f32_16x16x32_bf16 v[204:207], v[236:239], v[8:11], v[204:207]
  ds_read_b64_tr_b16 v[234:235], v245 offset:22528
  v_cvt_pk_bf16_f32 v151, v222, v223
  v_mfma_f32_16x16x32_bf16 v[208:211], v[236:239], v[40:43], v[208:211]
  v_cvt_pk_bf16_f32 v154, v224, v225
  v_cvt_pk_bf16_f32 v155, v226, v227
  v_mfma_f32_16x16x32_bf16 v[212:215], v[236:239], v[72:75], v[212:215]
  ds_read_b64_tr_b16 v[236:237], v245 offset:24576
  s_waitcnt lgkmcnt(5)
  v_mfma_f32_16x16x32_bf16 v[204:207], v[240:243], v[12:15], v[204:207]
  ds_read_b64_tr_b16 v[238:239], v245 offset:26624
  v_permlane16_swap_b32 v144, v146
  v_mfma_f32_16x16x32_bf16 v[208:211], v[240:243], v[44:47], v[208:211]
  v_permlane16_swap_b32 v145, v147
  v_permlane16_swap_b32 v148, v150
  v_mfma_f32_16x16x32_bf16 v[212:215], v[240:243], v[76:79], v[212:215]
  ds_read_b64_tr_b16 v[240:241], v245 offset:28672
  s_waitcnt lgkmcnt(5)
  v_mfma_f32_16x16x32_bf16 v[204:207], v[228:231], v[16:19], v[204:207]
  ds_read_b64_tr_b16 v[242:243], v245 offset:30720
  v_permlane16_swap_b32 v149, v151
  v_mfma_f32_16x16x32_bf16 v[208:211], v[228:231], v[48:51], v[208:211]
  v_permlane16_swap_b32 v152, v154
  v_permlane16_swap_b32 v153, v155
  v_mfma_f32_16x16x32_bf16 v[212:215], v[228:231], v[80:83], v[212:215]
  v_add_u32 v253, 32768, v253
  ds_read_b64_tr_b16 v[228:229], v253 offset:0
  s_waitcnt lgkmcnt(5)
  v_mfma_f32_16x16x32_bf16 v[204:207], v[232:235], v[20:23], v[204:207]
  ds_read_b64_tr_b16 v[230:231], v253 offset:2048
  v_lshlrev_b32 v216, 16, v158
  v_and_b32 v217, 0xffff0000, v158
  v_mfma_f32_16x16x32_bf16 v[208:211], v[232:235], v[52:55], v[208:211]
  v_lshlrev_b32 v218, 16, v159
  v_and_b32 v219, 0xffff0000, v159
  s_mul_i32 s66, s53, 12288
  s_add_u32 s66, s66, s65
  buffer_store_dwordx4 v[144:147], v251, s[76:79], s66 offen offset:0 sc1
  v_mfma_f32_16x16x32_bf16 v[212:215], v[232:235], v[84:87], v[212:215]
  ds_read_b64_tr_b16 v[232:233], v253 offset:4096
  s_waitcnt lgkmcnt(5)
  v_mfma_f32_16x16x32_bf16 v[204:207], v[236:239], v[24:27], v[204:207]
  ds_read_b64_tr_b16 v[234:235], v253 offset:6144
  v_lshlrev_b32 v220, 16, v162
  v_and_b32 v221, 0xffff0000, v162
  v_mfma_f32_16x16x32_bf16 v[208:211], v[236:239], v[56:59], v[208:211]
  v_lshlrev_b32 v222, 16, v163
  v_and_b32 v223, 0xffff0000, v163
  buffer_store_dwordx4 v[148:151], v251, s[76:79], s66 offen offset:1024 sc1
  v_mfma_f32_16x16x32_bf16 v[212:215], v[236:239], v[88:91], v[212:215]
  ds_read_b64_tr_b16 v[236:237], v253 offset:8192
  s_waitcnt lgkmcnt(5)
  v_mfma_f32_16x16x32_bf16 v[204:207], v[240:243], v[28:31], v[204:207]
  ds_read_b64_tr_b16 v[238:239], v253 offset:10240
  v_lshlrev_b32 v224, 16, v166
  v_and_b32 v225, 0xffff0000, v166
  v_mfma_f32_16x16x32_bf16 v[208:211], v[240:243], v[60:63], v[208:211]
  v_lshlrev_b32 v226, 16, v167
  v_and_b32 v227, 0xffff0000, v167
  buffer_store_dwordx4 v[152:155], v251, s[76:79], s66 offen offset:2048 sc1
  s_add_u32 s53, s53, 1
  s_cmp_eq_u32 s53, 9
  s_cselect_b32 s53, 0, s53
  v_mfma_f32_16x16x32_bf16 v[212:215], v[240:243], v[92:95], v[212:215]
  ds_read_b64_tr_b16 v[240:241], v253 offset:12288
  s_waitcnt lgkmcnt(5)
  v_mfma_f32_16x16x32_bf16 v[216:219], v[228:231], v[0:3], v[216:219]
  ds_read_b64_tr_b16 v[242:243], v253 offset:14336
  v_mfma_f32_16x16x32_bf16 v[220:223], v[228:231], v[32:35], v[220:223]
  s_barrier
  v_mfma_f32_16x16x32_bf16 v[224:227], v[228:231], v[64:67], v[224:227]
  ds_read_b64_tr_b16 v[228:229], v253 offset:16384
  s_waitcnt lgkmcnt(5)
  v_mfma_f32_16x16x32_bf16 v[216:219], v[232:235], v[4:7], v[216:219]
  ds_read_b64_tr_b16 v[230:231], v253 offset:18432
  v_cvt_pk_bf16_f32 v156, v204, v205
  v_mfma_f32_16x16x32_bf16 v[220:223], v[232:235], v[36:39], v[220:223]
  v_cvt_pk_bf16_f32 v157, v206, v207
  v_cvt_pk_bf16_f32 v160, v208, v209
  v_mfma_f32_16x16x32_bf16 v[224:227], v[232:235], v[68:71], v[224:227]
  ds_read_b64_tr_b16 v[232:233], v253 offset:20480
  s_waitcnt lgkmcnt(5)
  v_mfma_f32_16x16x32_bf16 v[216:219], v[236:239], v[8:11], v[216:219]
  ds_read_b64_tr_b16 v[234:235], v253 offset:22528
  v_cvt_pk_bf16_f32 v161, v210, v211
  v_mfma_f32_16x16x32_bf16 v[220:223], v[236:239], v[40:43], v[220:223]
  v_cvt_pk_bf16_f32 v164, v212, v213
  v_cvt_pk_bf16_f32 v165, v214, v215
  v_mfma_f32_16x16x32_bf16 v[224:227], v[236:239], v[72:75], v[224:227]
  ds_read_b64_tr_b16 v[236:237], v253 offset:24576
  s_waitcnt lgkmcnt(5)
  v_mfma_f32_16x16x32_bf16 v[216:219], v[240:243], v[12:15], v[216:219]
  ds_read_b64_tr_b16 v[238:239], v253 offset:26624
  v_lshlrev_b32 v204, 16, v168
  v_mfma_f32_16x16x32_bf16 v[220:223], v[240:243], v[44:47], v[220:223]
  v_and_b32 v205, 0xffff0000, v168
  v_lshlrev_b32 v206, 16, v169
  v_mfma_f32_16x16x32_bf16 v[224:227], v[240:243], v[76:79], v[224:227]
  ds_read_b64_tr_b16 v[240:241], v253 offset:28672
  s_waitcnt lgkmcnt(5)
  v_mfma_f32_16x16x32_bf16 v[216:219], v[228:231], v[16:19], v[216:219]
  ds_read_b64_tr_b16 v[242:243], v253 offset:30720
  v_and_b32 v207, 0xffff0000, v169
  v_mfma_f32_16x16x32_bf16 v[220:223], v[228:231], v[48:51], v[220:223]
  v_lshlrev_b32 v208, 16, v172
  v_and_b32 v209, 0xffff0000, v172
  v_mfma_f32_16x16x32_bf16 v[224:227], v[228:231], v[80:83], v[224:227]
  v_add_u32 v245, 32768, v245
  ds_read_b64_tr_b16 v[228:229], v245 offset:0
  s_waitcnt lgkmcnt(5)
  v_mfma_f32_16x16x32_bf16 v[216:219], v[232:235], v[20:23], v[216:219]
  ds_read_b64_tr_b16 v[230:231], v245 offset:2048
  v_lshlrev_b32 v210, 16, v173
  v_mfma_f32_16x16x32_bf16 v[220:223], v[232:235], v[52:55], v[220:223]
  v_and_b32 v211, 0xffff0000, v173
  v_lshlrev_b32 v212, 16, v176
  v_mfma_f32_16x16x32_bf16 v[224:227], v[232:235], v[84:87], v[224:227]
  ds_read_b64_tr_b16 v[232:233], v245 offset:4096
  s_waitcnt lgkmcnt(5)
  v_mfma_f32_16x16x32_bf16 v[216:219], v[236:239], v[24:27], v[216:219]
  ds_read_b64_tr_b16 v[234:235], v245 offset:6144
  v_and_b32 v213, 0xffff0000, v176
  v_mfma_f32_16x16x32_bf16 v[220:223], v[236:239], v[56:59], v[220:223]
  v_lshlrev_b32 v214, 16, v177
  v_and_b32 v215, 0xffff0000, v177
  v_mfma_f32_16x16x32_bf16 v[224:227], v[236:239], v[88:91], v[224:227]
  ds_read_b64_tr_b16 v[236:237], v245 offset:8192
  s_waitcnt lgkmcnt(5)
  v_mfma_f32_16x16x32_bf16 v[216:219], v[240:243], v[28:31], v[216:219]
  ds_read_b64_tr_b16 v[238:239], v245 offset:10240
  v_mfma_f32_16x16x32_bf16 v[220:223], v[240:243], v[60:63], v[220:223]
  v_mfma_f32_16x16x32_bf16 v[224:227], v[240:243], v[92:95], v[224:227]
  ds_read_b64_tr_b16 v[240:241], v245 offset:12288
  s_waitcnt lgkmcnt(5)
  v_mfma_f32_16x16x32_bf16 v[204:207], v[228:231], v[0:3], v[204:207]
  ds_read_b64_tr_b16 v[242:243], v245 offset:14336
  v_mfma_f32_16x16x32_bf16 v[208:211], v[228:231], v[32:35], v[208:211]
  v_mfma_f32_16x16x32_bf16 v[212:215], v[228:231], v[64:67], v[212:215]
  ds_read_b64_tr_b16 v[228:229], v245 offset:16384
  s_waitcnt lgkmcnt(5)
  v_mfma_f32_16x16x32_bf16 v[204:207], v[232:235], v[4:7], v[204:207]
  ds_read_b64_tr_b16 v[230:231], v245 offset:18432
  v_cvt_pk_bf16_f32 v158, v216, v217
  v_mfma_f32_16x16x32_bf16 v[208:211], v[232:235], v[36:39], v[208:211]
  v_cvt_pk_bf16_f32 v159, v218, v219
  v_cvt_pk_bf16_f32 v162, v220, v221
  v_mfma_f32_16x16x32_bf16 v[212:215], v[232:235], v[68:71], v[212:215]
  ds_read_b64_tr_b16 v[232:233], v245 offset:20480
  s_waitcnt lgkmcnt(5)
  v_mfma_f32_16x16x32_bf16 v[204:207], v[236:239], v[8:11], v[204:207]
  ds_read_b64_tr_b16 v[234:235], v245 offset:22528
  v_cvt_pk_bf16_f32 v163, v222, v223
  v_mfma_f32_16x16x32_bf16 v[208:211], v[236:239], v[40:43], v[208:211]
  v_cvt_pk_bf16_f32 v166, v224, v225
  v_cvt_pk_bf16_f32 v167, v226, v227
  v_mfma_f32_16x16x32_bf16 v[212:215], v[236:239], v[72:75], v[212:215]
  ds_read_b64_tr_b16 v[236:237], v245 offset:24576
  s_waitcnt lgkmcnt(5)
  v_mfma_f32_16x16x32_bf16 v[204:207], v[240:243], v[12:15], v[204:207]
  ds_read_b64_tr_b16 v[238:239], v245 offset:26624
  v_permlane16_swap_b32 v156, v158
  v_mfma_f32_16x16x32_bf16 v[208:211], v[240:243], v[44:47], v[208:211]
  v_permlane16_swap_b32 v157, v159
  v_permlane16_swap_b32 v160, v162
  v_mfma_f32_16x16x32_bf16 v[212:215], v[240:243], v[76:79], v[212:215]
  ds_read_b64_tr_b16 v[240:241], v245 offset:28672
  s_waitcnt lgkmcnt(5)
  v_mfma_f32_16x16x32_bf16 v[204:207], v[228:231], v[16:19], v[204:207]
  ds_read_b64_tr_b16 v[242:243], v245 offset:30720
  v_permlane16_swap_b32 v161, v163
  v_mfma_f32_16x16x32_bf16 v[208:211], v[228:231], v[48:51], v[208:211]
  v_permlane16_swap_b32 v164, v166
  v_permlane16_swap_b32 v165, v167
  v_mfma_f32_16x16x32_bf16 v[212:215], v[228:231], v[80:83], v[212:215]
  v_add_u32 v253, 32768, v253
  ds_read_b64_tr_b16 v[228:229], v253 offset:0
  s_waitcnt lgkmcnt(5)
  v_mfma_f32_16x16x32_bf16 v[204:207], v[232:235], v[20:23], v[204:207]
  ds_read_b64_tr_b16 v[230:231], v253 offset:2048
  v_lshlrev_b32 v216, 16, v170
  v_and_b32 v217, 0xffff0000, v170
  v_mfma_f32_16x16x32_bf16 v[208:211], v[232:235], v[52:55], v[208:211]
  v_lshlrev_b32 v218, 16, v171
  v_and_b32 v219, 0xffff0000, v171
  s_mul_i32 s66, s53, 12288
  s_add_u32 s66, s66, s65
  buffer_store_dwordx4 v[156:159], v251, s[76:79], s66 offen offset:0 sc1
  v_mfma_f32_16x16x32_bf16 v[212:215], v[232:235], v[84:87], v[212:215]
  ds_read_b64_tr_b16 v[232:233], v253 offset:4096
  s_waitcnt lgkmcnt(5)
  v_mfma_f32_16x16x32_bf16 v[204:207], v[236:239], v[24:27], v[204:207]
  ds_read_b64_tr_b16 v[234:235], v253 offset:6144
  v_lshlrev_b32 v220, 16, v174
  v_and_b32 v221, 0xffff0000, v174
  v_mfma_f32_16x16x32_bf16 v[208:211], v[236:239], v[56:59], v[208:211]
  v_lshlrev_b32 v222, 16, v175
  v_and_b32 v223, 0xffff0000, v175
  buffer_store_dwordx4 v[160:163], v251, s[76:79], s66 offen offset:1024 sc1
  v_mfma_f32_16x16x32_bf16 v[212:215], v[236:239], v[88:91], v[212:215]
  ds_read_b64_tr_b16 v[236:237], v253 offset:8192
  s_waitcnt lgkmcnt(5)
  v_mfma_f32_16x16x32_bf16 v[204:207], v[240:243], v[28:31], v[204:207]
  ds_read_b64_tr_b16 v[238:239], v253 offset:10240
  v_lshlrev_b32 v224, 16, v178
  v_and_b32 v225, 0xffff0000, v178
  v_mfma_f32_16x16x32_bf16 v[208:211], v[240:243], v[60:63], v[208:211]
  v_lshlrev_b32 v226, 16, v179
  v_and_b32 v227, 0xffff0000, v179
  buffer_store_dwordx4 v[164:167], v251, s[76:79], s66 offen offset:2048 sc1
  s_add_u32 s53, s53, 1
  s_cmp_eq_u32 s53, 9
  s_cselect_b32 s53, 0, s53
  v_mfma_f32_16x16x32_bf16 v[212:215], v[240:243], v[92:95], v[212:215]
  ds_read_b64_tr_b16 v[240:241], v253 offset:12288
  s_waitcnt lgkmcnt(5)
  v_mfma_f32_16x16x32_bf16 v[216:219], v[228:231], v[0:3], v[216:219]
  ds_read_b64_tr_b16 v[242:243], v253 offset:14336
  v_mfma_f32_16x16x32_bf16 v[220:223], v[228:231], v[32:35], v[220:223]
  s_barrier
  v_mfma_f32_16x16x32_bf16 v[224:227], v[228:231], v[64:67], v[224:227]
  ds_read_b64_tr_b16 v[228:229], v253 offset:16384
  s_waitcnt lgkmcnt(5)
  v_mfma_f32_16x16x32_bf16 v[216:219], v[232:235], v[4:7], v[216:219]
  ds_read_b64_tr_b16 v[230:231], v253 offset:18432
  v_cvt_pk_bf16_f32 v168, v204, v205
  v_mfma_f32_16x16x32_bf16 v[220:223], v[232:235], v[36:39], v[220:223]
  v_cvt_pk_bf16_f32 v169, v206, v207
  v_cvt_pk_bf16_f32 v172, v208, v209
  v_mfma_f32_16x16x32_bf16 v[224:227], v[232:235], v[68:71], v[224:227]
  ds_read_b64_tr_b16 v[232:233], v253 offset:20480
  s_waitcnt lgkmcnt(5)
  v_mfma_f32_16x16x32_bf16 v[216:219], v[236:239], v[8:11], v[216:219]
  ds_read_b64_tr_b16 v[234:235], v253 offset:22528
  v_cvt_pk_bf16_f32 v173, v210, v211
  v_mfma_f32_16x16x32_bf16 v[220:223], v[236:239], v[40:43], v[220:223]
  v_cvt_pk_bf16_f32 v176, v212, v213
  v_cvt_pk_bf16_f32 v177, v214, v215
  v_mfma_f32_16x16x32_bf16 v[224:227], v[236:239], v[72:75], v[224:227]
  ds_read_b64_tr_b16 v[236:237], v253 offset:24576
  s_waitcnt lgkmcnt(5)
  v_mfma_f32_16x16x32_bf16 v[216:219], v[240:243], v[12:15], v[216:219]
  ds_read_b64_tr_b16 v[238:239], v253 offset:26624
  v_lshlrev_b32 v204, 16, v180
  v_mfma_f32_16x16x32_bf16 v[220:223], v[240:243], v[44:47], v[220:223]
  v_and_b32 v205, 0xffff0000, v180
  v_lshlrev_b32 v206, 16, v181
  v_mfma_f32_16x16x32_bf16 v[224:227], v[240:243], v[76:79], v[224:227]
  ds_read_b64_tr_b16 v[240:241], v253 offset:28672
  s_waitcnt lgkmcnt(5)
  v_mfma_f32_16x16x32_bf16 v[216:219], v[228:231], v[16:19], v[216:219]
  ds_read_b64_tr_b16 v[242:243], v253 offset:30720
  v_and_b32 v207, 0xffff0000, v181
  v_mfma_f32_16x16x32_bf16 v[220:223], v[228:231], v[48:51], v[220:223]
  v_lshlrev_b32 v208, 16, v184
  v_and_b32 v209, 0xffff0000, v184
  v_mfma_f32_16x16x32_bf16 v[224:227], v[228:231], v[80:83], v[224:227]
  v_add_u32 v245, 4294868992, v245
  ds_read_b64_tr_b16 v[228:229], v245 offset:0
  s_waitcnt lgkmcnt(5)
  v_mfma_f32_16x16x32_bf16 v[216:219], v[232:235], v[20:23], v[216:219]
  ds_read_b64_tr_b16 v[230:231], v245 offset:2048
  v_lshlrev_b32 v210, 16, v185
  v_mfma_f32_16x16x32_bf16 v[220:223], v[232:235], v[52:55], v[220:223]
  v_and_b32 v211, 0xffff0000, v185
  v_lshlrev_b32 v212, 16, v188
  v_mfma_f32_16x16x32_bf16 v[224:227], v[232:235], v[84:87], v[224:227]
  ds_read_b64_tr_b16 v[232:233], v245 offset:4096
  s_waitcnt lgkmcnt(5)
  v_mfma_f32_16x16x32_bf16 v[216:219], v[236:239], v[24:27], v[216:219]
  ds_read_b64_tr_b16 v[234:235], v245 offset:6144
  v_and_b32 v213, 0xffff0000, v188
  v_mfma_f32_16x16x32_bf16 v[220:223], v[236:239], v[56:59], v[220:223]
  v_lshlrev_b32 v214, 16, v189
  v_and_b32 v215, 0xffff0000, v189
  v_mfma_f32_16x16x32_bf16 v[224:227], v[236:239], v[88:91], v[224:227]
  ds_read_b64_tr_b16 v[236:237], v245 offset:8192
  s_waitcnt lgkmcnt(5)
  v_mfma_f32_16x16x32_bf16 v[216:219], v[240:243], v[28:31], v[216:219]
  ds_read_b64_tr_b16 v[238:239], v245 offset:10240
  v_mfma_f32_16x16x32_bf16 v[220:223], v[240:243], v[60:63], v[220:223]
  v_mfma_f32_16x16x32_bf16 v[224:227], v[240:243], v[92:95], v[224:227]
  ds_read_b64_tr_b16 v[240:241], v245 offset:12288
  s_waitcnt lgkmcnt(5)
  v_mfma_f32_16x16x32_bf16 v[204:207], v[228:231], v[0:3], v[204:207]
  ds_read_b64_tr_b16 v[242:243], v245 offset:14336
  v_mfma_f32_16x16x32_bf16 v[208:211], v[228:231], v[32:35], v[208:211]
  v_mfma_f32_16x16x32_bf16 v[212:215], v[228:231], v[64:67], v[212:215]
  ds_read_b64_tr_b16 v[228:229], v245 offset:16384
  s_waitcnt lgkmcnt(5)
  v_mfma_f32_16x16x32_bf16 v[204:207], v[232:235], v[4:7], v[204:207]
  ds_read_b64_tr_b16 v[230:231], v245 offset:18432
  v_cvt_pk_bf16_f32 v170, v216, v217
  v_mfma_f32_16x16x32_bf16 v[208:211], v[232:235], v[36:39], v[208:211]
  v_cvt_pk_bf16_f32 v171, v218, v219
  v_cvt_pk_bf16_f32 v174, v220, v221
  v_mfma_f32_16x16x32_bf16 v[212:215], v[232:235], v[68:71], v[212:215]
  ds_read_b64_tr_b16 v[232:233], v245 offset:20480
  s_waitcnt lgkmcnt(5)
  v_mfma_f32_16x16x32_bf16 v[204:207], v[236:239], v[8:11], v[204:207]
  ds_read_b64_tr_b16 v[234:235], v245 offset:22528
  v_cvt_pk_bf16_f32 v175, v222, v223
  v_mfma_f32_16x16x32_bf16 v[208:211], v[236:239], v[40:43], v[208:211]
  v_cvt_pk_bf16_f32 v178, v224, v225
  v_cvt_pk_bf16_f32 v179, v226, v227
  v_mfma_f32_16x16x32_bf16 v[212:215], v[236:239], v[72:75], v[212:215]
  ds_read_b64_tr_b16 v[236:237], v245 offset:24576
  s_waitcnt lgkmcnt(5)
  v_mfma_f32_16x16x32_bf16 v[204:207], v[240:243], v[12:15], v[204:207]
  ds_read_b64_tr_b16 v[238:239], v245 offset:26624
  v_permlane16_swap_b32 v168, v170
  v_mfma_f32_16x16x32_bf16 v[208:211], v[240:243], v[44:47], v[208:211]
  v_permlane16_swap_b32 v169, v171
  v_permlane16_swap_b32 v172, v174
  v_mfma_f32_16x16x32_bf16 v[212:215], v[240:243], v[76:79], v[212:215]
  ds_read_b64_tr_b16 v[240:241], v245 offset:28672
  s_waitcnt lgkmcnt(5)
  v_mfma_f32_16x16x32_bf16 v[204:207], v[228:231], v[16:19], v[204:207]
  ds_read_b64_tr_b16 v[242:243], v245 offset:30720
  v_permlane16_swap_b32 v173, v175
  v_mfma_f32_16x16x32_bf16 v[208:211], v[228:231], v[48:51], v[208:211]
  v_permlane16_swap_b32 v176, v178
  v_permlane16_swap_b32 v177, v179
  v_mfma_f32_16x16x32_bf16 v[212:215], v[228:231], v[80:83], v[212:215]
  v_add_u32 v253, 4294868992, v253
  ds_read_b64_tr_b16 v[228:229], v253 offset:0
  s_waitcnt lgkmcnt(5)
  v_mfma_f32_16x16x32_bf16 v[204:207], v[232:235], v[20:23], v[204:207]
  ds_read_b64_tr_b16 v[230:231], v253 offset:2048
  v_lshlrev_b32 v216, 16, v182
  v_and_b32 v217, 0xffff0000, v182
  v_mfma_f32_16x16x32_bf16 v[208:211], v[232:235], v[52:55], v[208:211]
  v_lshlrev_b32 v218, 16, v183
  v_and_b32 v219, 0xffff0000, v183
  s_mul_i32 s66, s53, 12288
  s_add_u32 s66, s66, s65
  buffer_store_dwordx4 v[168:171], v251, s[76:79], s66 offen offset:0 sc1
  v_mfma_f32_16x16x32_bf16 v[212:215], v[232:235], v[84:87], v[212:215]
  ds_read_b64_tr_b16 v[232:233], v253 offset:4096
  s_waitcnt lgkmcnt(5)
  v_mfma_f32_16x16x32_bf16 v[204:207], v[236:239], v[24:27], v[204:207]
  ds_read_b64_tr_b16 v[234:235], v253 offset:6144
  v_lshlrev_b32 v220, 16, v186
  v_and_b32 v221, 0xffff0000, v186
  v_mfma_f32_16x16x32_bf16 v[208:211], v[236:239], v[56:59], v[208:211]
  v_lshlrev_b32 v222, 16, v187
  v_and_b32 v223, 0xffff0000, v187
  buffer_store_dwordx4 v[172:175], v251, s[76:79], s66 offen offset:1024 sc1
  v_mfma_f32_16x16x32_bf16 v[212:215], v[236:239], v[88:91], v[212:215]
  ds_read_b64_tr_b16 v[236:237], v253 offset:8192
  s_waitcnt lgkmcnt(5)
  v_mfma_f32_16x16x32_bf16 v[204:207], v[240:243], v[28:31], v[204:207]
  ds_read_b64_tr_b16 v[238:239], v253 offset:10240
  v_lshlrev_b32 v224, 16, v190
  v_and_b32 v225, 0xffff0000, v190
  v_mfma_f32_16x16x32_bf16 v[208:211], v[240:243], v[60:63], v[208:211]
  v_lshlrev_b32 v226, 16, v191
  v_and_b32 v227, 0xffff0000, v191
  buffer_store_dwordx4 v[176:179], v251, s[76:79], s66 offen offset:2048 sc1
  s_add_u32 s53, s53, 1
  s_cmp_eq_u32 s53, 9
  s_cselect_b32 s53, 0, s53
  v_mfma_f32_16x16x32_bf16 v[212:215], v[240:243], v[92:95], v[212:215]
  ds_read_b64_tr_b16 v[240:241], v253 offset:12288
  s_waitcnt lgkmcnt(5)
  v_mfma_f32_16x16x32_bf16 v[216:219], v[228:231], v[0:3], v[216:219]
  ds_read_b64_tr_b16 v[242:243], v253 offset:14336
  v_mfma_f32_16x16x32_bf16 v[220:223], v[228:231], v[32:35], v[220:223]
  s_barrier
  v_mfma_f32_16x16x32_bf16 v[224:227], v[228:231], v[64:67], v[224:227]
  ds_read_b64_tr_b16 v[228:229], v253 offset:16384
  s_waitcnt lgkmcnt(5)
  v_mfma_f32_16x16x32_bf16 v[216:219], v[232:235], v[4:7], v[216:219]
  ds_read_b64_tr_b16 v[230:231], v253 offset:18432
  v_cvt_pk_bf16_f32 v180, v204, v205
  v_mfma_f32_16x16x32_bf16 v[220:223], v[232:235], v[36:39], v[220:223]
  v_cvt_pk_bf16_f32 v181, v206, v207
  v_cvt_pk_bf16_f32 v184, v208, v209
  v_mfma_f32_16x16x32_bf16 v[224:227], v[232:235], v[68:71], v[224:227]
  ds_read_b64_tr_b16 v[232:233], v253 offset:20480
  s_waitcnt lgkmcnt(5)
  v_mfma_f32_16x16x32_bf16 v[216:219], v[236:239], v[8:11], v[216:219]
  ds_read_b64_tr_b16 v[234:235], v253 offset:22528
  v_cvt_pk_bf16_f32 v185, v210, v211
  v_mfma_f32_16x16x32_bf16 v[220:223], v[236:239], v[40:43], v[220:223]
  v_cvt_pk_bf16_f32 v188, v212, v213
  v_cvt_pk_bf16_f32 v189, v214, v215
  v_mfma_f32_16x16x32_bf16 v[224:227], v[236:239], v[72:75], v[224:227]
  ds_read_b64_tr_b16 v[236:237], v253 offset:24576
  s_waitcnt lgkmcnt(5)
  v_mfma_f32_16x16x32_bf16 v[216:219], v[240:243], v[12:15], v[216:219]
  ds_read_b64_tr_b16 v[238:239], v253 offset:26624
  v_lshlrev_b32 v204, 16, v192
  v_mfma_f32_16x16x32_bf16 v[220:223], v[240:243], v[44:47], v[220:223]
  v_and_b32 v205, 0xffff0000, v192
  v_lshlrev_b32 v206, 16, v193
  v_mfma_f32_16x16x32_bf16 v[224:227], v[240:243], v[76:79], v[224:227]
  ds_read_b64_tr_b16 v[240:241], v253 offset:28672
  s_waitcnt lgkmcnt(5)
  v_mfma_f32_16x16x32_bf16 v[216:219], v[228:231], v[16:19], v[216:219]
  ds_read_b64_tr_b16 v[242:243], v253 offset:30720
  v_and_b32 v207, 0xffff0000, v193
  v_mfma_f32_16x16x32_bf16 v[220:223], v[228:231], v[48:51], v[220:223]
  v_lshlrev_b32 v208, 16, v196
  v_and_b32 v209, 0xffff0000, v196
  v_mfma_f32_16x16x32_bf16 v[224:227], v[228:231], v[80:83], v[224:227]
  v_add_u32 v245, 32768, v245
  ds_read_b64_tr_b16 v[228:229], v245 offset:0
  s_waitcnt lgkmcnt(5)
  v_mfma_f32_16x16x32_bf16 v[216:219], v[232:235], v[20:23], v[216:219]
  ds_read_b64_tr_b16 v[230:231], v245 offset:2048
  v_lshlrev_b32 v210, 16, v197
  v_mfma_f32_16x16x32_bf16 v[220:223], v[232:235], v[52:55], v[220:223]
  v_and_b32 v211, 0xffff0000, v197
  v_lshlrev_b32 v212, 16, v200
  v_mfma_f32_16x16x32_bf16 v[224:227], v[232:235], v[84:87], v[224:227]
  ds_read_b64_tr_b16 v[232:233], v245 offset:4096
  s_waitcnt lgkmcnt(5)
  v_mfma_f32_16x16x32_bf16 v[216:219], v[236:239], v[24:27], v[216:219]
  ds_read_b64_tr_b16 v[234:235], v245 offset:6144
  v_and_b32 v213, 0xffff0000, v200
  v_mfma_f32_16x16x32_bf16 v[220:223], v[236:239], v[56:59], v[220:223]
  v_lshlrev_b32 v214, 16, v201
  v_and_b32 v215, 0xffff0000, v201
  v_mfma_f32_16x16x32_bf16 v[224:227], v[236:239], v[88:91], v[224:227]
  ds_read_b64_tr_b16 v[236:237], v245 offset:8192
  s_waitcnt lgkmcnt(5)
  v_mfma_f32_16x16x32_bf16 v[216:219], v[240:243], v[28:31], v[216:219]
  ds_read_b64_tr_b16 v[238:239], v245 offset:10240
  v_mfma_f32_16x16x32_bf16 v[220:223], v[240:243], v[60:63], v[220:223]
  v_mfma_f32_16x16x32_bf16 v[224:227], v[240:243], v[92:95], v[224:227]
  ds_read_b64_tr_b16 v[240:241], v245 offset:12288
  s_waitcnt lgkmcnt(5)
  v_mfma_f32_16x16x32_bf16 v[204:207], v[228:231], v[0:3], v[204:207]
  ds_read_b64_tr_b16 v[242:243], v245 offset:14336
  v_mfma_f32_16x16x32_bf16 v[208:211], v[228:231], v[32:35], v[208:211]
  v_mfma_f32_16x16x32_bf16 v[212:215], v[228:231], v[64:67], v[212:215]
  ds_read_b64_tr_b16 v[228:229], v245 offset:16384
  s_waitcnt lgkmcnt(5)
  v_mfma_f32_16x16x32_bf16 v[204:207], v[232:235], v[4:7], v[204:207]
  ds_read_b64_tr_b16 v[230:231], v245 offset:18432
  v_cvt_pk_bf16_f32 v182, v216, v217
  v_mfma_f32_16x16x32_bf16 v[208:211], v[232:235], v[36:39], v[208:211]
  v_cvt_pk_bf16_f32 v183, v218, v219
  v_cvt_pk_bf16_f32 v186, v220, v221
  v_mfma_f32_16x16x32_bf16 v[212:215], v[232:235], v[68:71], v[212:215]
  ds_read_b64_tr_b16 v[232:233], v245 offset:20480
  s_waitcnt lgkmcnt(5)
  v_mfma_f32_16x16x32_bf16 v[204:207], v[236:239], v[8:11], v[204:207]
  ds_read_b64_tr_b16 v[234:235], v245 offset:22528
  v_cvt_pk_bf16_f32 v187, v222, v223
  v_mfma_f32_16x16x32_bf16 v[208:211], v[236:239], v[40:43], v[208:211]
  v_cvt_pk_bf16_f32 v190, v224, v225
  v_cvt_pk_bf16_f32 v191, v226, v227
  v_mfma_f32_16x16x32_bf16 v[212:215], v[236:239], v[72:75], v[212:215]
  ds_read_b64_tr_b16 v[236:237], v245 offset:24576
  s_waitcnt lgkmcnt(5)
  v_mfma_f32_16x16x32_bf16 v[204:207], v[240:243], v[12:15], v[204:207]
  ds_read_b64_tr_b16 v[238:239], v245 offset:26624
  v_permlane16_swap_b32 v180, v182
  v_mfma_f32_16x16x32_bf16 v[208:211], v[240:243], v[44:47], v[208:211]
  v_permlane16_swap_b32 v181, v183
  v_permlane16_swap_b32 v184, v186
  v_mfma_f32_16x16x32_bf16 v[212:215], v[240:243], v[76:79], v[212:215]
  ds_read_b64_tr_b16 v[240:241], v245 offset:28672
  s_waitcnt lgkmcnt(5)
  v_mfma_f32_16x16x32_bf16 v[204:207], v[228:231], v[16:19], v[204:207]
  ds_read_b64_tr_b16 v[242:243], v245 offset:30720
  v_permlane16_swap_b32 v185, v187
  v_mfma_f32_16x16x32_bf16 v[208:211], v[228:231], v[48:51], v[208:211]
  v_permlane16_swap_b32 v188, v190
  v_permlane16_swap_b32 v189, v191
  v_mfma_f32_16x16x32_bf16 v[212:215], v[228:231], v[80:83], v[212:215]
  v_add_u32 v253, 32768, v253
  ds_read_b64_tr_b16 v[228:229], v253 offset:0
  s_waitcnt lgkmcnt(5)
  v_mfma_f32_16x16x32_bf16 v[204:207], v[232:235], v[20:23], v[204:207]
  ds_read_b64_tr_b16 v[230:231], v253 offset:2048
  v_lshlrev_b32 v216, 16, v194
  v_and_b32 v217, 0xffff0000, v194
  v_mfma_f32_16x16x32_bf16 v[208:211], v[232:235], v[52:55], v[208:211]
  v_lshlrev_b32 v218, 16, v195
  v_and_b32 v219, 0xffff0000, v195
  s_mul_i32 s66, s53, 12288
  s_add_u32 s66, s66, s65
  buffer_store_dwordx4 v[180:183], v251, s[76:79], s66 offen offset:0 sc1
  v_mfma_f32_16x16x32_bf16 v[212:215], v[232:235], v[84:87], v[212:215]
  ds_read_b64_tr_b16 v[232:233], v253 offset:4096
  s_waitcnt lgkmcnt(5)
  v_mfma_f32_16x16x32_bf16 v[204:207], v[236:239], v[24:27], v[204:207]
  ds_read_b64_tr_b16 v[234:235], v253 offset:6144
  v_lshlrev_b32 v220, 16, v198
  v_and_b32 v221, 0xffff0000, v198
  v_mfma_f32_16x16x32_bf16 v[208:211], v[236:239], v[56:59], v[208:211]
  v_lshlrev_b32 v222, 16, v199
  v_and_b32 v223, 0xffff0000, v199
  buffer_store_dwordx4 v[184:187], v251, s[76:79], s66 offen offset:1024 sc1
  v_mfma_f32_16x16x32_bf16 v[212:215], v[236:239], v[88:91], v[212:215]
  ds_read_b64_tr_b16 v[236:237], v253 offset:8192
  s_waitcnt lgkmcnt(5)
  v_mfma_f32_16x16x32_bf16 v[204:207], v[240:243], v[28:31], v[204:207]
  ds_read_b64_tr_b16 v[238:239], v253 offset:10240
  v_lshlrev_b32 v224, 16, v202
  v_and_b32 v225, 0xffff0000, v202
  v_mfma_f32_16x16x32_bf16 v[208:211], v[240:243], v[60:63], v[208:211]
  v_lshlrev_b32 v226, 16, v203
  v_and_b32 v227, 0xffff0000, v203
  buffer_store_dwordx4 v[188:191], v251, s[76:79], s66 offen offset:2048 sc1
  s_add_u32 s53, s53, 1
  s_cmp_eq_u32 s53, 9
  s_cselect_b32 s53, 0, s53
  v_mfma_f32_16x16x32_bf16 v[212:215], v[240:243], v[92:95], v[212:215]
  ds_read_b64_tr_b16 v[240:241], v253 offset:12288
  s_waitcnt lgkmcnt(5)
  v_mfma_f32_16x16x32_bf16 v[216:219], v[228:231], v[0:3], v[216:219]
  ds_read_b64_tr_b16 v[242:243], v253 offset:14336
  v_mfma_f32_16x16x32_bf16 v[220:223], v[228:231], v[32:35], v[220:223]
  v_mfma_f32_16x16x32_bf16 v[224:227], v[228:231], v[64:67], v[224:227]
  ds_read_b64_tr_b16 v[228:229], v253 offset:16384
  s_waitcnt lgkmcnt(5)
  v_mfma_f32_16x16x32_bf16 v[216:219], v[232:235], v[4:7], v[216:219]
  ds_read_b64_tr_b16 v[230:231], v253 offset:18432
  v_cvt_pk_bf16_f32 v192, v204, v205
  v_mfma_f32_16x16x32_bf16 v[220:223], v[232:235], v[36:39], v[220:223]
  v_cvt_pk_bf16_f32 v193, v206, v207
  v_cvt_pk_bf16_f32 v196, v208, v209
  v_mfma_f32_16x16x32_bf16 v[224:227], v[232:235], v[68:71], v[224:227]
  ds_read_b64_tr_b16 v[232:233], v253 offset:20480
  s_waitcnt lgkmcnt(5)
  v_mfma_f32_16x16x32_bf16 v[216:219], v[236:239], v[8:11], v[216:219]
  ds_read_b64_tr_b16 v[234:235], v253 offset:22528
  v_cvt_pk_bf16_f32 v197, v210, v211
  v_mfma_f32_16x16x32_bf16 v[220:223], v[236:239], v[40:43], v[220:223]
  v_cvt_pk_bf16_f32 v200, v212, v213
  v_cvt_pk_bf16_f32 v201, v214, v215
  v_mfma_f32_16x16x32_bf16 v[224:227], v[236:239], v[72:75], v[224:227]
  ds_read_b64_tr_b16 v[236:237], v253 offset:24576
  s_waitcnt lgkmcnt(5)
  v_mfma_f32_16x16x32_bf16 v[216:219], v[240:243], v[12:15], v[216:219]
  ds_read_b64_tr_b16 v[238:239], v253 offset:26624
  v_mfma_f32_16x16x32_bf16 v[220:223], v[240:243], v[44:47], v[220:223]
  v_mfma_f32_16x16x32_bf16 v[224:227], v[240:243], v[76:79], v[224:227]
  ds_read_b64_tr_b16 v[240:241], v253 offset:28672
  s_waitcnt lgkmcnt(5)
  v_mfma_f32_16x16x32_bf16 v[216:219], v[228:231], v[16:19], v[216:219]
  ds_read_b64_tr_b16 v[242:243], v253 offset:30720
  v_mfma_f32_16x16x32_bf16 v[220:223], v[228:231], v[48:51], v[220:223]
  v_mfma_f32_16x16x32_bf16 v[224:227], v[228:231], v[80:83], v[224:227]
  s_waitcnt lgkmcnt(4)
  v_mfma_f32_16x16x32_bf16 v[216:219], v[232:235], v[20:23], v[216:219]
  v_mfma_f32_16x16x32_bf16 v[220:223], v[232:235], v[52:55], v[220:223]
  v_mfma_f32_16x16x32_bf16 v[224:227], v[232:235], v[84:87], v[224:227]
  s_waitcnt lgkmcnt(2)
  v_mfma_f32_16x16x32_bf16 v[216:219], v[236:239], v[24:27], v[216:219]
  v_mfma_f32_16x16x32_bf16 v[220:223], v[236:239], v[56:59], v[220:223]
  v_mfma_f32_16x16x32_bf16 v[224:227], v[236:239], v[88:91], v[224:227]
  s_waitcnt lgkmcnt(0)
  v_mfma_f32_16x16x32_bf16 v[216:219], v[240:243], v[28:31], v[216:219]
  v_mfma_f32_16x16x32_bf16 v[220:223], v[240:243], v[60:63], v[220:223]
  v_mfma_f32_16x16x32_bf16 v[224:227], v[240:243], v[92:95], v[224:227]
  s_nop 5
  v_cvt_pk_bf16_f32 v194, v216, v217
  v_cvt_pk_bf16_f32 v195, v218, v219
  v_cvt_pk_bf16_f32 v198, v220, v221
  v_cvt_pk_bf16_f32 v199, v222, v223
  v_cvt_pk_bf16_f32 v202, v224, v225
  v_cvt_pk_bf16_f32 v203, v226, v227
  v_permlane16_swap_b32 v192, v194
  v_permlane16_swap_b32 v193, v195
  v_permlane16_swap_b32 v196, v198
  v_permlane16_swap_b32 v197, v199
  v_permlane16_swap_b32 v200, v202
  v_permlane16_swap_b32 v201, v203
  s_mul_i32 s66, s53, 12288
  s_add_u32 s66, s66, s65
  buffer_store_dwordx4 v[192:195], v251, s[76:79], s66 offen offset:0 sc1
  buffer_store_dwordx4 v[196:199], v251, s[76:79], s66 offen offset:1024 sc1
  buffer_store_dwordx4 v[200:203], v251, s[76:79], s66 offen offset:2048 sc1
  s_add_u32 s53, s53, 1
  s_cmp_eq_u32 s53, 9
  s_cselect_b32 s53, 0, s53
  v_lshrrev_b32 v240, 2, v251
  v_and_b32 v241, 64, v240
  v_and_b32 v240, 60, v240
  v_lshl_add_u32 v240, v241, 5, v240
  s_mul_i32 s62, s70, 864
  s_mul_i32 s52, s71, 221184
  s_mul_i32 s31, s84, 1152
  s_add_u32 s52, s52, s31
  s_lshl_b32 s63, s84, 1
  s_lshl_b32 s89, s84, 4
  s_lshl_b32 s31, s30, 6
  s_add_u32 s31, s31, 0
  v_add_u32 v1, s31, v250
  v_add_u32 v2, s62, v1
  v_lshrrev_b32 v3, 6, v2
  v_mul_u32_u24 v4, 171, v3
  v_lshrrev_b32 v4, 9, v4
  v_mul_u32_u24 v5, 3, v4
  v_sub_u32 v5, v3, v5
  v_and_b32 v6, 1, v4
  v_mul_u32_u24 v6, 3, v6
  v_add_u32 v5, v5, v6
  v_and_b32 v6, 15, v2
  v_lshl_add_u32 v5, v5, 4, v6
  v_mul_u32_u24 v5, 2304, v5
  v_lshrrev_b32 v4, 1, v4
  v_lshl_add_u32 v5, v4, 6, v5
  v_bfe_u32 v6, v2, 5, 1
  v_lshl_add_u32 v5, v6, 4, v5
  v_bfe_u32 v6, v2, 4, 1
  v_lshl_add_u32 v5, v6, 5, v5
  v_lshlrev_b32 v2, 4, v2
  v_cmp_gt_u32 vcc, 432, v1
  v_mov_b32 v6, 0x10000000
  s_nop 0
  v_cndmask_b32 v232, v6, v2, vcc
  v_cndmask_b32 v236, v6, v5, vcc
  s_lshl_b32 s31, s30, 6
  s_add_u32 s31, s31, 256
  v_add_u32 v1, s31, v250
  v_add_u32 v2, s62, v1
  v_lshrrev_b32 v3, 6, v2
  v_mul_u32_u24 v4, 171, v3
  v_lshrrev_b32 v4, 9, v4
  v_mul_u32_u24 v5, 3, v4
  v_sub_u32 v5, v3, v5
  v_and_b32 v6, 1, v4
  v_mul_u32_u24 v6, 3, v6
  v_add_u32 v5, v5, v6
  v_and_b32 v6, 15, v2
  v_lshl_add_u32 v5, v5, 4, v6
  v_mul_u32_u24 v5, 2304, v5
  v_lshrrev_b32 v4, 1, v4
  v_lshl_add_u32 v5, v4, 6, v5
  v_bfe_u32 v6, v2, 5, 1
  v_lshl_add_u32 v5, v6, 4, v5
  v_bfe_u32 v6, v2, 4, 1
  v_lshl_add_u32 v5, v6, 5, v5
  v_lshlrev_b32 v2, 4, v2
  v_cmp_gt_u32 vcc, 432, v1
  v_mov_b32 v6, 0x10000000
  s_nop 0
  v_cndmask_b32 v233, v6, v2, vcc
  v_cndmask_b32 v237, v6, v5, vcc
  s_waitcnt vmcnt(0)
  s_barrier
  s_cmp_lg_u32 s30, 0
  s_cbranch_scc1 L_w0_141
  s_add_u32 s31, s70, s89
  s_lshl_b64 exec, 1, s31
  buffer_store_dword v252, v240, s[56:59], 0 offen sc1
  s_mov_b64 exec, -1
L_w0_141:
L_red_wait:
  s_cmp_lg_u32 s30, 0
  s_cbranch_scc1 L_w0_142
  s_mov_b32 s88, 0x8000
L_spin_143:
  buffer_load_dword v242, v240, s[56:59], 0 offen sc1
  s_waitcnt vmcnt(0)
  v_cmp_eq_u32 vcc, v242, v252
  s_sub_u32 s88, s88, 1
  s_cmp_eq_u32 s88, 0
  s_cbranch_scc1 L_ok_144
  s_lshr_b32 s31, vcc_lo, s89
  s_and_b32 s31, s31, 0xff
  s_cmp_eq_u32 s31, 0xff
  s_cbranch_scc1 L_ok_144
  s_sleep 2
  s_branch L_spin_143
L_ok_144:
L_w0_142:
  s_barrier
L_red:
  s_mov_b32 s66, 0
  buffer_load_dwordx4 v[96:99], v232, s[76:79], s66 offen sc1
  buffer_load_dwordx4 v[100:103], v233, s[76:79], s66 offen sc1
  s_mov_b32 s66, 110592
  buffer_load_dwordx4 v[104:107], v232, s[76:79], s66 offen sc1
  buffer_load_dwordx4 v[108:111], v233, s[76:79], s66 offen sc1
  s_mov_b32 s66, 221184
  buffer_load_dwordx4 v[112:115], v232, s[76:79], s66 offen sc1
  buffer_load_dwordx4 v[116:119], v233, s[76:79], s66 offen sc1
  s_mov_b32 s66, 331776
  buffer_load_dwordx4 v[120:123], v232, s[76:79], s66 offen sc1
  buffer_load_dwordx4 v[124:127], v233, s[76:79], s66 offen sc1
  s_mov_b32 s66, 442368
  buffer_load_dwordx4 v[128:131], v232, s[76:79], s66 offen sc1
  buffer_load_dwordx4 v[132:135], v233, s[76:79], s66 offen sc1
  s_mov_b32 s66, 552960
  buffer_load_dwordx4 v[136:139], v232, s[76:79], s66 offen sc1
  buffer_load_dwordx4 v[140:143], v233, s[76:79], s66 offen sc1
  s_mov_b32 s66, 663552
  buffer_load_dwordx4 v[144:147], v232, s[76:79], s66 offen sc1
  buffer_load_dwordx4 v[148:151], v233, s[76:79], s66 offen sc1
  s_mov_b32 s66, 774144
  buffer_load_dwordx4 v[152:155], v232, s[76:79], s66 offen sc1
  buffer_load_dwordx4 v[156:159], v233, s[76:79], s66 offen sc1
  s_waitcnt vmcnt(14)
  v_lshlrev_b32 v8, 16, v96
  v_and_b32 v9, 0xffff0000, v96
  v_lshlrev_b32 v10, 16, v97
  v_and_b32 v11, 0xffff0000, v97
  v_lshlrev_b32 v12, 16, v98
  v_and_b32 v13, 0xffff0000, v98
  v_lshlrev_b32 v14, 16, v99
  v_and_b32 v15, 0xffff0000, v99
  v_lshlrev_b32 v16, 16, v100
  v_and_b32 v17, 0xffff0000, v100
  v_lshlrev_b32 v18, 16, v101
  v_and_b32 v19, 0xffff0000, v101
  v_lshlrev_b32 v20, 16, v102
  v_and_b32 v21, 0xffff0000, v102
  v_lshlrev_b32 v22, 16, v103
  v_and_b32 v23, 0xffff0000, v103
  s_waitcnt vmcnt(12)
  v_lshlrev_b32 v44, 16, v104
  v_and_b32 v45, 0xffff0000, v104
  v_pk_add_f32 v[8:9], v[8:9], v[44:45]
  v_lshlrev_b32 v46, 16, v105
  v_and_b32 v47, 0xffff0000, v105
  v_pk_add_f32 v[10:11], v[10:11], v[46:47]
  v_lshlrev_b32 v44, 16, v106
  v_and_b32 v45, 0xffff0000, v106
  v_pk_add_f32 v[12:13], v[12:13], v[44:45]
  v_lshlrev_b32 v46, 16, v107
  v_and_b32 v47, 0xffff0000, v107
  v_pk_add_f32 v[14:15], v[14:15], v[46:47]
  v_lshlrev_b32 v44, 16, v108
  v_and_b32 v45, 0xffff0000, v108
  v_pk_add_f32 v[16:17], v[16:17], v[44:45]
  v_lshlrev_b32 v46, 16, v109
  v_and_b32 v47, 0xffff0000, v109
  v_pk_add_f32 v[18:19], v[18:19], v[46:47]
  v_lshlrev_b32 v44, 16, v110
  v_and_b32 v45, 0xffff0000, v110
  v_pk_add_f32 v[20:21], v[20:21], v[44:45]
  v_lshlrev_b32 v46, 16, v111
  v_and_b32 v47, 0xffff0000, v111
  v_pk_add_f32 v[22:23], v[22:23], v[46:47]
  s_waitcnt vmcnt(10)
  v_lshlrev_b32 v44, 16, v112
  v_and_b32 v45, 0xffff0000, v112
  v_pk_add_f32 v[8:9], v[8:9], v[44:45]
  v_lshlrev_b32 v46, 16, v113
  v_and_b32 v47, 0xffff0000, v113
  v_pk_add_f32 v[10:11], v[10:11], v[46:47]
  v_lshlrev_b32 v44, 16, v114
  v_and_b32 v45, 0xffff0000, v114
  v_pk_add_f32 v[12:13], v[12:13], v[44:45]
  v_lshlrev_b32 v46, 16, v115
  v_and_b32 v47, 0xffff0000, v115
  v_pk_add_f32 v[14:15], v[14:15], v[46:47]
  v_lshlrev_b32 v44, 16, v116
  v_and_b32 v45, 0xffff0000, v116
  v_pk_add_f32 v[16:17], v[16:17], v[44:45]
  v_lshlrev_b32 v46, 16, v117
  v_and_b32 v47, 0xffff0000, v117
  v_pk_add_f32 v[18:19], v[18:19], v[46:47]
  v_lshlrev_b32 v44, 16, v118
  v_and_b32 v45, 0xffff0000, v118
  v_pk_add_f32 v[20:21], v[20:21], v[44:45]
  v_lshlrev_b32 v46, 16, v119
  v_and_b32 v47, 0xffff0000, v119
  v_pk_add_f32 v[22:23], v[22:23], v[46:47]
  s_waitcnt vmcnt(8)
  v_lshlrev_b32 v44, 16, v120
  v_and_b32 v45, 0xffff0000, v120
  v_pk_add_f32 v[8:9], v[8:9], v[44:45]
  v_lshlrev_b32 v46, 16, v121
  v_and_b32 v47, 0xffff0000, v121
  v_pk_add_f32 v[10:11], v[10:11], v[46:47]
  v_lshlrev_b32 v44, 16, v122
  v_and_b32 v45, 0xffff0000, v122
  v_pk_add_f32 v[12:13], v[12:13], v[44:45]
  v_lshlrev_b32 v46, 16, v123
  v_and_b32 v47, 0xffff0000, v123
  v_pk_add_f32 v[14:15], v[14:15], v[46:47]
  v_lshlrev_b32 v44, 16, v124
  v_and_b32 v45, 0xffff0000, v124
  v_pk_add_f32 v[16:17], v[16:17], v[44:45]
  v_lshlrev_b32 v46, 16, v125
  v_and_b32 v47, 0xffff0000, v125
  v_pk_add_f32 v[18:19], v[18:19], v[46:47]
  v_lshlrev_b32 v44, 16, v126
  v_and_b32 v45, 0xffff0000, v126
  v_pk_add_f32 v[20:21], v[20:21], v[44:45]
  v_lshlrev_b32 v46, 16, v127
  v_and_b32 v47, 0xffff0000, v127
  v_pk_add_f32 v[22:23], v[22:23], v[46:47]
  s_waitcnt vmcnt(6)
  v_lshlrev_b32 v44, 16, v128
  v_and_b32 v45, 0xffff0000, v128
  v_pk_add_f32 v[8:9], v[8:9], v[44:45]
  v_lshlrev_b32 v46, 16, v129
  v_and_b32 v47, 0xffff0000, v129
  v_pk_add_f32 v[10:11], v[10:11], v[46:47]
  v_lshlrev_b32 v44, 16, v130
  v_and_b32 v45, 0xffff0000, v130
  v_pk_add_f32 v[12:13], v[12:13], v[44:45]
  v_lshlrev_b32 v46, 16, v131
  v_and_b32 v47, 0xffff0000, v131
  v_pk_add_f32 v[14:15], v[14:15], v[46:47]
  v_lshlrev_b32 v44, 16, v132
  v_and_b32 v45, 0xffff0000, v132
  v_pk_add_f32 v[16:17], v[16:17], v[44:45]
  v_lshlrev_b32 v46, 16, v133
  v_and_b32 v47, 0xffff0000, v133
  v_pk_add_f32 v[18:19], v[18:19], v[46:47]
  v_lshlrev_b32 v44, 16, v134
  v_and_b32 v45, 0xffff0000, v134
  v_pk_add_f32 v[20:21], v[20:21], v[44:45]
  v_lshlrev_b32 v46, 16, v135
  v_and_b32 v47, 0xffff0000, v135
  v_pk_add_f32 v[22:23], v[22:23], v[46:47]
  s_waitcnt vmcnt(4)
  v_lshlrev_b32 v44, 16, v136
  v_and_b32 v45, 0xffff0000, v136
  v_pk_add_f32 v[8:9], v[8:9], v[44:45]
  v_lshlrev_b32 v46, 16, v137
  v_and_b32 v47, 0xffff0000, v137
  v_pk_add_f32 v[10:11], v[10:11], v[46:47]
  v_lshlrev_b32 v44, 16, v138
  v_and_b32 v45, 0xffff0000, v138
  v_pk_add_f32 v[12:13], v[12:13], v[44:45]
  v_lshlrev_b32 v46, 16, v139
  v_and_b32 v47, 0xffff0000, v139
  v_pk_add_f32 v[14:15], v[14:15], v[46:47]
  v_lshlrev_b32 v44, 16, v140
  v_and_b32 v45, 0xffff0000, v140
  v_pk_add_f32 v[16:17], v[16:17], v[44:45]
  v_lshlrev_b32 v46, 16, v141
  v_and_b32 v47, 0xffff0000, v141
  v_pk_add_f32 v[18:19], v[18:19], v[46:47]
  v_lshlrev_b32 v44, 16, v142
  v_and_b32 v45, 0xffff0000, v142
  v_pk_add_f32 v[20:21], v[20:21], v[44:45]
  v_lshlrev_b32 v46, 16, v143
  v_and_b32 v47, 0xffff0000, v143
  v_pk_add_f32 v[22:23], v[22:23], v[46:47]
  s_waitcnt vmcnt(2)
  v_lshlrev_b32 v44, 16, v144
  v_and_b32 v45, 0xffff0000, v144
  v_pk_add_f32 v[8:9], v[8:9], v[44:45]
  v_lshlrev_b32 v46, 16, v145
  v_and_b32 v47, 0xffff0000, v145
  v_pk_add_f32 v[10:11], v[10:11], v[46:47]
  v_lshlrev_b32 v44, 16, v146
  v_and_b32 v45, 0xffff0000, v146
  v_pk_add_f32 v[12:13], v[12:13], v[44:45]
  v_lshlrev_b32 v46, 16, v147
  v_and_b32 v47, 0xffff0000, v147
  v_pk_add_f32 v[14:15], v[14:15], v[46:47]
  v_lshlrev_b32 v44, 16, v148
  v_and_b32 v45, 0xffff0000, v148
  v_pk_add_f32 v[16:17], v[16:17], v[44:45]
  v_lshlrev_b32 v46, 16, v149
  v_and_b32 v47, 0xffff0000, v149
  v_pk_add_f32 v[18:19], v[18:19], v[46:47]
  v_lshlrev_b32 v44, 16, v150
  v_and_b32 v45, 0xffff0000, v150
  v_pk_add_f32 v[20:21], v[20:21], v[44:45]
  v_lshlrev_b32 v46, 16, v151
  v_and_b32 v47, 0xffff0000, v151
  v_pk_add_f32 v[22:23], v[22:23], v[46:47]
  s_waitcnt vmcnt(0)
  v_lshlrev_b32 v44, 16, v152
  v_and_b32 v45, 0xffff0000, v152
  v_pk_add_f32 v[8:9], v[8:9], v[44:45]
  v_lshlrev_b32 v46, 16, v153
  v_and_b32 v47, 0xffff0000, v153
  v_pk_add_f32 v[10:11], v[10:11], v[46:47]
  v_lshlrev_b32 v44, 16, v154
  v_and_b32 v45, 0xffff0000, v154
  v_pk_add_f32 v[12:13], v[12:13], v[44:45]
  v_lshlrev_b32 v46, 16, v155
  v_and_b32 v47, 0xffff0000, v155
  v_pk_add_f32 v[14:15], v[14:15], v[46:47]
  v_lshlrev_b32 v44, 16, v156
  v_and_b32 v45, 0xffff0000, v156
  v_pk_add_f32 v[16:17], v[16:17], v[44:45]
  v_lshlrev_b32 v46, 16, v157
  v_and_b32 v47, 0xffff0000, v157
  v_pk_add_f32 v[18:19], v[18:19], v[46:47]
  v_lshlrev_b32 v44, 16, v158
  v_and_b32 v45, 0xffff0000, v158
  v_pk_add_f32 v[20:21], v[20:21], v[44:45]
  v_lshlrev_b32 v46, 16, v159
  v_and_b32 v47, 0xffff0000, v159
  v_pk_add_f32 v[22:23], v[22:23], v[46:47]
  v_cvt_pk_bf16_f32 v48, v8, v9
  v_cvt_pk_bf16_f32 v49, v10, v11
  v_cvt_pk_bf16_f32 v50, v12, v13
  v_cvt_pk_bf16_f32 v51, v14, v15
  v_cvt_pk_bf16_f32 v52, v16, v17
  v_cvt_pk_bf16_f32 v53, v18, v19
  v_cvt_pk_bf16_f32 v54, v20, v21
  v_cvt_pk_bf16_f32 v55, v22, v23
  buffer_store_dwordx4 v[48:51], v236, s[80:83], s52 offen
  buffer_store_dwordx4 v[52:55], v237, s[80:83], s52 offen
  s_add_u32 s63, s63, 1
  s_cmp_eq_u32 s63, 3
  s_cbranch_scc1 L_red_done
  s_cmp_eq_u32 s63, 2
  s_cbranch_scc1 L_red_b
  s_add_u32 s62, s62, 432
  s_lshl_b32 s31, s30, 6
  s_add_u32 s31, s31, 0
  v_add_u32 v1, s31, v250
  v_add_u32 v2, s62, v1
  v_lshrrev_b32 v3, 6, v2
  v_mul_u32_u24 v4, 171, v3
  v_lshrrev_b32 v4, 9, v4
  v_mul_u32_u24 v5, 3, v4
  v_sub_u32 v5, v3, v5
  v_and_b32 v6, 1, v4
  v_mul_u32_u24 v6, 3, v6
  v_add_u32 v5, v5, v6
  v_and_b32 v6, 15, v2
  v_lshl_add_u32 v5, v5, 4, v6
  v_mul_u32_u24 v5, 2304, v5
  v_lshrrev_b32 v4, 1, v4
  v_lshl_add_u32 v5, v4, 6, v5
  v_bfe_u32 v6, v2, 5, 1
  v_lshl_add_u32 v5, v6, 4, v5
  v_bfe_u32 v6, v2, 4, 1
  v_lshl_add_u32 v5, v6, 5, v5
  v_lshlrev_b32 v2, 4, v2
  v_cmp_gt_u32 vcc, 432, v1
  v_mov_b32 v6, 0x10000000
  s_nop 0
  v_cndmask_b32 v232, v6, v2, vcc
  v_cndmask_b32 v236, v6, v5, vcc
  s_lshl_b32 s31, s30, 6
  s_add_u32 s31, s31, 256
  v_add_u32 v1, s31, v250
  v_add_u32 v2, s62, v1
  v_lshrrev_b32 v3, 6, v2
  v_mul_u32_u24 v4, 171, v3
  v_lshrrev_b32 v4, 9, v4
  v_mul_u32_u24 v5, 3, v4
  v_sub_u32 v5, v3, v5
  v_and_b32 v6, 1, v4
  v_mul_u32_u24 v6, 3, v6
  v_add_u32 v5, v5, v6
  v_and_b32 v6, 15, v2
  v_lshl_add_u32 v5, v5, 4, v6
  v_mul_u32_u24 v5, 2304, v5
  v_lshrrev_b32 v4, 1, v4
  v_lshl_add_u32 v5, v4, 6, v5
  v_bfe_u32 v6, v2, 5, 1
  v_lshl_add_u32 v5, v6, 4, v5
  v_bfe_u32 v6, v2, 4, 1
  v_lshl_add_u32 v5, v6, 5, v5
  v_lshlrev_b32 v2, 4, v2
  v_cmp_gt_u32 vcc, 432, v1
  v_mov_b32 v6, 0x10000000
  s_nop 0
  v_cndmask_b32 v233, v6, v2, vcc
  v_cndmask_b32 v237, v6, v5, vcc
  s_branch L_red
L_red_b:
  s_add_u32 s76, s76, 14155776
  s_addc_u32 s77, s77, 0
  s_add_u32 s52, s52, 1152
  s_mov_b32 s89, 16
  s_branch L_red_wait
L_red_done:
  s_endpgm
L_attn:
  s_mov_b32 s62, 118784
  s_and_b32 s88, s86, 15
  s_lshr_b64 s[86:87], s[86:87], 4
  s_lshl_b32 s65, s88, 7
  s_lshl_b32 s66, s88, 19
  s_add_u32 m0, s62, s68
  s_add_u32 s66, s66, s61
  buffer_load_dwordx4 v224, s[72:75], s65 offen offset:0 lds
  buffer_load_dwordx4 v225, s[72:75], s65 offen offset:1024 lds
  buffer_load_dwordx4 v226, s[72:75], s65 offen offset:2048 lds
  s_add_u32 m0, s62, s69
  s_nop 0
  buffer_load_dwordx4 v227, s[76:79], s66 offen offset:0 lds
  buffer_load_dwordx4 v228, s[76:79], s66 offen offset:1024 lds
  buffer_load_dwordx4 v229, s[76:79], s66 offen offset:2048 lds
  buffer_load_dwordx4 v230, s[76:79], s66 offen offset:3072 lds
  s_add_u32 m0, s62, s69
  s_add_u32 m0, m0, 16384
  s_add_u32 s66, s66, 256
  buffer_load_dwordx4 v227, s[76:79], s66 offen offset:0 lds
  buffer_load_dwordx4 v228, s[76:79], s66 offen offset:1024 lds
  buffer_load_dwordx4 v229, s[76:79], s66 offen offset:2048 lds
  buffer_load_dwordx4 v230, s[76:79], s66 offen offset:3072 lds
  s_add_u32 s62, s62, 45056
  s_cmp_eq_u32 s62, 90112
  s_cselect_b32 s62, 118784, s62
  s_cmp_eq_u32 s62, 163840
  s_cselect_b32 s62, 0, s62
  s_lshl_b32 s31, s71, 3
  s_add_u32 s52, s31, s70
  s_add_u32 s31, s84, 19
  s_lshl_b32 s54, s52, s31
  s_lshl_b32 s55, s30, 11
  s_add_u32 s54, s54, s55
  s_lshl_b32 s53, 1, s31
  s_sub_u32 s53, s53, s55
  s_add_u32 s32, s6, s54
  s_addc_u32 s33, s7, 0
  s_and_b32 s33, s33, 0xffff
  s_mov_b32 s34, s53
  s_mov_b32 s35, 0x20000
  s_add_u32 s36, s8, s54
  s_addc_u32 s37, s9, 0
  s_and_b32 s37, s37, 0xffff
  s_mov_b32 s38, s53
  s_mov_b32 s39, 0x20000
  s_lshl_b32 s50, s84, 18
  s_mov_b32 s44, 0
  s_mov_b32 s45, 0
  s_mov_b32 s46, 0
  s_mov_b32 s47, 0
  s_mul_i32 s31, s30, 2112
  s_add_u32 s48, s31, 96256
  s_mov_b32 s90, s48
  s_add_u32 s49, s31, 163840
  s_mov_b32 s43, 16896
  s_mov_b32 s56, 4294916608
  s_mov_b32 s40, 0
  s_mov_b32 s42, 1092616192
  s_mov_b32 s59, 0
  s_mov_b32 s67, 0
  v_and_b32 v1, 7, v250
  v_mul_u32_u24 v1, 1056, v1
  v_bfe_u32 v2, v250, 3, 1
  v_lshl_add_u32 v1, v2, 8, v1
  v_lshrrev_b32 v2, 4, v250
  v_lshl_add_u32 v1, v2, 4, v1
  v_add_u32 v240, 96256, v1
  v_bfe_u32 v1, v250, 2, 3
  v_mul_u32_u24 v1, 1056, v1
  v_lshrrev_b32 v2, 5, v250
  v_lshl_add_u32 v1, v2, 8, v1
  v_and_b32 v2, 3, v250
  v_lshl_add_u32 v1, v2, 3, v1
  v_add_u32 v241, 104704, v1
  v_lshrrev_b32 v1, 4, v250
  v_and_b32 v2, 15, v250
  v_mul_u32_u24 v3, 272, v2
  v_lshl_add_u32 v3, v1, 4, v3
  s_mul_i32 s31, s30, 13056
  v_add_u32 v159, s31, v3
  s_and_b32 s31, s30, 1
  s_mul_i32 s31, s31, 24576
  s_lshr_b32 s3, s30, 1
  s_lshl_b32 s3, s3, 12
  s_add_u32 s31, s31, s3
  v_add_u32 v243, s31, v251
  v_mov_b64 v[0:1], 0
  v_mov_b64 v[2:3], 0
  v_mov_b64 v[4:5], 0
  v_mov_b64 v[6:7], 0
  v_mov_b64 v[8:9], 0
  v_mov_b64 v[10:11], 0
  v_mov_b64 v[12:13], 0
  v_mov_b64 v[14:15], 0
  v_mov_b64 v[16:17], 0
  v_mov_b64 v[18:19], 0
  v_mov_b64 v[20:21], 0
  v_mov_b64 v[22:23], 0
  v_mov_b64 v[24:25], 0
  v_mov_b64 v[26:27], 0
  v_mov_b64 v[28:29], 0
  v_mov_b64 v[30:31], 0
  v_mov_b64 v[32:33], 0
  v_mov_b64 v[34:35], 0
  v_mov_b64 v[36:37], 0
  v_mov_b64 v[38:39], 0
  v_mov_b64 v[40:41], 0
  v_mov_b64 v[42:43], 0
  v_mov_b64 v[44:45], 0
  v_mov_b64 v[46:47], 0
  v_mov_b64 v[48:49], 0
  v_mov_b64 v[50:51], 0
  v_mov_b64 v[52:53], 0
  v_mov_b64 v[54:55], 0
  v_mov_b64 v[56:57], 0
  v_mov_b64 v[58:59], 0
  v_mov_b64 v[60:61], 0
  v_mov_b64 v[62:63], 0
  v_mov_b64 v[64:65], 0
  v_mov_b64 v[66:67], 0
  v_mov_b64 v[68:69], 0
  v_mov_b64 v[70:71], 0
  v_mov_b64 v[72:73], 0
  v_mov_b64 v[74:75], 0
  v_mov_b64 v[76:77], 0
  v_mov_b64 v[78:79], 0
  v_mov_b64 v[80:81], 0
  v_mov_b64 v[82:83], 0
  v_mov_b64 v[84:85], 0
  v_mov_b64 v[86:87], 0
  v_mov_b64 v[88:89], 0
  v_mov_b64 v[90:91], 0
  v_mov_b64 v[92:93], 0
  v_mov_b64 v[94:95], 0
  s_mov_b32 s41, 1
L_sl:
  s_and_b32 s88, s86, 15
  s_lshr_b64 s[86:87], s[86:87], 4
  s_lshl_b32 s65, s88, 7
  s_lshl_b32 s66, s88, 19
  s_add_u32 m0, s62, s68
  s_add_u32 s66, s66, s61
  buffer_load_dwordx4 v224, s[72:75], s65 offen offset:0 lds
  buffer_load_dwordx4 v225, s[72:75], s65 offen offset:1024 lds
  buffer_load_dwordx4 v226, s[72:75], s65 offen offset:2048 lds
  s_add_u32 m0, s62, s69
  s_nop 0
  buffer_load_dwordx4 v227, s[76:79], s66 offen offset:0 lds
  buffer_load_dwordx4 v228, s[76:79], s66 offen offset:1024 lds
  buffer_load_dwordx4 v229, s[76:79], s66 offen offset:2048 lds
  buffer_load_dwordx4 v230, s[76:79], s66 offen offset:3072 lds
  s_add_u32 m0, s62, s69
  s_add_u32 m0, m0, 16384
  s_add_u32 s66, s66, 256
  buffer_load_dwordx4 v227, s[76:79], s66 offen offset:0 lds
  buffer_load_dwordx4 v228, s[76:79], s66 offen offset:1024 lds
  buffer_load_dwordx4 v229, s[76:79], s66 offen offset:2048 lds
  buffer_load_dwordx4 v230, s[76:79], s66 offen offset:3072 lds
  s_add_u32 s62, s62, 45056
  s_cmp_eq_u32 s62, 90112
  s_cselect_b32 s62, 118784, s62
  s_cmp_eq_u32 s62, 163840
  s_cselect_b32 s62, 0, s62
  s_waitcnt vmcnt(11)
  s_barrier
  s_add_u32 s41, s41, 1
  s_cmp_lg_u32 s41, 9
  s_cbranch_scc1 L_sl
  s_add_u32 m0, s90, 8448
  s_add_u32 s51, s44, s45
  buffer_load_dwordx4 v251, s[32:35], s51 offen nt lds
  s_add_u32 m0, s90, 8480
  s_nop 0
  buffer_load_dwordx4 v251, s[32:35], s51 offen offset:1024 nt lds
  s_xor_b32 s45, s45, s50
  s_cselect_b32 s31, 0, 8192
  s_add_u32 s44, s44, s31
  s_and_b32 s31, s44, s50
  s_add_u32 s44, s44, s31
  s_add_u32 s90, s90, 16896
  s_cmp_eq_u32 s90, s49
  s_cselect_b32 s31, 67584, 0
  s_sub_u32 s90, s90, s31
  s_add_u32 m0, s48, 0
  s_add_u32 s51, s44, s45
  buffer_load_dwordx4 v251, s[32:35], s51 offen nt lds
  s_add_u32 m0, s48, 32
  s_nop 0
  buffer_load_dwordx4 v251, s[32:35], s51 offen offset:1024 nt lds
  s_xor_b32 s45, s45, s50
  s_cselect_b32 s31, 0, 8192
  s_add_u32 s44, s44, s31
  s_and_b32 s31, s44, s50
  s_add_u32 s44, s44, s31
  s_add_u32 s48, s48, 16896
  s_cmp_eq_u32 s48, s49
  s_cselect_b32 s31, 67584, 0
  s_sub_u32 s48, s48, s31
  s_waitcnt vmcnt(4)
  s_barrier
  s_add_u32 m0, s90, 8448
  s_add_u32 s51, s46, s47
  buffer_load_dwordx4 v251, s[36:39], s51 offen nt lds
  s_add_u32 m0, s90, 8480
  s_nop 0
  buffer_load_dwordx4 v251, s[36:39], s51 offen offset:1024 nt lds
  s_cmp_eq_u32 s84, 0
  s_cselect_b32 s46, 8192, 0
  s_add_u32 s90, s90, 16896
  s_cmp_eq_u32 s90, s49
  s_cselect_b32 s31, 67584, 0
  s_sub_u32 s90, s90, s31
  s_add_u32 m0, s48, 0
  s_add_u32 s51, s44, s45
  buffer_load_dwordx4 v251, s[32:35], s51 offen nt lds
  s_add_u32 m0, s48, 32
  s_nop 0
  buffer_load_dwordx4 v251, s[32:35], s51 offen offset:1024 nt lds
  s_xor_b32 s45, s45, s50
  s_cselect_b32 s31, 0, 8192
  s_add_u32 s44, s44, s31
  s_and_b32 s31, s44, s50
  s_add_u32 s44, s44, s31
  s_add_u32 s48, s48, 16896
  s_cmp_eq_u32 s48, s49
  s_cselect_b32 s31, 67584, 0
  s_sub_u32 s48, s48, s31
  s_add_u32 m0, s90, 8448
  s_add_u32 s51, s46, s47
  buffer_load_dwordx4 v251, s[36:39], s51 offen nt lds
  s_add_u32 m0, s90, 8480
  s_nop 0
  buffer_load_dwordx4 v251, s[36:39], s51 offen offset:1024 nt lds
  s_xor_b32 s47, s47, s50
  s_cselect_b32 s31, 0, 8192
  s_add_u32 s46, s46, s31
  s_and_b32 s31, s46, s50
  s_add_u32 s46, s46, s31
  s_add_u32 s90, s90, 16896
  s_cmp_eq_u32 s90, s49
  s_cselect_b32 s31, 67584, 0
  s_sub_u32 s90, s90, s31
  s_add_u32 m0, s48, 0
  s_add_u32 s51, s44, s45
  buffer_load_dwordx4 v251, s[32:35], s51 offen nt lds
  s_add_u32 m0, s48, 32
  s_nop 0
  buffer_load_dwordx4 v251, s[32:35], s51 offen offset:1024 nt lds
  s_xor_b32 s45, s45, s50
  s_cselect_b32 s31, 0, 8192
  s_add_u32 s44, s44, s31
  s_and_b32 s31, s44, s50
  s_add_u32 s44, s44, s31
  s_add_u32 s48, s48, 16896
  s_cmp_eq_u32 s48, s49
  s_cselect_b32 s31, 67584, 0
  s_sub_u32 s48, s48, s31
  s_barrier
  s_setprio 1
  s_cmp_eq_u32 s84, 1
  s_cbranch_scc1 L_typeB
  s_waitcnt vmcnt(8)
  s_barrier
  ds_read_b128 v[96:99], v159 offset:0
  ds_read_b128 v[100:103], v159 offset:64
  ds_read_b128 v[104:107], v159 offset:128
  ds_read_b128 v[108:111], v159 offset:192
  ds_read_b128 v[112:115], v159 offset:4352
  ds_read_b128 v[116:119], v159 offset:4416
  ds_read_b128 v[120:123], v159 offset:4480
  ds_read_b128 v[124:127], v159 offset:4544
  ds_read_b128 v[128:131], v159 offset:8704
  ds_read_b128 v[132:135], v159 offset:8768
  ds_read_b128 v[136:139], v159 offset:8832
  ds_read_b128 v[140:143], v159 offset:8896
  ds_read_b128 v[208:211], v240 offset:8448
  ds_read_b128 v[212:215], v240 offset:8512
  ds_read_b128 v[216:219], v240 offset:8576
  s_waitcnt lgkmcnt(7)
  ds_read_b128 v[220:223], v240 offset:8640
  ds_read_b128 v[224:227], v240 offset:8960
  ds_read_b128 v[228:231], v240 offset:9024
  ds_read_b128 v[232:235], v240 offset:9088
  ds_read_b128 v[236:239], v240 offset:9152
  s_waitcnt lgkmcnt(7)
  v_mfma_f32_16x16x32_bf16 v[160:163], v[208:211], v[96:99], 0
  v_mfma_f32_16x16x32_bf16 v[168:171], v[208:211], v[112:115], 0
  v_mfma_f32_16x16x32_bf16 v[176:179], v[208:211], v[128:131], 0
  s_waitcnt lgkmcnt(6)
  v_mfma_f32_16x16x32_bf16 v[160:163], v[212:215], v[100:103], v[160:163]
  v_mfma_f32_16x16x32_bf16 v[168:171], v[212:215], v[116:119], v[168:171]
  v_mfma_f32_16x16x32_bf16 v[176:179], v[212:215], v[132:135], v[176:179]
  s_waitcnt lgkmcnt(5)
  v_mfma_f32_16x16x32_bf16 v[160:163], v[216:219], v[104:107], v[160:163]
  v_mfma_f32_16x16x32_bf16 v[168:171], v[216:219], v[120:123], v[168:171]
  v_mfma_f32_16x16x32_bf16 v[176:179], v[216:219], v[136:139], v[176:179]
  s_waitcnt lgkmcnt(4)
  v_mfma_f32_16x16x32_bf16 v[160:163], v[220:223], v[108:111], v[160:163]
  v_mfma_f32_16x16x32_bf16 v[168:171], v[220:223], v[124:127], v[168:171]
  v_mfma_f32_16x16x32_bf16 v[176:179], v[220:223], v[140:143], v[176:179]
  s_waitcnt lgkmcnt(3)
  v_mfma_f32_16x16x32_bf16 v[164:167], v[224:227], v[96:99], 0
  v_mfma_f32_16x16x32_bf16 v[172:175], v[224:227], v[112:115], 0
  v_mfma_f32_16x16x32_bf16 v[180:183], v[224:227], v[128:131], 0
  s_waitcnt lgkmcnt(2)
  v_mfma_f32_16x16x32_bf16 v[164:167], v[228:231], v[100:103], v[164:167]
  v_mfma_f32_16x16x32_bf16 v[172:175], v[228:231], v[116:119], v[172:175]
  v_mfma_f32_16x16x32_bf16 v[180:183], v[228:231], v[132:135], v[180:183]
  s_waitcnt lgkmcnt(1)
  v_mfma_f32_16x16x32_bf16 v[164:167], v[232:235], v[104:107], v[164:167]
  v_mfma_f32_16x16x32_bf16 v[172:175], v[232:235], v[120:123], v[172:175]
  v_mfma_f32_16x16x32_bf16 v[180:183], v[232:235], v[136:139], v[180:183]
  ds_read_b128 v[232:235], v240 offset:640
  s_waitcnt lgkmcnt(1)
  v_mfma_f32_16x16x32_bf16 v[164:167], v[236:239], v[108:111], v[164:167]
  v_mfma_f32_16x16x32_bf16 v[172:175], v[236:239], v[124:127], v[172:175]
  v_mfma_f32_16x16x32_bf16 v[180:183], v[236:239], v[140:143], v[180:183]
  ds_read_b128 v[236:239], v240 offset:704
  ds_read_b128 v[208:211], v240 offset:0
  ds_read_b128 v[212:215], v240 offset:64
  ds_read_b128 v[216:219], v240 offset:128
  ds_read_b128 v[220:223], v240 offset:192
  ds_read_b128 v[224:227], v240 offset:512
  ds_read_b128 v[228:231], v240 offset:576
  v_max3_f32 v248, v160, v161, v162
  v_max3_f32 v248, v248, v163, v164
  v_max3_f32 v248, v248, v165, v166
  v_max_f32 v248, v248, v167
  v_mov_b32 v249, v248
  s_nop 1
  v_permlane16_swap_b32 v249, v248
  v_max_f32 v248, v248, v249
  v_mov_b32 v249, v248
  s_nop 1
  v_permlane32_swap_b32 v249, v248
  v_max_f32 v248, v248, v249
  v_sub_f32 v144, 0, v248
  v_sub_f32 v145, 0, v248
  v_sub_f32 v146, 0, v248
  v_sub_f32 v147, 0, v248
  v_sub_f32 v160, v160, v248
  v_sub_f32 v161, v161, v248
  v_sub_f32 v162, v162, v248
  v_sub_f32 v163, v163, v248
  v_sub_f32 v164, v164, v248
  v_sub_f32 v165, v165, v248
  v_sub_f32 v166, v166, v248
  v_sub_f32 v167, v167, v248
  v_max3_f32 v248, v168, v169, v170
  v_max3_f32 v248, v248, v171, v172
  v_max3_f32 v248, v248, v173, v174
  v_max_f32 v248, v248, v175
  v_mov_b32 v249, v248
  s_nop 1
  v_permlane16_swap_b32 v249, v248
  v_max_f32 v248, v248, v249
  v_mov_b32 v249, v248
  s_nop 1
  v_permlane32_swap_b32 v249, v248
  v_max_f32 v248, v248, v249
  v_sub_f32 v148, 0, v248
  v_sub_f32 v149, 0, v248
  v_sub_f32 v150, 0, v248
  v_sub_f32 v151, 0, v248
  v_sub_f32 v168, v168, v248
  v_sub_f32 v169, v169, v248
  v_sub_f32 v170, v170, v248
  v_sub_f32 v171, v171, v248
  v_sub_f32 v172, v172, v248
  v_sub_f32 v173, v173, v248
  v_sub_f32 v174, v174, v248
  v_sub_f32 v175, v175, v248
  v_max3_f32 v248, v176, v177, v178
  v_max3_f32 v248, v248, v179, v180
  v_max3_f32 v248, v248, v181, v182
  v_max_f32 v248, v248, v183
  v_mov_b32 v249, v248
  s_nop 1
  v_permlane16_swap_b32 v249, v248
  v_max_f32 v248, v248, v249
  v_mov_b32 v249, v248
  s_nop 1
  v_permlane32_swap_b32 v249, v248
  v_max_f32 v248, v248, v249
  v_sub_f32 v152, 0, v248
  v_sub_f32 v153, 0, v248
  v_sub_f32 v154, 0, v248
  v_sub_f32 v155, 0, v248
  v_sub_f32 v176, v176, v248
  v_sub_f32 v177, v177, v248
  v_sub_f32 v178, v178, v248
  v_sub_f32 v179, v179, v248
  v_sub_f32 v180, v180, v248
  v_sub_f32 v181, v181, v248
  v_sub_f32 v182, v182, v248
  v_sub_f32 v183, v183, v248
  v_mov_b32 v156, 0
  v_mov_b32 v157, 0
  v_mov_b32 v158, 0
  v_exp_f32 v160, v160
  v_exp_f32 v161, v161
  v_add_f32 v156, v156, v160
  v_exp_f32 v162, v162
  v_add_f32 v156, v156, v161
  v_exp_f32 v163, v163
  v_cvt_pk_bf16_f32 v160, v160, v161
  v_exp_f32 v164, v164
  v_add_f32 v156, v156, v162
  v_exp_f32 v165, v165
  v_add_f32 v156, v156, v163
  v_exp_f32 v166, v166
  v_cvt_pk_bf16_f32 v161, v162, v163
  v_add_f32 v156, v156, v164
  v_exp_f32 v167, v167
  v_add_f32 v156, v156, v165
  v_cvt_pk_bf16_f32 v162, v164, v165
  v_add_f32 v156, v156, v166
  v_add_f32 v156, v156, v167
  v_cvt_pk_bf16_f32 v163, v166, v167
  v_exp_f32 v168, v168
  v_exp_f32 v169, v169
  v_add_f32 v157, v157, v168
  v_exp_f32 v170, v170
  v_add_f32 v157, v157, v169
  s_waitcnt lgkmcnt(0)
  s_waitcnt vmcnt(0)
L_G:
  s_add_u32 s40, s40, 1
  s_cmp_eq_u32 s40, 4
  s_cselect_b32 s57, s56, s43
  s_cselect_b32 s40, 0, s40
  v_add_u32 v241, s57, v241
  v_add_u32 v240, s57, v240
  s_mov_b32 s41, 15
L_loop_145:
  s_barrier
  v_mfma_f32_16x16x32_bf16 v[184:187], v[208:211], v[96:99], v[144:147]
  ds_read_b64_tr_b16 v[244:245], v241 offset:192
  v_exp_f32 v171, v171
  v_mfma_f32_16x16x32_bf16 v[192:195], v[208:211], v[112:115], v[148:151]
  ds_read_b64_tr_b16 v[246:247], v241 offset:704
  v_cvt_pk_bf16_f32 v168, v168, v169
  v_mfma_f32_16x16x32_bf16 v[200:203], v[208:211], v[128:131], v[152:155]
  ds_read_b64_tr_b16 v[208:209], v241 offset:0
  v_exp_f32 v172, v172
  v_mfma_f32_16x16x32_bf16 v[184:187], v[212:215], v[100:103], v[184:187]
  ds_read_b64_tr_b16 v[210:211], v241 offset:512
  v_add_f32 v157, v157, v170
  v_mfma_f32_16x16x32_bf16 v[192:195], v[212:215], v[116:119], v[192:195]
  ds_read_b64_tr_b16 v[252:253], v241 offset:224
  v_exp_f32 v173, v173
  v_mfma_f32_16x16x32_bf16 v[200:203], v[212:215], v[132:135], v[200:203]
  ds_read_b64_tr_b16 v[212:213], v241 offset:32
  v_add_f32 v157, v157, v171
  v_mfma_f32_16x16x32_bf16 v[184:187], v[216:219], v[104:107], v[184:187]
  ds_read_b64_tr_b16 v[214:215], v241 offset:544
  v_exp_f32 v174, v174
  v_mfma_f32_16x16x32_bf16 v[192:195], v[216:219], v[120:123], v[192:195]
  ds_read_b64_tr_b16 v[254:255], v241 offset:736
  v_cvt_pk_bf16_f32 v169, v170, v171
  v_add_f32 v157, v157, v172
  v_mfma_f32_16x16x32_bf16 v[200:203], v[216:219], v[136:139], v[200:203]
  ds_read_b64_tr_b16 v[216:217], v241 offset:64
  v_exp_f32 v175, v175
  v_mfma_f32_16x16x32_bf16 v[184:187], v[220:223], v[108:111], v[184:187]
  ds_read_b64_tr_b16 v[218:219], v241 offset:576
  v_add_f32 v157, v157, v173
  v_cvt_pk_bf16_f32 v170, v172, v173
  v_mfma_f32_16x16x32_bf16 v[192:195], v[220:223], v[124:127], v[192:195]
  v_add_f32 v157, v157, v174
  v_add_f32 v157, v157, v175
  v_cvt_pk_bf16_f32 v171, v174, v175
  v_mfma_f32_16x16x32_bf16 v[200:203], v[220:223], v[140:143], v[200:203]
  ds_read_b64_tr_b16 v[220:221], v241 offset:96
  v_exp_f32 v176, v176
  v_mfma_f32_16x16x32_bf16 v[188:191], v[224:227], v[96:99], v[144:147]
  ds_read_b64_tr_b16 v[222:223], v241 offset:608
  v_exp_f32 v177, v177
  v_mfma_f32_16x16x32_bf16 v[196:199], v[224:227], v[112:115], v[148:151]
  v_add_f32 v158, v158, v176
  v_exp_f32 v178, v178
  v_mfma_f32_16x16x32_bf16 v[204:207], v[224:227], v[128:131], v[152:155]
  ds_read_b64_tr_b16 v[224:225], v241 offset:128
  v_add_f32 v158, v158, v177
  v_mfma_f32_16x16x32_bf16 v[188:191], v[228:231], v[100:103], v[188:191]
  ds_read_b64_tr_b16 v[226:227], v241 offset:640
  v_exp_f32 v179, v179
  v_mfma_f32_16x16x32_bf16 v[196:199], v[228:231], v[116:119], v[196:199]
  v_cvt_pk_bf16_f32 v176, v176, v177
  v_exp_f32 v180, v180
  v_mfma_f32_16x16x32_bf16 v[204:207], v[228:231], v[132:135], v[204:207]
  ds_read_b64_tr_b16 v[228:229], v241 offset:160
  v_add_f32 v158, v158, v178
  v_mfma_f32_16x16x32_bf16 v[188:191], v[232:235], v[104:107], v[188:191]
  s_waitcnt lgkmcnt(7)
  ds_read_b64_tr_b16 v[230:231], v241 offset:672
  v_exp_f32 v181, v181
  v_mfma_f32_16x16x32_bf16 v[196:199], v[232:235], v[120:123], v[196:199]
  v_add_f32 v158, v158, v179
  v_exp_f32 v182, v182
  v_mfma_f32_16x16x32_bf16 v[204:207], v[232:235], v[136:139], v[204:207]
  ds_read_b128 v[232:235], v240 offset:640
  v_cvt_pk_bf16_f32 v177, v178, v179
  v_mfma_f32_16x16x32_bf16 v[188:191], v[236:239], v[108:111], v[188:191]
  v_add_f32 v158, v158, v180
  v_exp_f32 v183, v183
  v_mfma_f32_16x16x32_bf16 v[196:199], v[236:239], v[124:127], v[196:199]
  v_add_f32 v158, v158, v181
  v_cvt_pk_bf16_f32 v178, v180, v181
  v_add_f32 v158, v158, v182
  v_mfma_f32_16x16x32_bf16 v[204:207], v[236:239], v[140:143], v[204:207]
  ds_read_b128 v[236:239], v240 offset:704
  v_add_f32 v158, v158, v183
  v_cvt_pk_bf16_f32 v179, v182, v183
  s_waitcnt lgkmcnt(8)
  v_mfma_f32_16x16x32_bf16 v[0:3], v[208:211], v[160:163], v[0:3]
  v_max_f32 v248, v184, v185
  v_max3_f32 v248, v248, v186, v187
  v_max3_f32 v248, v248, v192, v193
  v_mfma_f32_16x16x32_bf16 v[32:35], v[208:211], v[168:171], v[32:35]
  v_max3_f32 v248, v248, v194, v195
  v_max3_f32 v248, v248, v200, v201
  v_mfma_f32_16x16x32_bf16 v[64:67], v[208:211], v[176:179], v[64:67]
  ds_read_b128 v[208:211], v240 offset:0
  v_max3_f32 v248, v248, v202, v203
  v_mfma_f32_16x16x32_bf16 v[4:7], v[212:215], v[160:163], v[4:7]
  v_max3_f32 v248, v248, v188, v189
  v_max3_f32 v248, v248, v190, v191
  v_max3_f32 v248, v248, v196, v197
  v_mfma_f32_16x16x32_bf16 v[36:39], v[212:215], v[168:171], v[36:39]
  v_max3_f32 v248, v248, v198, v199
  v_max3_f32 v248, v248, v204, v205
  v_mfma_f32_16x16x32_bf16 v[68:71], v[212:215], v[176:179], v[68:71]
  ds_read_b128 v[212:215], v240 offset:64
  v_max3_f32 v248, v248, v206, v207
  v_cmp_lt_f32 vcc, s42, v248
  s_cbranch_vccnz L_rare_146
  v_mfma_f32_16x16x32_bf16 v[8:11], v[216:219], v[160:163], v[8:11]
  s_add_u32 s40, s40, 1
  s_cmp_eq_u32 s40, 4
  s_cselect_b32 s57, s56, s43
  s_cselect_b32 s40, 0, s40
  v_mfma_f32_16x16x32_bf16 v[40:43], v[216:219], v[168:171], v[40:43]
  v_add_u32 v241, s57, v241
  v_exp_f32 v184, v184
  v_mfma_f32_16x16x32_bf16 v[72:75], v[216:219], v[176:179], v[72:75]
  ds_read_b128 v[216:219], v240 offset:128
  s_waitcnt lgkmcnt(5)
  v_mfma_f32_16x16x32_bf16 v[12:15], v[220:223], v[160:163], v[12:15]
  v_exp_f32 v185, v185
  v_add_f32 v156, v156, v184
  v_mfma_f32_16x16x32_bf16 v[44:47], v[220:223], v[168:171], v[44:47]
  v_exp_f32 v186, v186
  v_add_f32 v156, v156, v185
  v_mfma_f32_16x16x32_bf16 v[76:79], v[220:223], v[176:179], v[76:79]
  ds_read_b128 v[220:223], v240 offset:192
  v_mfma_f32_16x16x32_bf16 v[16:19], v[224:227], v[160:163], v[16:19]
  v_exp_f32 v187, v187
  v_cvt_pk_bf16_f32 v184, v184, v185
  v_mfma_f32_16x16x32_bf16 v[48:51], v[224:227], v[168:171], v[48:51]
  v_exp_f32 v188, v188
  v_add_f32 v156, v156, v186
  v_mfma_f32_16x16x32_bf16 v[80:83], v[224:227], v[176:179], v[80:83]
  ds_read_b128 v[224:227], v240 offset:512
  v_mfma_f32_16x16x32_bf16 v[20:23], v[228:231], v[160:163], v[20:23]
  v_exp_f32 v189, v189
  v_add_f32 v156, v156, v187
  v_mfma_f32_16x16x32_bf16 v[52:55], v[228:231], v[168:171], v[52:55]
  v_exp_f32 v190, v190
  v_cvt_pk_bf16_f32 v185, v186, v187
  v_mfma_f32_16x16x32_bf16 v[84:87], v[228:231], v[176:179], v[84:87]
  ds_read_b128 v[228:231], v240 offset:576
  v_add_f32 v156, v156, v188
  v_mfma_f32_16x16x32_bf16 v[24:27], v[244:247], v[160:163], v[24:27]
  v_exp_f32 v191, v191
  v_add_f32 v156, v156, v189
  v_mfma_f32_16x16x32_bf16 v[56:59], v[244:247], v[168:171], v[56:59]
  v_cvt_pk_bf16_f32 v186, v188, v189
  v_add_f32 v156, v156, v190
  v_mfma_f32_16x16x32_bf16 v[88:91], v[244:247], v[176:179], v[88:91]
  v_add_f32 v156, v156, v191
  v_cvt_pk_bf16_f32 v187, v190, v191
  v_mfma_f32_16x16x32_bf16 v[28:31], v[252:255], v[160:163], v[28:31]
  v_exp_f32 v192, v192
  v_mfma_f32_16x16x32_bf16 v[60:63], v[252:255], v[168:171], v[60:63]
  v_exp_f32 v193, v193
  v_add_f32 v157, v157, v192
  v_mfma_f32_16x16x32_bf16 v[92:95], v[252:255], v[176:179], v[92:95]
  v_exp_f32 v194, v194
  v_add_f32 v157, v157, v193
L_rareb_147:
  v_add_u32 v240, s57, v240
  s_waitcnt lgkmcnt(0)
  s_barrier
  v_mfma_f32_16x16x32_bf16 v[160:163], v[208:211], v[96:99], v[144:147]
  ds_read_b64_tr_b16 v[244:245], v241 offset:192
  v_exp_f32 v195, v195
  v_mfma_f32_16x16x32_bf16 v[168:171], v[208:211], v[112:115], v[148:151]
  ds_read_b64_tr_b16 v[246:247], v241 offset:704
  v_cvt_pk_bf16_f32 v192, v192, v193
  v_mfma_f32_16x16x32_bf16 v[176:179], v[208:211], v[128:131], v[152:155]
  ds_read_b64_tr_b16 v[208:209], v241 offset:0
  v_exp_f32 v196, v196
  v_mfma_f32_16x16x32_bf16 v[160:163], v[212:215], v[100:103], v[160:163]
  ds_read_b64_tr_b16 v[210:211], v241 offset:512
  v_add_f32 v157, v157, v194
  v_mfma_f32_16x16x32_bf16 v[168:171], v[212:215], v[116:119], v[168:171]
  ds_read_b64_tr_b16 v[252:253], v241 offset:224
  v_exp_f32 v197, v197
  v_mfma_f32_16x16x32_bf16 v[176:179], v[212:215], v[132:135], v[176:179]
  ds_read_b64_tr_b16 v[212:213], v241 offset:32
  v_add_f32 v157, v157, v195
  v_mfma_f32_16x16x32_bf16 v[160:163], v[216:219], v[104:107], v[160:163]
  ds_read_b64_tr_b16 v[214:215], v241 offset:544
  v_exp_f32 v198, v198
  v_mfma_f32_16x16x32_bf16 v[168:171], v[216:219], v[120:123], v[168:171]
  ds_read_b64_tr_b16 v[254:255], v241 offset:736
  v_cvt_pk_bf16_f32 v193, v194, v195
  v_add_f32 v157, v157, v196
  v_mfma_f32_16x16x32_bf16 v[176:179], v[216:219], v[136:139], v[176:179]
  ds_read_b64_tr_b16 v[216:217], v241 offset:64
  v_exp_f32 v199, v199
  v_mfma_f32_16x16x32_bf16 v[160:163], v[220:223], v[108:111], v[160:163]
  ds_read_b64_tr_b16 v[218:219], v241 offset:576
  v_add_f32 v157, v157, v197
  v_cvt_pk_bf16_f32 v194, v196, v197
  v_mfma_f32_16x16x32_bf16 v[168:171], v[220:223], v[124:127], v[168:171]
  v_add_f32 v157, v157, v198
  v_add_f32 v157, v157, v199
  v_cvt_pk_bf16_f32 v195, v198, v199
  v_mfma_f32_16x16x32_bf16 v[176:179], v[220:223], v[140:143], v[176:179]
  ds_read_b64_tr_b16 v[220:221], v241 offset:96
  v_exp_f32 v200, v200
  v_mfma_f32_16x16x32_bf16 v[164:167], v[224:227], v[96:99], v[144:147]
  ds_read_b64_tr_b16 v[222:223], v241 offset:608
  v_exp_f32 v201, v201
  v_mfma_f32_16x16x32_bf16 v[172:175], v[224:227], v[112:115], v[148:151]
  v_add_f32 v158, v158, v200
  v_exp_f32 v202, v202
  v_mfma_f32_16x16x32_bf16 v[180:183], v[224:227], v[128:131], v[152:155]
  ds_read_b64_tr_b16 v[224:225], v241 offset:128
  v_add_f32 v158, v158, v201
  v_mfma_f32_16x16x32_bf16 v[164:167], v[228:231], v[100:103], v[164:167]
  ds_read_b64_tr_b16 v[226:227], v241 offset:640
  v_exp_f32 v203, v203
  v_mfma_f32_16x16x32_bf16 v[172:175], v[228:231], v[116:119], v[172:175]
  v_cvt_pk_bf16_f32 v200, v200, v201
  v_exp_f32 v204, v204
  v_mfma_f32_16x16x32_bf16 v[180:183], v[228:231], v[132:135], v[180:183]
  ds_read_b64_tr_b16 v[228:229], v241 offset:160
  v_add_f32 v158, v158, v202
  v_mfma_f32_16x16x32_bf16 v[164:167], v[232:235], v[104:107], v[164:167]
  s_waitcnt lgkmcnt(7)
  ds_read_b64_tr_b16 v[230:231], v241 offset:672
  v_exp_f32 v205, v205
  v_mfma_f32_16x16x32_bf16 v[172:175], v[232:235], v[120:123], v[172:175]
  v_add_f32 v158, v158, v203
  v_exp_f32 v206, v206
  v_mfma_f32_16x16x32_bf16 v[180:183], v[232:235], v[136:139], v[180:183]
  ds_read_b128 v[232:235], v240 offset:640
  v_cvt_pk_bf16_f32 v201, v202, v203
  v_mfma_f32_16x16x32_bf16 v[164:167], v[236:239], v[108:111], v[164:167]
  v_add_f32 v158, v158, v204
  v_exp_f32 v207, v207
  v_mfma_f32_16x16x32_bf16 v[172:175], v[236:239], v[124:127], v[172:175]
  v_add_f32 v158, v158, v205
  v_cvt_pk_bf16_f32 v202, v204, v205
  v_add_f32 v158, v158, v206
  v_mfma_f32_16x16x32_bf16 v[180:183], v[236:239], v[140:143], v[180:183]
  ds_read_b128 v[236:239], v240 offset:704
  v_add_f32 v158, v158, v207
  v_cvt_pk_bf16_f32 v203, v206, v207
  s_waitcnt lgkmcnt(8)
  v_mfma_f32_16x16x32_bf16 v[0:3], v[208:211], v[184:187], v[0:3]
  v_max_f32 v248, v160, v161
  v_max3_f32 v248, v248, v162, v163
  v_max3_f32 v248, v248, v168, v169
  v_mfma_f32_16x16x32_bf16 v[32:35], v[208:211], v[192:195], v[32:35]
  v_max3_f32 v248, v248, v170, v171
  v_max3_f32 v248, v248, v176, v177
  v_mfma_f32_16x16x32_bf16 v[64:67], v[208:211], v[200:203], v[64:67]
  ds_read_b128 v[208:211], v240 offset:0
  v_max3_f32 v248, v248, v178, v179
  v_mfma_f32_16x16x32_bf16 v[4:7], v[212:215], v[184:187], v[4:7]
  v_max3_f32 v248, v248, v164, v165
  v_max3_f32 v248, v248, v166, v167
  v_max3_f32 v248, v248, v172, v173
  v_mfma_f32_16x16x32_bf16 v[36:39], v[212:215], v[192:195], v[36:39]
  v_max3_f32 v248, v248, v174, v175
  v_max3_f32 v248, v248, v180, v181
  v_mfma_f32_16x16x32_bf16 v[68:71], v[212:215], v[200:203], v[68:71]
  ds_read_b128 v[212:215], v240 offset:64
  v_max3_f32 v248, v248, v182, v183
  v_cmp_lt_f32 vcc, s42, v248
  s_cbranch_vccnz L_rare_148
  v_mfma_f32_16x16x32_bf16 v[8:11], v[216:219], v[184:187], v[8:11]
  s_add_u32 s40, s40, 1
  s_cmp_eq_u32 s40, 4
  s_cselect_b32 s57, s56, s43
  s_cselect_b32 s40, 0, s40
  v_mfma_f32_16x16x32_bf16 v[40:43], v[216:219], v[192:195], v[40:43]
  v_add_u32 v241, s57, v241
  v_exp_f32 v160, v160
  v_mfma_f32_16x16x32_bf16 v[72:75], v[216:219], v[200:203], v[72:75]
  ds_read_b128 v[216:219], v240 offset:128
  s_waitcnt lgkmcnt(5)
  v_mfma_f32_16x16x32_bf16 v[12:15], v[220:223], v[184:187], v[12:15]
  v_exp_f32 v161, v161
  v_add_f32 v156, v156, v160
  v_mfma_f32_16x16x32_bf16 v[44:47], v[220:223], v[192:195], v[44:47]
  v_exp_f32 v162, v162
  v_add_f32 v156, v156, v161
  v_mfma_f32_16x16x32_bf16 v[76:79], v[220:223], v[200:203], v[76:79]
  ds_read_b128 v[220:223], v240 offset:192
  v_mfma_f32_16x16x32_bf16 v[16:19], v[224:227], v[184:187], v[16:19]
  v_exp_f32 v163, v163
  v_cvt_pk_bf16_f32 v160, v160, v161
  v_mfma_f32_16x16x32_bf16 v[48:51], v[224:227], v[192:195], v[48:51]
  v_exp_f32 v164, v164
  v_add_f32 v156, v156, v162
  v_mfma_f32_16x16x32_bf16 v[80:83], v[224:227], v[200:203], v[80:83]
  ds_read_b128 v[224:227], v240 offset:512
  v_mfma_f32_16x16x32_bf16 v[20:23], v[228:231], v[184:187], v[20:23]
  v_exp_f32 v165, v165
  v_add_f32 v156, v156, v163
  v_mfma_f32_16x16x32_bf16 v[52:55], v[228:231], v[192:195], v[52:55]
  v_exp_f32 v166, v166
  v_cvt_pk_bf16_f32 v161, v162, v163
  v_mfma_f32_16x16x32_bf16 v[84:87], v[228:231], v[200:203], v[84:87]
  ds_read_b128 v[228:231], v240 offset:576
  v_add_f32 v156, v156, v164
  v_mfma_f32_16x16x32_bf16 v[24:27], v[244:247], v[184:187], v[24:27]
  v_exp_f32 v167, v167
  v_add_f32 v156, v156, v165
  v_mfma_f32_16x16x32_bf16 v[56:59], v[244:247], v[192:195], v[56:59]
  v_cvt_pk_bf16_f32 v162, v164, v165
  v_add_f32 v156, v156, v166
  v_mfma_f32_16x16x32_bf16 v[88:91], v[244:247], v[200:203], v[88:91]
  v_add_f32 v156, v156, v167
  v_cvt_pk_bf16_f32 v163, v166, v167
  v_mfma_f32_16x16x32_bf16 v[28:31], v[252:255], v[184:187], v[28:31]
  v_exp_f32 v168, v168
  v_mfma_f32_16x16x32_bf16 v[60:63], v[252:255], v[192:195], v[60:63]
  v_exp_f32 v169, v169
  v_add_f32 v157, v157, v168
  v_mfma_f32_16x16x32_bf16 v[92:95], v[252:255], v[200:203], v[92:95]
  v_exp_f32 v170, v170
  v_add_f32 v157, v157, v169
L_rareb_149:
  v_add_u32 v240, s57, v240
  s_waitcnt lgkmcnt(0)
  s_sub_u32 s41, s41, 1
  s_cmp_lg_u32 s41, 0
  s_cbranch_scc1 L_loop_145
  s_barrier
  v_mfma_f32_16x16x32_bf16 v[184:187], v[208:211], v[96:99], v[144:147]
  ds_read_b64_tr_b16 v[244:245], v241 offset:192
  v_exp_f32 v171, v171
  v_mfma_f32_16x16x32_bf16 v[192:195], v[208:211], v[112:115], v[148:151]
  ds_read_b64_tr_b16 v[246:247], v241 offset:704
  v_cvt_pk_bf16_f32 v168, v168, v169
  v_mfma_f32_16x16x32_bf16 v[200:203], v[208:211], v[128:131], v[152:155]
  ds_read_b64_tr_b16 v[208:209], v241 offset:0
  v_exp_f32 v172, v172
  v_mfma_f32_16x16x32_bf16 v[184:187], v[212:215], v[100:103], v[184:187]
  ds_read_b64_tr_b16 v[210:211], v241 offset:512
  v_add_f32 v157, v157, v170
  v_mfma_f32_16x16x32_bf16 v[192:195], v[212:215], v[116:119], v[192:195]
  ds_read_b64_tr_b16 v[252:253], v241 offset:224
  v_exp_f32 v173, v173
  v_mfma_f32_16x16x32_bf16 v[200:203], v[212:215], v[132:135], v[200:203]
  ds_read_b64_tr_b16 v[212:213], v241 offset:32
  v_add_f32 v157, v157, v171
  v_mfma_f32_16x16x32_bf16 v[184:187], v[216:219], v[104:107], v[184:187]
  ds_read_b64_tr_b16 v[214:215], v241 offset:544
  v_exp_f32 v174, v174
  v_mfma_f32_16x16x32_bf16 v[192:195], v[216:219], v[120:123], v[192:195]
  ds_read_b64_tr_b16 v[254:255], v241 offset:736
  v_cvt_pk_bf16_f32 v169, v170, v171
  v_add_f32 v157, v157, v172
  v_mfma_f32_16x16x32_bf16 v[200:203], v[216:219], v[136:139], v[200:203]
  ds_read_b64_tr_b16 v[216:217], v241 offset:64
  v_exp_f32 v175, v175
  v_mfma_f32_16x16x32_bf16 v[184:187], v[220:223], v[108:111], v[184:187]
  ds_read_b64_tr_b16 v[218:219], v241 offset:576
  v_add_f32 v157, v157, v173
  v_cvt_pk_bf16_f32 v170, v172, v173
  v_mfma_f32_16x16x32_bf16 v[192:195], v[220:223], v[124:127], v[192:195]
  v_add_f32 v157, v157, v174
  v_add_f32 v157, v157, v175
  v_cvt_pk_bf16_f32 v171, v174, v175
  v_mfma_f32_16x16x32_bf16 v[200:203], v[220:223], v[140:143], v[200:203]
  ds_read_b64_tr_b16 v[220:221], v241 offset:96
  v_exp_f32 v176, v176
  v_mfma_f32_16x16x32_bf16 v[188:191], v[224:227], v[96:99], v[144:147]
  ds_read_b64_tr_b16 v[222:223], v241 offset:608
  v_exp_f32 v177, v177
  v_mfma_f32_16x16x32_bf16 v[196:199], v[224:227], v[112:115], v[148:151]
  v_add_f32 v158, v158, v176
  v_exp_f32 v178, v178
  v_mfma_f32_16x16x32_bf16 v[204:207], v[224:227], v[128:131], v[152:155]
  ds_read_b64_tr_b16 v[224:225], v241 offset:128
  v_add_f32 v158, v158, v177
  v_mfma_f32_16x16x32_bf16 v[188:191], v[228:231], v[100:103], v[188:191]
  ds_read_b64_tr_b16 v[226:227], v241 offset:640
  v_exp_f32 v179, v179
  v_mfma_f32_16x16x32_bf16 v[196:199], v[228:231], v[116:119], v[196:199]
  v_cvt_pk_bf16_f32 v176, v176, v177
  v_exp_f32 v180, v180
  v_mfma_f32_16x16x32_bf16 v[204:207], v[228:231], v[132:135], v[204:207]
  ds_read_b64_tr_b16 v[228:229], v241 offset:160
  v_add_f32 v158, v158, v178
  v_mfma_f32_16x16x32_bf16 v[188:191], v[232:235], v[104:107], v[188:191]
  s_waitcnt lgkmcnt(7)
  ds_read_b64_tr_b16 v[230:231], v241 offset:672
  v_exp_f32 v181, v181
  v_mfma_f32_16x16x32_bf16 v[196:199], v[232:235], v[120:123], v[196:199]
  v_add_f32 v158, v158, v179
  v_exp_f32 v182, v182
  v_mfma_f32_16x16x32_bf16 v[204:207], v[232:235], v[136:139], v[204:207]
  ds_read_b128 v[232:235], v240 offset:640
  v_cvt_pk_bf16_f32 v177, v178, v179
  v_mfma_f32_16x16x32_bf16 v[188:191], v[236:239], v[108:111], v[188:191]
  v_add_f32 v158, v158, v180
  v_exp_f32 v183, v183
  v_mfma_f32_16x16x32_bf16 v[196:199], v[236:239], v[124:127], v[196:199]
  v_add_f32 v158, v158, v181
  v_cvt_pk_bf16_f32 v178, v180, v181
  v_add_f32 v158, v158, v182
  v_mfma_f32_16x16x32_bf16 v[204:207], v[236:239], v[140:143], v[204:207]
  ds_read_b128 v[236:239], v240 offset:704
  v_add_f32 v158, v158, v183
  v_cvt_pk_bf16_f32 v179, v182, v183
  s_waitcnt lgkmcnt(8)
  v_mfma_f32_16x16x32_bf16 v[0:3], v[208:211], v[160:163], v[0:3]
  v_max_f32 v248, v184, v185
  v_max3_f32 v248, v248, v186, v187
  v_max3_f32 v248, v248, v192, v193
  v_mfma_f32_16x16x32_bf16 v[32:35], v[208:211], v[168:171], v[32:35]
  v_max3_f32 v248, v248, v194, v195
  v_max3_f32 v248, v248, v200, v201
  v_mfma_f32_16x16x32_bf16 v[64:67], v[208:211], v[176:179], v[64:67]
  ds_read_b128 v[208:211], v240 offset:0
  v_max3_f32 v248, v248, v202, v203
  v_mfma_f32_16x16x32_bf16 v[4:7], v[212:215], v[160:163], v[4:7]
  v_max3_f32 v248, v248, v188, v189
  v_max3_f32 v248, v248, v190, v191
  v_max3_f32 v248, v248, v196, v197
  v_mfma_f32_16x16x32_bf16 v[36:39], v[212:215], v[168:171], v[36:39]
  v_max3_f32 v248, v248, v198, v199
  v_max3_f32 v248, v248, v204, v205
  v_mfma_f32_16x16x32_bf16 v[68:71], v[212:215], v[176:179], v[68:71]
  ds_read_b128 v[212:215], v240 offset:64
  v_max3_f32 v248, v248, v206, v207
  v_cmp_lt_f32 vcc, s42, v248
  s_cbranch_vccnz L_rare_150
  v_mfma_f32_16x16x32_bf16 v[8:11], v[216:219], v[160:163], v[8:11]
  s_add_u32 s40, s40, 1
  s_cmp_eq_u32 s40, 4
  s_cselect_b32 s57, s56, s43
  s_cselect_b32 s40, 0, s40
  v_mfma_f32_16x16x32_bf16 v[40:43], v[216:219], v[168:171], v[40:43]
  v_add_u32 v241, s57, v241
  v_exp_f32 v184, v184
  v_mfma_f32_16x16x32_bf16 v[72:75], v[216:219], v[176:179], v[72:75]
  ds_read_b128 v[216:219], v240 offset:128
  s_waitcnt lgkmcnt(5)
  v_mfma_f32_16x16x32_bf16 v[12:15], v[220:223], v[160:163], v[12:15]
  v_exp_f32 v185, v185
  v_add_f32 v156, v156, v184
  v_mfma_f32_16x16x32_bf16 v[44:47], v[220:223], v[168:171], v[44:47]
  v_exp_f32 v186, v186
  v_add_f32 v156, v156, v185
  v_mfma_f32_16x16x32_bf16 v[76:79], v[220:223], v[176:179], v[76:79]
  ds_read_b128 v[220:223], v240 offset:192
  v_mfma_f32_16x16x32_bf16 v[16:19], v[224:227], v[160:163], v[16:19]
  v_exp_f32 v187, v187
  v_cvt_pk_bf16_f32 v184, v184, v185
  v_mfma_f32_16x16x32_bf16 v[48:51], v[224:227], v[168:171], v[48:51]
  v_exp_f32 v188, v188
  v_add_f32 v156, v156, v186
  v_mfma_f32_16x16x32_bf16 v[80:83], v[224:227], v[176:179], v[80:83]
  ds_read_b128 v[224:227], v240 offset:512
  v_mfma_f32_16x16x32_bf16 v[20:23], v[228:231], v[160:163], v[20:23]
  v_exp_f32 v189, v189
  v_add_f32 v156, v156, v187
  v_mfma_f32_16x16x32_bf16 v[52:55], v[228:231], v[168:171], v[52:55]
  v_exp_f32 v190, v190
  v_cvt_pk_bf16_f32 v185, v186, v187
  v_mfma_f32_16x16x32_bf16 v[84:87], v[228:231], v[176:179], v[84:87]
  ds_read_b128 v[228:231], v240 offset:576
  v_add_f32 v156, v156, v188
  v_mfma_f32_16x16x32_bf16 v[24:27], v[244:247], v[160:163], v[24:27]
  v_exp_f32 v191, v191
  v_add_f32 v156, v156, v189
  v_mfma_f32_16x16x32_bf16 v[56:59], v[244:247], v[168:171], v[56:59]
  v_cvt_pk_bf16_f32 v186, v188, v189
  v_add_f32 v156, v156, v190
  v_mfma_f32_16x16x32_bf16 v[88:91], v[244:247], v[176:179], v[88:91]
  v_add_f32 v156, v156, v191
  v_cvt_pk_bf16_f32 v187, v190, v191
  v_mfma_f32_16x16x32_bf16 v[28:31], v[252:255], v[160:163], v[28:31]
  v_exp_f32 v192, v192
  v_mfma_f32_16x16x32_bf16 v[60:63], v[252:255], v[168:171], v[60:63]
  v_exp_f32 v193, v193
  v_add_f32 v157, v157, v192
  v_mfma_f32_16x16x32_bf16 v[92:95], v[252:255], v[176:179], v[92:95]
  v_exp_f32 v194, v194
  v_add_f32 v157, v157, v193
L_rareb_151:
  v_add_u32 v240, s57, v240
  s_waitcnt lgkmcnt(0)
  s_cmp_eq_u32 s59, 1
  s_cbranch_scc1 L_last
  s_mov_b32 s59, 1
  ds_read_b128 v[96:99], v159 offset:0
  ds_read_b128 v[100:103], v159 offset:64
  ds_read_b128 v[104:107], v159 offset:128
  ds_read_b128 v[108:111], v159 offset:192
  ds_read_b128 v[112:115], v159 offset:4352
  ds_read_b128 v[116:119], v159 offset:4416
  ds_read_b128 v[120:123], v159 offset:4480
  ds_read_b128 v[124:127], v159 offset:4544
  ds_read_b128 v[128:131], v159 offset:8704
  ds_read_b128 v[132:135], v159 offset:8768
  ds_read_b128 v[136:139], v159 offset:8832
  ds_read_b128 v[140:143], v159 offset:8896
  s_waitcnt lgkmcnt(0)
  s_barrier
  v_mfma_f32_16x16x32_bf16 v[160:163], v[208:211], v[96:99], 0
  ds_read_b64_tr_b16 v[244:245], v241 offset:192
  v_exp_f32 v195, v195
  v_mfma_f32_16x16x32_bf16 v[168:171], v[208:211], v[112:115], 0
  ds_read_b64_tr_b16 v[246:247], v241 offset:704
  v_cvt_pk_bf16_f32 v192, v192, v193
  v_mfma_f32_16x16x32_bf16 v[176:179], v[208:211], v[128:131], 0
  ds_read_b64_tr_b16 v[208:209], v241 offset:0
  v_exp_f32 v196, v196
  v_mfma_f32_16x16x32_bf16 v[160:163], v[212:215], v[100:103], v[160:163]
  ds_read_b64_tr_b16 v[210:211], v241 offset:512
  v_add_f32 v157, v157, v194
  v_mfma_f32_16x16x32_bf16 v[168:171], v[212:215], v[116:119], v[168:171]
  ds_read_b64_tr_b16 v[252:253], v241 offset:224
  v_exp_f32 v197, v197
  v_mfma_f32_16x16x32_bf16 v[176:179], v[212:215], v[132:135], v[176:179]
  ds_read_b64_tr_b16 v[212:213], v241 offset:32
  v_add_f32 v157, v157, v195
  v_mfma_f32_16x16x32_bf16 v[160:163], v[216:219], v[104:107], v[160:163]
  ds_read_b64_tr_b16 v[214:215], v241 offset:544
  v_exp_f32 v198, v198
  v_mfma_f32_16x16x32_bf16 v[168:171], v[216:219], v[120:123], v[168:171]
  ds_read_b64_tr_b16 v[254:255], v241 offset:736
  v_cvt_pk_bf16_f32 v193, v194, v195
  v_add_f32 v157, v157, v196
  v_mfma_f32_16x16x32_bf16 v[176:179], v[216:219], v[136:139], v[176:179]
  ds_read_b64_tr_b16 v[216:217], v241 offset:64
  v_exp_f32 v199, v199
  v_mfma_f32_16x16x32_bf16 v[160:163], v[220:223], v[108:111], v[160:163]
  ds_read_b64_tr_b16 v[218:219], v241 offset:576
  v_add_f32 v157, v157, v197
  v_cvt_pk_bf16_f32 v194, v196, v197
  v_mfma_f32_16x16x32_bf16 v[168:171], v[220:223], v[124:127], v[168:171]
  v_add_f32 v157, v157, v198
  v_add_f32 v157, v157, v199
  v_cvt_pk_bf16_f32 v195, v198, v199
  v_mfma_f32_16x16x32_bf16 v[176:179], v[220:223], v[140:143], v[176:179]
  ds_read_b64_tr_b16 v[220:221], v241 offset:96
  v_exp_f32 v200, v200
  v_mfma_f32_16x16x32_bf16 v[164:167], v[224:227], v[96:99], 0
  ds_read_b64_tr_b16 v[222:223], v241 offset:608
  v_exp_f32 v201, v201
  v_mfma_f32_16x16x32_bf16 v[172:175], v[224:227], v[112:115], 0
  v_add_f32 v158, v158, v200
  v_exp_f32 v202, v202
  v_mfma_f32_16x16x32_bf16 v[180:183], v[224:227], v[128:131], 0
  ds_read_b64_tr_b16 v[224:225], v241 offset:128
  v_add_f32 v158, v158, v201
  v_mfma_f32_16x16x32_bf16 v[164:167], v[228:231], v[100:103], v[164:167]
  ds_read_b64_tr_b16 v[226:227], v241 offset:640
  v_exp_f32 v203, v203
  v_mfma_f32_16x16x32_bf16 v[172:175], v[228:231], v[116:119], v[172:175]
  v_cvt_pk_bf16_f32 v200, v200, v201
  v_exp_f32 v204, v204
  v_mfma_f32_16x16x32_bf16 v[180:183], v[228:231], v[132:135], v[180:183]
  ds_read_b64_tr_b16 v[228:229], v241 offset:160
  v_add_f32 v158, v158, v202
  v_mfma_f32_16x16x32_bf16 v[164:167], v[232:235], v[104:107], v[164:167]
  s_waitcnt lgkmcnt(7)
  ds_read_b64_tr_b16 v[230:231], v241 offset:672
  v_exp_f32 v205, v205
  v_mfma_f32_16x16x32_bf16 v[172:175], v[232:235], v[120:123], v[172:175]
  v_add_f32 v158, v158, v203
  v_exp_f32 v206, v206
  v_mfma_f32_16x16x32_bf16 v[180:183], v[232:235], v[136:139], v[180:183]
  ds_read_b128 v[232:235], v240 offset:640
  v_cvt_pk_bf16_f32 v201, v202, v203
  v_mfma_f32_16x16x32_bf16 v[164:167], v[236:239], v[108:111], v[164:167]
  v_add_f32 v158, v158, v204
  v_exp_f32 v207, v207
  v_mfma_f32_16x16x32_bf16 v[172:175], v[236:239], v[124:127], v[172:175]
  v_add_f32 v158, v158, v205
  v_cvt_pk_bf16_f32 v202, v204, v205
  v_add_f32 v158, v158, v206
  v_mfma_f32_16x16x32_bf16 v[180:183], v[236:239], v[140:143], v[180:183]
  ds_read_b128 v[236:239], v240 offset:704
  v_add_f32 v158, v158, v207
  v_cvt_pk_bf16_f32 v203, v206, v207
  s_waitcnt lgkmcnt(8)
  v_mfma_f32_16x16x32_bf16 v[0:3], v[208:211], v[184:187], v[0:3]
  v_mov_b32 v242, v156
  s_nop 1
  v_permlane16_swap_b32 v242, v156
  v_add_f32 v156, v156, v242
  v_mov_b32 v242, v156
  v_mfma_f32_16x16x32_bf16 v[32:35], v[208:211], v[192:195], v[32:35]
  s_nop 0
  v_permlane32_swap_b32 v242, v156
  v_add_f32 v156, v156, v242
  v_rcp_f32 v156, v156
  v_mfma_f32_16x16x32_bf16 v[64:67], v[208:211], v[200:203], v[64:67]
  ds_read_b128 v[208:211], v240 offset:0
  v_mov_b32 v242, v157
  s_nop 1
  v_permlane16_swap_b32 v242, v157
  v_mfma_f32_16x16x32_bf16 v[4:7], v[212:215], v[184:187], v[4:7]
  v_add_f32 v157, v157, v242
  v_mov_b32 v242, v157
  s_nop 1
  v_permlane32_swap_b32 v242, v157
  v_add_f32 v157, v157, v242
  v_mfma_f32_16x16x32_bf16 v[36:39], v[212:215], v[192:195], v[36:39]
  v_rcp_f32 v157, v157
  v_mov_b32 v242, v158
  s_nop 1
  v_permlane16_swap_b32 v242, v158
  v_mfma_f32_16x16x32_bf16 v[68:71], v[212:215], v[200:203], v[68:71]
  ds_read_b128 v[212:215], v240 offset:64
  v_add_f32 v158, v158, v242
  v_mov_b32 v242, v158
  v_mfma_f32_16x16x32_bf16 v[8:11], v[216:219], v[184:187], v[8:11]
  s_nop 0
  v_permlane32_swap_b32 v242, v158
  v_add_f32 v158, v158, v242
  v_rcp_f32 v158, v158
  v_mfma_f32_16x16x32_bf16 v[40:43], v[216:219], v[192:195], v[40:43]
  v_max3_f32 v248, v160, v161, v162
  v_max3_f32 v248, v248, v163, v164
  v_max3_f32 v248, v248, v165, v166
  v_max_f32 v248, v248, v167
  v_mov_b32 v249, v248
  v_mfma_f32_16x16x32_bf16 v[72:75], v[216:219], v[200:203], v[72:75]
  ds_read_b128 v[216:219], v240 offset:128
  v_permlane16_swap_b32 v249, v248
  v_max_f32 v248, v248, v249
  s_waitcnt lgkmcnt(5)
  v_mfma_f32_16x16x32_bf16 v[12:15], v[220:223], v[184:187], v[12:15]
  v_mov_b32 v249, v248
  s_nop 1
  v_permlane32_swap_b32 v249, v248
  v_max_f32 v248, v248, v249
  v_sub_f32 v144, 0, v248
  v_mfma_f32_16x16x32_bf16 v[44:47], v[220:223], v[192:195], v[44:47]
  v_sub_f32 v145, 0, v248
  v_sub_f32 v146, 0, v248
  v_sub_f32 v147, 0, v248
  v_sub_f32 v160, v160, v248
  v_sub_f32 v161, v161, v248
  v_mfma_f32_16x16x32_bf16 v[76:79], v[220:223], v[200:203], v[76:79]
  ds_read_b128 v[220:223], v240 offset:192
  v_sub_f32 v162, v162, v248
  v_sub_f32 v163, v163, v248
  v_sub_f32 v164, v164, v248
  v_mfma_f32_16x16x32_bf16 v[16:19], v[224:227], v[184:187], v[16:19]
  v_sub_f32 v165, v165, v248
  v_sub_f32 v166, v166, v248
  v_sub_f32 v167, v167, v248
  v_max3_f32 v248, v168, v169, v170
  v_max3_f32 v248, v248, v171, v172
  v_mfma_f32_16x16x32_bf16 v[48:51], v[224:227], v[192:195], v[48:51]
  v_max3_f32 v248, v248, v173, v174
  v_max_f32 v248, v248, v175
  v_mov_b32 v249, v248
  s_nop 1
  v_permlane16_swap_b32 v249, v248
  v_mfma_f32_16x16x32_bf16 v[80:83], v[224:227], v[200:203], v[80:83]
  ds_read_b128 v[224:227], v240 offset:512
  v_max_f32 v248, v248, v249
  v_mov_b32 v249, v248
  v_mfma_f32_16x16x32_bf16 v[20:23], v[228:231], v[184:187], v[20:23]
  s_nop 0
  v_permlane32_swap_b32 v249, v248
  v_max_f32 v248, v248, v249
  v_sub_f32 v148, 0, v248
  v_sub_f32 v149, 0, v248
  v_mfma_f32_16x16x32_bf16 v[52:55], v[228:231], v[192:195], v[52:55]
  v_sub_f32 v150, 0, v248
  v_sub_f32 v151, 0, v248
  v_sub_f32 v168, v168, v248
  v_sub_f32 v169, v169, v248
  v_mfma_f32_16x16x32_bf16 v[84:87], v[228:231], v[200:203], v[84:87]
  ds_read_b128 v[228:231], v240 offset:576
  v_sub_f32 v170, v170, v248
  v_sub_f32 v171, v171, v248
  v_sub_f32 v172, v172, v248
  v_mfma_f32_16x16x32_bf16 v[24:27], v[244:247], v[184:187], v[24:27]
  v_sub_f32 v173, v173, v248
  v_sub_f32 v174, v174, v248
  v_sub_f32 v175, v175, v248
  v_max3_f32 v248, v176, v177, v178
  v_max3_f32 v248, v248, v179, v180
  v_mfma_f32_16x16x32_bf16 v[56:59], v[244:247], v[192:195], v[56:59]
  v_max3_f32 v248, v248, v181, v182
  v_max_f32 v248, v248, v183
  v_mov_b32 v249, v248
  s_nop 1
  v_permlane16_swap_b32 v249, v248
  v_mfma_f32_16x16x32_bf16 v[88:91], v[244:247], v[200:203], v[88:91]
  v_max_f32 v248, v248, v249
  v_mov_b32 v249, v248
  s_nop 1
  v_permlane32_swap_b32 v249, v248
  v_mfma_f32_16x16x32_bf16 v[28:31], v[252:255], v[184:187], v[28:31]
  v_max_f32 v248, v248, v249
  v_sub_f32 v152, 0, v248
  v_sub_f32 v153, 0, v248
  v_sub_f32 v154, 0, v248
  v_mfma_f32_16x16x32_bf16 v[60:63], v[252:255], v[192:195], v[60:63]
  v_sub_f32 v155, 0, v248
  v_sub_f32 v176, v176, v248
  v_sub_f32 v177, v177, v248
  v_sub_f32 v178, v178, v248
  v_sub_f32 v179, v179, v248
  v_mfma_f32_16x16x32_bf16 v[92:95], v[252:255], v[200:203], v[92:95]
  v_sub_f32 v180, v180, v248
  v_sub_f32 v181, v181, v248
  v_sub_f32 v182, v182, v248
  v_sub_f32 v183, v183, v248
  v_mov_b32 v248, v156
  v_pk_mul_f32 v[0:1], v[0:1], v[248:249] op_sel_hi:[1,0]
  v_pk_mul_f32 v[2:3], v[2:3], v[248:249] op_sel_hi:[1,0]
  v_pk_mul_f32 v[4:5], v[4:5], v[248:249] op_sel_hi:[1,0]
  v_pk_mul_f32 v[6:7], v[6:7], v[248:249] op_sel_hi:[1,0]
  v_cvt_pk_bf16_f32 v0, v0, v1
  v_cvt_pk_bf16_f32 v1, v2, v3
  v_cvt_pk_bf16_f32 v2, v4, v5
  v_cvt_pk_bf16_f32 v3, v6, v7
  ds_write_b128 v243, v[0:3] offset:0
  v_pk_mul_f32 v[8:9], v[8:9], v[248:249] op_sel_hi:[1,0]
  v_pk_mul_f32 v[10:11], v[10:11], v[248:249] op_sel_hi:[1,0]
  v_pk_mul_f32 v[12:13], v[12:13], v[248:249] op_sel_hi:[1,0]
  v_pk_mul_f32 v[14:15], v[14:15], v[248:249] op_sel_hi:[1,0]
  v_cvt_pk_bf16_f32 v8, v8, v9
  v_cvt_pk_bf16_f32 v9, v10, v11
  v_cvt_pk_bf16_f32 v10, v12, v13
  v_cvt_pk_bf16_f32 v11, v14, v15
  ds_write_b128 v243, v[8:11] offset:1024
  v_pk_mul_f32 v[16:17], v[16:17], v[248:249] op_sel_hi:[1,0]
  v_pk_mul_f32 v[18:19], v[18:19], v[248:249] op_sel_hi:[1,0]
  v_pk_mul_f32 v[20:21], v[20:21], v[248:249] op_sel_hi:[1,0]
  v_pk_mul_f32 v[22:23], v[22:23], v[248:249] op_sel_hi:[1,0]
  v_cvt_pk_bf16_f32 v16, v16, v17
  v_cvt_pk_bf16_f32 v17, v18, v19
  v_cvt_pk_bf16_f32 v18, v20, v21
  v_cvt_pk_bf16_f32 v19, v22, v23
  ds_write_b128 v243, v[16:19] offset:2048
  v_pk_mul_f32 v[24:25], v[24:25], v[248:249] op_sel_hi:[1,0]
  v_pk_mul_f32 v[26:27], v[26:27], v[248:249] op_sel_hi:[1,0]
  v_pk_mul_f32 v[28:29], v[28:29], v[248:249] op_sel_hi:[1,0]
  v_pk_mul_f32 v[30:31], v[30:31], v[248:249] op_sel_hi:[1,0]
  v_cvt_pk_bf16_f32 v24, v24, v25
  v_cvt_pk_bf16_f32 v25, v26, v27
  v_cvt_pk_bf16_f32 v26, v28, v29
  v_cvt_pk_bf16_f32 v27, v30, v31
  ds_write_b128 v243, v[24:27] offset:3072
  v_mov_b32 v248, v157
  v_pk_mul_f32 v[32:33], v[32:33], v[248:249] op_sel_hi:[1,0]
  v_pk_mul_f32 v[34:35], v[34:35], v[248:249] op_sel_hi:[1,0]
  v_pk_mul_f32 v[36:37], v[36:37], v[248:249] op_sel_hi:[1,0]
  v_pk_mul_f32 v[38:39], v[38:39], v[248:249] op_sel_hi:[1,0]
  v_cvt_pk_bf16_f32 v32, v32, v33
  v_cvt_pk_bf16_f32 v33, v34, v35
  v_cvt_pk_bf16_f32 v34, v36, v37
  v_cvt_pk_bf16_f32 v35, v38, v39
  ds_write_b128 v243, v[32:35] offset:8192
  v_pk_mul_f32 v[40:41], v[40:41], v[248:249] op_sel_hi:[1,0]
  v_pk_mul_f32 v[42:43], v[42:43], v[248:249] op_sel_hi:[1,0]
  v_pk_mul_f32 v[44:45], v[44:45], v[248:249] op_sel_hi:[1,0]
  v_pk_mul_f32 v[46:47], v[46:47], v[248:249] op_sel_hi:[1,0]
  v_cvt_pk_bf16_f32 v40, v40, v41
  v_cvt_pk_bf16_f32 v41, v42, v43
  v_cvt_pk_bf16_f32 v42, v44, v45
  v_cvt_pk_bf16_f32 v43, v46, v47
  ds_write_b128 v243, v[40:43] offset:9216
  v_pk_mul_f32 v[48:49], v[48:49], v[248:249] op_sel_hi:[1,0]
  v_pk_mul_f32 v[50:51], v[50:51], v[248:249] op_sel_hi:[1,0]
  v_pk_mul_f32 v[52:53], v[52:53], v[248:249] op_sel_hi:[1,0]
  v_pk_mul_f32 v[54:55], v[54:55], v[248:249] op_sel_hi:[1,0]
  v_cvt_pk_bf16_f32 v48, v48, v49
  v_cvt_pk_bf16_f32 v49, v50, v51
  v_cvt_pk_bf16_f32 v50, v52, v53
  v_cvt_pk_bf16_f32 v51, v54, v55
  ds_write_b128 v243, v[48:51] offset:10240
  v_pk_mul_f32 v[56:57], v[56:57], v[248:249] op_sel_hi:[1,0]
  v_pk_mul_f32 v[58:59], v[58:59], v[248:249] op_sel_hi:[1,0]
  v_pk_mul_f32 v[60:61], v[60:61], v[248:249] op_sel_hi:[1,0]
  v_pk_mul_f32 v[62:63], v[62:63], v[248:249] op_sel_hi:[1,0]
  v_cvt_pk_bf16_f32 v56, v56, v57
  v_cvt_pk_bf16_f32 v57, v58, v59
  v_cvt_pk_bf16_f32 v58, v60, v61
  v_cvt_pk_bf16_f32 v59, v62, v63
  s_waitcnt lgkmcnt(7)
  ds_write_b128 v243, v[56:59] offset:11264
  v_mov_b32 v248, v158
  v_pk_mul_f32 v[64:65], v[64:65], v[248:249] op_sel_hi:[1,0]
  v_pk_mul_f32 v[66:67], v[66:67], v[248:249] op_sel_hi:[1,0]
  v_pk_mul_f32 v[68:69], v[68:69], v[248:249] op_sel_hi:[1,0]
  v_pk_mul_f32 v[70:71], v[70:71], v[248:249] op_sel_hi:[1,0]
  v_cvt_pk_bf16_f32 v64, v64, v65
  v_cvt_pk_bf16_f32 v65, v66, v67
  v_cvt_pk_bf16_f32 v66, v68, v69
  v_cvt_pk_bf16_f32 v67, v70, v71
  ds_write_b128 v243, v[64:67] offset:16384
  v_pk_mul_f32 v[72:73], v[72:73], v[248:249] op_sel_hi:[1,0]
  v_pk_mul_f32 v[74:75], v[74:75], v[248:249] op_sel_hi:[1,0]
  v_pk_mul_f32 v[76:77], v[76:77], v[248:249] op_sel_hi:[1,0]
  v_pk_mul_f32 v[78:79], v[78:79], v[248:249] op_sel_hi:[1,0]
  v_cvt_pk_bf16_f32 v72, v72, v73
  v_cvt_pk_bf16_f32 v73, v74, v75
  v_cvt_pk_bf16_f32 v74, v76, v77
  v_cvt_pk_bf16_f32 v75, v78, v79
  ds_write_b128 v243, v[72:75] offset:17408
  v_pk_mul_f32 v[80:81], v[80:81], v[248:249] op_sel_hi:[1,0]
  v_pk_mul_f32 v[82:83], v[82:83], v[248:249] op_sel_hi:[1,0]
  v_pk_mul_f32 v[84:85], v[84:85], v[248:249] op_sel_hi:[1,0]
  v_pk_mul_f32 v[86:87], v[86:87], v[248:249] op_sel_hi:[1,0]
  v_cvt_pk_bf16_f32 v80, v80, v81
  v_cvt_pk_bf16_f32 v81, v82, v83
  v_cvt_pk_bf16_f32 v82, v84, v85
  v_cvt_pk_bf16_f32 v83, v86, v87
  ds_write_b128 v243, v[80:83] offset:18432
  v_pk_mul_f32 v[88:89], v[88:89], v[248:249] op_sel_hi:[1,0]
  v_pk_mul_f32 v[90:91], v[90:91], v[248:249] op_sel_hi:[1,0]
  v_pk_mul_f32 v[92:93], v[92:93], v[248:249] op_sel_hi:[1,0]
  v_pk_mul_f32 v[94:95], v[94:95], v[248:249] op_sel_hi:[1,0]
  v_cvt_pk_bf16_f32 v88, v88, v89
  v_cvt_pk_bf16_f32 v89, v90, v91
  v_cvt_pk_bf16_f32 v90, v92, v93
  v_cvt_pk_bf16_f32 v91, v94, v95
  ds_write_b128 v243, v[88:91] offset:19456
  v_mov_b32 v156, 0
  v_mov_b32 v157, 0
  v_mov_b32 v158, 0
  v_exp_f32 v160, v160
  v_exp_f32 v161, v161
  v_add_f32 v156, v156, v160
  v_exp_f32 v162, v162
  v_add_f32 v156, v156, v161
  v_exp_f32 v163, v163
  v_cvt_pk_bf16_f32 v160, v160, v161
  v_exp_f32 v164, v164
  v_add_f32 v156, v156, v162
  v_exp_f32 v165, v165
  v_add_f32 v156, v156, v163
  v_exp_f32 v166, v166
  v_cvt_pk_bf16_f32 v161, v162, v163
  v_add_f32 v156, v156, v164
  v_exp_f32 v167, v167
  v_add_f32 v156, v156, v165
  v_cvt_pk_bf16_f32 v162, v164, v165
  v_add_f32 v156, v156, v166
  v_add_f32 v156, v156, v167
  v_cvt_pk_bf16_f32 v163, v166, v167
  v_exp_f32 v168, v168
  v_exp_f32 v169, v169
  v_add_f32 v157, v157, v168
  v_exp_f32 v170, v170
  v_add_f32 v157, v157, v169
  s_waitcnt lgkmcnt(0)
  v_mov_b64 v[0:1], 0
  v_mov_b64 v[2:3], 0
  v_mov_b64 v[4:5], 0
  v_mov_b64 v[6:7], 0
  v_mov_b64 v[8:9], 0
  v_mov_b64 v[10:11], 0
  v_mov_b64 v[12:13], 0
  v_mov_b64 v[14:15], 0
  v_mov_b64 v[16:17], 0
  v_mov_b64 v[18:19], 0
  v_mov_b64 v[20:21], 0
  v_mov_b64 v[22:23], 0
  v_mov_b64 v[24:25], 0
  v_mov_b64 v[26:27], 0
  v_mov_b64 v[28:29], 0
  v_mov_b64 v[30:31], 0
  v_mov_b64 v[32:33], 0
  v_mov_b64 v[34:35], 0
  v_mov_b64 v[36:37], 0
  v_mov_b64 v[38:39], 0
  v_mov_b64 v[40:41], 0
  v_mov_b64 v[42:43], 0
  v_mov_b64 v[44:45], 0
  v_mov_b64 v[46:47], 0
  v_mov_b64 v[48:49], 0
  v_mov_b64 v[50:51], 0
  v_mov_b64 v[52:53], 0
  v_mov_b64 v[54:55], 0
  v_mov_b64 v[56:57], 0
  v_mov_b64 v[58:59], 0
  v_mov_b64 v[60:61], 0
  v_mov_b64 v[62:63], 0
  v_mov_b64 v[64:65], 0
  v_mov_b64 v[66:67], 0
  v_mov_b64 v[68:69], 0
  v_mov_b64 v[70:71], 0
  v_mov_b64 v[72:73], 0
  v_mov_b64 v[74:75], 0
  v_mov_b64 v[76:77], 0
  v_mov_b64 v[78:79], 0
  v_mov_b64 v[80:81], 0
  v_mov_b64 v[82:83], 0
  v_mov_b64 v[84:85], 0
  v_mov_b64 v[86:87], 0
  v_mov_b64 v[88:89], 0
  v_mov_b64 v[90:91], 0
  v_mov_b64 v[92:93], 0
  v_mov_b64 v[94:95], 0
  s_branch L_G
L_last:
  s_barrier
  ds_read_b64_tr_b16 v[244:245], v241 offset:192
  ds_read_b64_tr_b16 v[246:247], v241 offset:704
  ds_read_b64_tr_b16 v[252:253], v241 offset:224
  ds_read_b64_tr_b16 v[254:255], v241 offset:736
  ds_read_b64_tr_b16 v[208:209], v241 offset:0
  ds_read_b64_tr_b16 v[210:211], v241 offset:512
  ds_read_b64_tr_b16 v[212:213], v241 offset:32
  ds_read_b64_tr_b16 v[214:215], v241 offset:544
  ds_read_b64_tr_b16 v[216:217], v241 offset:64
  ds_read_b64_tr_b16 v[218:219], v241 offset:576
  ds_read_b64_tr_b16 v[220:221], v241 offset:96
  ds_read_b64_tr_b16 v[222:223], v241 offset:608
  ds_read_b64_tr_b16 v[224:225], v241 offset:128
  ds_read_b64_tr_b16 v[226:227], v241 offset:640
  ds_read_b64_tr_b16 v[228:229], v241 offset:160
  s_waitcnt lgkmcnt(7)
  ds_read_b64_tr_b16 v[230:231], v241 offset:672
  v_exp_f32 v195, v195
  v_cvt_pk_bf16_f32 v192, v192, v193
  v_exp_f32 v196, v196
  v_add_f32 v157, v157, v194
  v_exp_f32 v197, v197
  v_add_f32 v157, v157, v195
  v_exp_f32 v198, v198
  v_cvt_pk_bf16_f32 v193, v194, v195
  v_add_f32 v157, v157, v196
  v_exp_f32 v199, v199
  v_add_f32 v157, v157, v197
  v_cvt_pk_bf16_f32 v194, v196, v197
  v_add_f32 v157, v157, v198
  v_add_f32 v157, v157, v199
  v_cvt_pk_bf16_f32 v195, v198, v199
  v_exp_f32 v200, v200
  v_exp_f32 v201, v201
  v_add_f32 v158, v158, v200
  v_exp_f32 v202, v202
  v_add_f32 v158, v158, v201
  v_exp_f32 v203, v203
  v_cvt_pk_bf16_f32 v200, v200, v201
  v_exp_f32 v204, v204
  v_add_f32 v158, v158, v202
  v_exp_f32 v205, v205
  v_add_f32 v158, v158, v203
  v_exp_f32 v206, v206
  v_cvt_pk_bf16_f32 v201, v202, v203
  v_add_f32 v158, v158, v204
  v_exp_f32 v207, v207
  v_add_f32 v158, v158, v205
  v_cvt_pk_bf16_f32 v202, v204, v205
  v_add_f32 v158, v158, v206
  v_add_f32 v158, v158, v207
  v_cvt_pk_bf16_f32 v203, v206, v207
  s_waitcnt lgkmcnt(0)
  s_cmp_eq_u32 s67, 0
  s_cbranch_scc1 L_fin_152
  s_barrier
L_fin_152:
  v_mfma_f32_16x16x32_bf16 v[0:3], v[208:211], v[184:187], v[0:3]
  v_mov_b32 v242, v156
  v_mfma_f32_16x16x32_bf16 v[32:35], v[208:211], v[192:195], v[32:35]
  s_nop 0
  v_permlane16_swap_b32 v242, v156
  v_mfma_f32_16x16x32_bf16 v[64:67], v[208:211], v[200:203], v[64:67]
  v_add_f32 v156, v156, v242
  v_mfma_f32_16x16x32_bf16 v[4:7], v[212:215], v[184:187], v[4:7]
  v_mov_b32 v242, v156
  v_mfma_f32_16x16x32_bf16 v[36:39], v[212:215], v[192:195], v[36:39]
  s_nop 0
  v_permlane32_swap_b32 v242, v156
  v_mfma_f32_16x16x32_bf16 v[68:71], v[212:215], v[200:203], v[68:71]
  v_add_f32 v156, v156, v242
  v_mfma_f32_16x16x32_bf16 v[8:11], v[216:219], v[184:187], v[8:11]
  v_rcp_f32 v156, v156
  v_mfma_f32_16x16x32_bf16 v[40:43], v[216:219], v[192:195], v[40:43]
  v_mov_b32 v242, v157
  v_mfma_f32_16x16x32_bf16 v[72:75], v[216:219], v[200:203], v[72:75]
  s_nop 0
  v_permlane16_swap_b32 v242, v157
  v_mfma_f32_16x16x32_bf16 v[12:15], v[220:223], v[184:187], v[12:15]
  v_add_f32 v157, v157, v242
  v_mfma_f32_16x16x32_bf16 v[44:47], v[220:223], v[192:195], v[44:47]
  v_mov_b32 v242, v157
  v_mfma_f32_16x16x32_bf16 v[76:79], v[220:223], v[200:203], v[76:79]
  s_nop 0
  v_permlane32_swap_b32 v242, v157
  v_mfma_f32_16x16x32_bf16 v[16:19], v[224:227], v[184:187], v[16:19]
  v_add_f32 v157, v157, v242
  v_mfma_f32_16x16x32_bf16 v[48:51], v[224:227], v[192:195], v[48:51]
  v_rcp_f32 v157, v157
  v_mfma_f32_16x16x32_bf16 v[80:83], v[224:227], v[200:203], v[80:83]
  v_mov_b32 v242, v158
  v_mfma_f32_16x16x32_bf16 v[20:23], v[228:231], v[184:187], v[20:23]
  s_nop 0
  v_permlane16_swap_b32 v242, v158
  v_mfma_f32_16x16x32_bf16 v[52:55], v[228:231], v[192:195], v[52:55]
  v_add_f32 v158, v158, v242
  v_mfma_f32_16x16x32_bf16 v[84:87], v[228:231], v[200:203], v[84:87]
  v_mov_b32 v242, v158
  v_mfma_f32_16x16x32_bf16 v[24:27], v[244:247], v[184:187], v[24:27]
  v_mfma_f32_16x16x32_bf16 v[56:59], v[244:247], v[192:195], v[56:59]
  v_permlane32_swap_b32 v242, v158
  v_mfma_f32_16x16x32_bf16 v[88:91], v[244:247], v[200:203], v[88:91]
  v_add_f32 v158, v158, v242
  v_mfma_f32_16x16x32_bf16 v[28:31], v[252:255], v[184:187], v[28:31]
  v_mfma_f32_16x16x32_bf16 v[60:63], v[252:255], v[192:195], v[60:63]
  v_rcp_f32 v158, v158
  v_mfma_f32_16x16x32_bf16 v[92:95], v[252:255], v[200:203], v[92:95]
  v_mov_b32 v248, v156
  v_pk_mul_f32 v[0:1], v[0:1], v[248:249] op_sel_hi:[1,0]
  v_pk_mul_f32 v[2:3], v[2:3], v[248:249] op_sel_hi:[1,0]
  v_pk_mul_f32 v[4:5], v[4:5], v[248:249] op_sel_hi:[1,0]
  v_pk_mul_f32 v[6:7], v[6:7], v[248:249] op_sel_hi:[1,0]
  v_cvt_pk_bf16_f32 v0, v0, v1
  v_cvt_pk_bf16_f32 v1, v2, v3
  v_cvt_pk_bf16_f32 v2, v4, v5
  v_cvt_pk_bf16_f32 v3, v6, v7
  ds_write_b128 v243, v[0:3] offset:0
  v_pk_mul_f32 v[8:9], v[8:9], v[248:249] op_sel_hi:[1,0]
  v_pk_mul_f32 v[10:11], v[10:11], v[248:249] op_sel_hi:[1,0]
  v_pk_mul_f32 v[12:13], v[12:13], v[248:249] op_sel_hi:[1,0]
  v_pk_mul_f32 v[14:15], v[14:15], v[248:249] op_sel_hi:[1,0]
  v_cvt_pk_bf16_f32 v8, v8, v9
  v_cvt_pk_bf16_f32 v9, v10, v11
  v_cvt_pk_bf16_f32 v10, v12, v13
  v_cvt_pk_bf16_f32 v11, v14, v15
  ds_write_b128 v243, v[8:11] offset:1024
  v_pk_mul_f32 v[16:17], v[16:17], v[248:249] op_sel_hi:[1,0]
  v_pk_mul_f32 v[18:19], v[18:19], v[248:249] op_sel_hi:[1,0]
  v_pk_mul_f32 v[20:21], v[20:21], v[248:249] op_sel_hi:[1,0]
  v_pk_mul_f32 v[22:23], v[22:23], v[248:249] op_sel_hi:[1,0]
  v_cvt_pk_bf16_f32 v16, v16, v17
  v_cvt_pk_bf16_f32 v17, v18, v19
  v_cvt_pk_bf16_f32 v18, v20, v21
  v_cvt_pk_bf16_f32 v19, v22, v23
  ds_write_b128 v243, v[16:19] offset:2048
  v_pk_mul_f32 v[24:25], v[24:25], v[248:249] op_sel_hi:[1,0]
  v_pk_mul_f32 v[26:27], v[26:27], v[248:249] op_sel_hi:[1,0]
  v_pk_mul_f32 v[28:29], v[28:29], v[248:249] op_sel_hi:[1,0]
  v_pk_mul_f32 v[30:31], v[30:31], v[248:249] op_sel_hi:[1,0]
  v_cvt_pk_bf16_f32 v24, v24, v25
  v_cvt_pk_bf16_f32 v25, v26, v27
  v_cvt_pk_bf16_f32 v26, v28, v29
  v_cvt_pk_bf16_f32 v27, v30, v31
  ds_write_b128 v243, v[24:27] offset:3072
  v_mov_b32 v248, v157
  v_pk_mul_f32 v[32:33], v[32:33], v[248:249] op_sel_hi:[1,0]
  v_pk_mul_f32 v[34:35], v[34:35], v[248:249] op_sel_hi:[1,0]
  v_pk_mul_f32 v[36:37], v[36:37], v[248:249] op_sel_hi:[1,0]
  v_pk_mul_f32 v[38:39], v[38:39], v[248:249] op_sel_hi:[1,0]
  v_cvt_pk_bf16_f32 v32, v32, v33
  v_cvt_pk_bf16_f32 v33, v34, v35
  v_cvt_pk_bf16_f32 v34, v36, v37
  v_cvt_pk_bf16_f32 v35, v38, v39
  ds_write_b128 v243, v[32:35] offset:8192
  v_pk_mul_f32 v[40:41], v[40:41], v[248:249] op_sel_hi:[1,0]
  v_pk_mul_f32 v[42:43], v[42:43], v[248:249] op_sel_hi:[1,0]
  v_pk_mul_f32 v[44:45], v[44:45], v[248:249] op_sel_hi:[1,0]
  v_pk_mul_f32 v[46:47], v[46:47], v[248:249] op_sel_hi:[1,0]
  v_cvt_pk_bf16_f32 v40, v40, v41
  v_cvt_pk_bf16_f32 v41, v42, v43
  v_cvt_pk_bf16_f32 v42, v44, v45
  v_cvt_pk_bf16_f32 v43, v46, v47
  ds_write_b128 v243, v[40:43] offset:9216
  v_pk_mul_f32 v[48:49], v[48:49], v[248:249] op_sel_hi:[1,0]
  v_pk_mul_f32 v[50:51], v[50:51], v[248:249] op_sel_hi:[1,0]
  v_pk_mul_f32 v[52:53], v[52:53], v[248:249] op_sel_hi:[1,0]
  v_pk_mul_f32 v[54:55], v[54:55], v[248:249] op_sel_hi:[1,0]
  v_cvt_pk_bf16_f32 v48, v48, v49
  v_cvt_pk_bf16_f32 v49, v50, v51
  v_cvt_pk_bf16_f32 v50, v52, v53
  v_cvt_pk_bf16_f32 v51, v54, v55
  ds_write_b128 v243, v[48:51] offset:10240
  v_pk_mul_f32 v[56:57], v[56:57], v[248:249] op_sel_hi:[1,0]
  v_pk_mul_f32 v[58:59], v[58:59], v[248:249] op_sel_hi:[1,0]
  v_pk_mul_f32 v[60:61], v[60:61], v[248:249] op_sel_hi:[1,0]
  v_pk_mul_f32 v[62:63], v[62:63], v[248:249] op_sel_hi:[1,0]
  v_cvt_pk_bf16_f32 v56, v56, v57
  v_cvt_pk_bf16_f32 v57, v58, v59
  v_cvt_pk_bf16_f32 v58, v60, v61
  v_cvt_pk_bf16_f32 v59, v62, v63
  ds_write_b128 v243, v[56:59] offset:11264
  v_mov_b32 v248, v158
  v_pk_mul_f32 v[64:65], v[64:65], v[248:249] op_sel_hi:[1,0]
  v_pk_mul_f32 v[66:67], v[66:67], v[248:249] op_sel_hi:[1,0]
  v_pk_mul_f32 v[68:69], v[68:69], v[248:249] op_sel_hi:[1,0]
  v_pk_mul_f32 v[70:71], v[70:71], v[248:249] op_sel_hi:[1,0]
  v_cvt_pk_bf16_f32 v64, v64, v65
  v_cvt_pk_bf16_f32 v65, v66, v67
  v_cvt_pk_bf16_f32 v66, v68, v69
  v_cvt_pk_bf16_f32 v67, v70, v71
  ds_write_b128 v243, v[64:67] offset:16384
  v_pk_mul_f32 v[72:73], v[72:73], v[248:249] op_sel_hi:[1,0]
  v_pk_mul_f32 v[74:75], v[74:75], v[248:249] op_sel_hi:[1,0]
  v_pk_mul_f32 v[76:77], v[76:77], v[248:249] op_sel_hi:[1,0]
  v_pk_mul_f32 v[78:79], v[78:79], v[248:249] op_sel_hi:[1,0]
  v_cvt_pk_bf16_f32 v72, v72, v73
  v_cvt_pk_bf16_f32 v73, v74, v75
  v_cvt_pk_bf16_f32 v74, v76, v77
  v_cvt_pk_bf16_f32 v75, v78, v79
  ds_write_b128 v243, v[72:75] offset:17408
  v_pk_mul_f32 v[80:81], v[80:81], v[248:249] op_sel_hi:[1,0]
  v_pk_mul_f32 v[82:83], v[82:83], v[248:249] op_sel_hi:[1,0]
  v_pk_mul_f32 v[84:85], v[84:85], v[248:249] op_sel_hi:[1,0]
  v_pk_mul_f32 v[86:87], v[86:87], v[248:249] op_sel_hi:[1,0]
  v_cvt_pk_bf16_f32 v80, v80, v81
  v_cvt_pk_bf16_f32 v81, v82, v83
  v_cvt_pk_bf16_f32 v82, v84, v85
  v_cvt_pk_bf16_f32 v83, v86, v87
  ds_write_b128 v243, v[80:83] offset:18432
  v_pk_mul_f32 v[88:89], v[88:89], v[248:249] op_sel_hi:[1,0]
  v_pk_mul_f32 v[90:91], v[90:91], v[248:249] op_sel_hi:[1,0]
  v_pk_mul_f32 v[92:93], v[92:93], v[248:249] op_sel_hi:[1,0]
  v_pk_mul_f32 v[94:95], v[94:95], v[248:249] op_sel_hi:[1,0]
  v_cvt_pk_bf16_f32 v88, v88, v89
  v_cvt_pk_bf16_f32 v89, v90, v91
  v_cvt_pk_bf16_f32 v90, v92, v93
  v_cvt_pk_bf16_f32 v91, v94, v95
  ds_write_b128 v243, v[88:91] offset:19456
  s_waitcnt lgkmcnt(0)
  s_barrier
  s_mov_b32 s72, s12
  s_and_b32 s73, s13, 0xffff
  s_mov_b32 s74, 4718592
  s_mov_b32 s75, 0x20000
  s_lshl_b32 s31, s84, 4
  s_add_u32 s31, s31, s71
  s_mul_i32 s31, s31, 884736
  s_add_u32 s76, s28, s31
  s_addc_u32 s77, s29, 0
  s_and_b32 s77, s77, 0xffff
  s_mov_b32 s78, 884736
  s_mov_b32 s79, 0x20000
  s_lshl_b32 s31, s70, 3
  s_add_u32 s31, s31, s30
  s_add_u32 s31, s31, 4
  s_mul_i32 s61, s31, 73728
  s_mul_i32 s65, s70, 110592
  s_add_u32 s65, s65, s68
  s_lshl_b32 s69, s30, 13
  s_mov_b32 s53, s60
  v_lshrrev_b32 v1, 3, v250
  v_and_b32 v2, 7, v250
  v_bfe_u32 v3, v250, 4, 2
  v_lshlrev_b32 v3, 1, v3
  v_xor_b32 v2, v2, v3
  v_mul_u32_u24 v1, 1152, v1
  v_lshl_add_u32 v244, v2, 4, v1
  s_add_u32 s60, s60, 1
  s_cmp_eq_u32 s60, 9
  s_cselect_b32 s60, 0, s60
  s_setprio 0
  s_mov_b32 s62, 94208
  s_lshl_b32 s67, s60, 7
  s_add_u32 m0, s62, s69
  s_add_u32 s67, s67, s61
  buffer_load_dwordx4 v244, s[72:75], s67 offen lds
  s_add_u32 m0, m0, 1024
  s_add_u32 s67, s67, 9216
  buffer_load_dwordx4 v244, s[72:75], s67 offen lds
  s_add_u32 m0, m0, 1024
  s_add_u32 s67, s67, 9216
  buffer_load_dwordx4 v244, s[72:75], s67 offen lds
  s_add_u32 m0, m0, 1024
  s_add_u32 s67, s67, 9216
  buffer_load_dwordx4 v244, s[72:75], s67 offen lds
  s_add_u32 m0, s62, s69
  s_add_u32 m0, m0, 4096
  s_add_u32 s67, s67, 9216
  buffer_load_dwordx4 v244, s[72:75], s67 offen lds
  s_add_u32 m0, m0, 1024
  s_add_u32 s67, s67, 9216
  buffer_load_dwordx4 v244, s[72:75], s67 offen lds
  s_add_u32 m0, m0, 1024
  s_add_u32 s67, s67, 9216
  buffer_load_dwordx4 v244, s[72:75], s67 offen lds
  s_add_u32 m0, m0, 1024
  s_add_u32 s67, s67, 9216
  buffer_load_dwordx4 v244, s[72:75], s67 offen lds
  s_add_u32 s60, s60, 1
  s_cmp_eq_u32 s60, 9
  s_cselect_b32 s60, 0, s60
  s_add_u32 s62, s62, 32768
  s_cmp_gt_u32 s62, 126976
  s_cselect_b32 s62, 28672, s62
  s_mov_b32 s41, 7
L_wo:
  s_lshl_b32 s67, s60, 7
  s_add_u32 m0, s62, s69
  s_add_u32 s67, s67, s61
  buffer_load_dwordx4 v244, s[72:75], s67 offen lds
  s_add_u32 m0, m0, 1024
  s_add_u32 s67, s67, 9216
  buffer_load_dwordx4 v244, s[72:75], s67 offen lds
  s_add_u32 m0, m0, 1024
  s_add_u32 s67, s67, 9216
  buffer_load_dwordx4 v244, s[72:75], s67 offen lds
  s_add_u32 m0, m0, 1024
  s_add_u32 s67, s67, 9216
  buffer_load_dwordx4 v244, s[72:75], s67 offen lds
  s_add_u32 m0, s62, s69
  s_add_u32 m0, m0, 4096
  s_add_u32 s67, s67, 9216
  buffer_load_dwordx4 v244, s[72:75], s67 offen lds
  s_add_u32 m0, m0, 1024
  s_add_u32 s67, s67, 9216
  buffer_load_dwordx4 v244, s[72:75], s67 offen lds
  s_add_u32 m0, m0, 1024
  s_add_u32 s67, s67, 9216
  buffer_load_dwordx4 v244, s[72:75], s67 offen lds
  s_add_u32 m0, m0, 1024
  s_add_u32 s67, s67, 9216
  buffer_load_dwordx4 v244, s[72:75], s67 offen lds
  s_add_u32 s60, s60, 1
  s_cmp_eq_u32 s60, 9
  s_cselect_b32 s60, 0, s60
  s_add_u32 s62, s62, 32768
  s_cmp_gt_u32 s62, 126976
  s_cselect_b32 s62, 28672, s62
  s_waitcnt vmcnt(8)
  s_barrier
  s_sub_u32 s41, s41, 1
  s_cmp_lg_u32 s41, 0
  s_cbranch_scc1 L_wo
  s_waitcnt vmcnt(0)
  s_barrier
L_end:
  s_endpgm
L_typeB:
  s_mov_b32 s57, 4294933504
  s_cmp_lt_u32 s30, 2
  s_cselect_b32 s67, 1, 0
  s_cselect_b32 s31, 8448, 0
  v_add_u32 v240, s31, v240
  s_waitcnt vmcnt(8)
  s_barrier
  ds_read_b128 v[96:99], v159 offset:0
  ds_read_b128 v[100:103], v159 offset:64
  ds_read_b128 v[104:107], v159 offset:128
  ds_read_b128 v[108:111], v159 offset:192
  ds_read_b128 v[112:115], v159 offset:4352
  ds_read_b128 v[116:119], v159 offset:4416
  ds_read_b128 v[120:123], v159 offset:4480
  ds_read_b128 v[124:127], v159 offset:4544
  ds_read_b128 v[128:131], v159 offset:8704
  ds_read_b128 v[132:135], v159 offset:8768
  ds_read_b128 v[136:139], v159 offset:8832
  ds_read_b128 v[140:143], v159 offset:8896
  ds_read_b128 v[208:211], v240 offset:0
  ds_read_b128 v[212:215], v240 offset:64
  ds_read_b128 v[216:219], v240 offset:128
  s_waitcnt lgkmcnt(7)
  ds_read_b128 v[220:223], v240 offset:192
  ds_read_b128 v[224:227], v240 offset:512
  ds_read_b128 v[228:231], v240 offset:576
  ds_read_b128 v[232:235], v240 offset:640
  ds_read_b128 v[236:239], v240 offset:704
  s_mul_i32 s3, s67, 16896
  s_sub_u32 s3, 33792, s3
  s_sub_u32 s31, s3, s31
  v_add_u32 v240, s31, v240
  s_add_u32 s3, s3, 16896
  v_add_u32 v241, s3, v241
  s_mul_i32 s3, s67, 67584
  s_sub_u32 s58, 33792, s3
  s_waitcnt lgkmcnt(7)
  v_mfma_f32_16x16x32_bf16 v[160:163], v[208:211], v[96:99], 0
  v_mfma_f32_16x16x32_bf16 v[168:171], v[208:211], v[112:115], 0
  v_mfma_f32_16x16x32_bf16 v[176:179], v[208:211], v[128:131], 0
  s_waitcnt lgkmcnt(6)
  v_mfma_f32_16x16x32_bf16 v[160:163], v[212:215], v[100:103], v[160:163]
  v_mfma_f32_16x16x32_bf16 v[168:171], v[212:215], v[116:119], v[168:171]
  v_mfma_f32_16x16x32_bf16 v[176:179], v[212:215], v[132:135], v[176:179]
  s_waitcnt lgkmcnt(5)
  v_mfma_f32_16x16x32_bf16 v[160:163], v[216:219], v[104:107], v[160:163]
  v_mfma_f32_16x16x32_bf16 v[168:171], v[216:219], v[120:123], v[168:171]
  v_mfma_f32_16x16x32_bf16 v[176:179], v[216:219], v[136:139], v[176:179]
  s_waitcnt lgkmcnt(4)
  v_mfma_f32_16x16x32_bf16 v[160:163], v[220:223], v[108:111], v[160:163]
  v_mfma_f32_16x16x32_bf16 v[168:171], v[220:223], v[124:127], v[168:171]
  v_mfma_f32_16x16x32_bf16 v[176:179], v[220:223], v[140:143], v[176:179]
  s_waitcnt lgkmcnt(3)
  v_mfma_f32_16x16x32_bf16 v[164:167], v[224:227], v[96:99], 0
  v_mfma_f32_16x16x32_bf16 v[172:175], v[224:227], v[112:115], 0
  v_mfma_f32_16x16x32_bf16 v[180:183], v[224:227], v[128:131], 0
  s_waitcnt lgkmcnt(2)
  v_mfma_f32_16x16x32_bf16 v[164:167], v[228:231], v[100:103], v[164:167]
  v_mfma_f32_16x16x32_bf16 v[172:175], v[228:231], v[116:119], v[172:175]
  v_mfma_f32_16x16x32_bf16 v[180:183], v[228:231], v[132:135], v[180:183]
  s_waitcnt lgkmcnt(1)
  v_mfma_f32_16x16x32_bf16 v[164:167], v[232:235], v[104:107], v[164:167]
  v_mfma_f32_16x16x32_bf16 v[172:175], v[232:235], v[120:123], v[172:175]
  v_mfma_f32_16x16x32_bf16 v[180:183], v[232:235], v[136:139], v[180:183]
  s_waitcnt lgkmcnt(0)
  v_mfma_f32_16x16x32_bf16 v[164:167], v[236:239], v[108:111], v[164:167]
  v_mfma_f32_16x16x32_bf16 v[172:175], v[236:239], v[124:127], v[172:175]
  v_mfma_f32_16x16x32_bf16 v[180:183], v[236:239], v[140:143], v[180:183]
  v_max3_f32 v248, v160, v161, v162
  s_nop 4
  v_max3_f32 v248, v248, v163, v164
  v_max3_f32 v248, v248, v165, v166
  v_max_f32 v248, v248, v167
  v_mov_b32 v249, v248
  s_nop 1
  v_permlane16_swap_b32 v249, v248
  v_max_f32 v248, v248, v249
  v_mov_b32 v249, v248
  s_nop 1
  v_permlane32_swap_b32 v249, v248
  v_max_f32 v248, v248, v249
  v_sub_f32 v144, 0, v248
  v_sub_f32 v145, 0, v248
  v_sub_f32 v146, 0, v248
  v_sub_f32 v147, 0, v248
  v_sub_f32 v160, v160, v248
  v_sub_f32 v161, v161, v248
  v_sub_f32 v162, v162, v248
  v_sub_f32 v163, v163, v248
  v_sub_f32 v164, v164, v248
  v_sub_f32 v165, v165, v248
  v_sub_f32 v166, v166, v248
  v_sub_f32 v167, v167, v248
  v_max3_f32 v248, v168, v169, v170
  v_max3_f32 v248, v248, v171, v172
  v_max3_f32 v248, v248, v173, v174
  v_max_f32 v248, v248, v175
  v_mov_b32 v249, v248
  s_nop 1
  v_permlane16_swap_b32 v249, v248
  v_max_f32 v248, v248, v249
  v_mov_b32 v249, v248
  s_nop 1
  v_permlane32_swap_b32 v249, v248
  v_max_f32 v248, v248, v249
  v_sub_f32 v148, 0, v248
  v_sub_f32 v149, 0, v248
  v_sub_f32 v150, 0, v248
  v_sub_f32 v151, 0, v248
  v_sub_f32 v168, v168, v248
  v_sub_f32 v169, v169, v248
  v_sub_f32 v170, v170, v248
  v_sub_f32 v171, v171, v248
  v_sub_f32 v172, v172, v248
  v_sub_f32 v173, v173, v248
  v_sub_f32 v174, v174, v248
  v_sub_f32 v175, v175, v248
  v_max3_f32 v248, v176, v177, v178
  v_max3_f32 v248, v248, v179, v180
  v_max3_f32 v248, v248, v181, v182
  v_max_f32 v248, v248, v183
  v_mov_b32 v249, v248
  s_nop 1
  v_permlane16_swap_b32 v249, v248
  v_max_f32 v248, v248, v249
  v_mov_b32 v249, v248
  s_nop 1
  v_permlane32_swap_b32 v249, v248
  v_max_f32 v248, v248, v249
  v_sub_f32 v152, 0, v248
  v_sub_f32 v153, 0, v248
  v_sub_f32 v154, 0, v248
  v_sub_f32 v155, 0, v248
  v_sub_f32 v176, v176, v248
  v_sub_f32 v177, v177, v248
  v_sub_f32 v178, v178, v248
  v_sub_f32 v179, v179, v248
  v_sub_f32 v180, v180, v248
  v_sub_f32 v181, v181, v248
  v_sub_f32 v182, v182, v248
  v_sub_f32 v183, v183, v248
  v_mov_b32 v156, 0
  v_mov_b32 v157, 0
  v_mov_b32 v158, 0
  v_exp_f32 v160, v160
  v_exp_f32 v161, v161
  v_add_f32 v156, v156, v160
  v_exp_f32 v162, v162
  v_add_f32 v156, v156, v161
  v_exp_f32 v163, v163
  v_cvt_pk_bf16_f32 v160, v160, v161
  v_exp_f32 v164, v164
  v_add_f32 v156, v156, v162
  v_exp_f32 v165, v165
  v_add_f32 v156, v156, v163
  v_exp_f32 v166, v166
  v_cvt_pk_bf16_f32 v161, v162, v163
  v_add_f32 v156, v156, v164
  v_exp_f32 v167, v167
  v_add_f32 v156, v156, v165
  v_cvt_pk_bf16_f32 v162, v164, v165
  v_add_f32 v156, v156, v166
  v_add_f32 v156, v156, v167
  v_cvt_pk_bf16_f32 v163, v166, v167
  v_exp_f32 v168, v168
  v_exp_f32 v169, v169
  v_add_f32 v157, v157, v168
  v_exp_f32 v170, v170
  v_add_f32 v157, v157, v169
  s_waitcnt lgkmcnt(0)
  s_waitcnt vmcnt(0)
  s_cmp_eq_u32 s67, 1
  s_cbranch_scc1 L_lead
  s_barrier
L_lead:
  s_barrier
  ds_read_b128 v[208:211], v240 offset:0
  ds_read_b128 v[212:215], v240 offset:64
  ds_read_b128 v[216:219], v240 offset:128
  ds_read_b128 v[220:223], v240 offset:192
  ds_read_b128 v[224:227], v240 offset:512
  ds_read_b128 v[228:231], v240 offset:576
  ds_read_b128 v[232:235], v240 offset:640
  ds_read_b128 v[236:239], v240 offset:704
  s_waitcnt lgkmcnt(0)
  v_subrev_u32 v240, s58, v240
L_M:
  s_mov_b32 s41, 15
L_loop_153:
  s_barrier
L_M_in:
  v_mfma_f32_16x16x32_bf16 v[184:187], v[208:211], v[96:99], v[144:147]
  ds_read_b64_tr_b16 v[244:245], v241 offset:192
  v_exp_f32 v171, v171
  v_mfma_f32_16x16x32_bf16 v[192:195], v[208:211], v[112:115], v[148:151]
  ds_read_b64_tr_b16 v[246:247], v241 offset:704
  v_cvt_pk_bf16_f32 v168, v168, v169
  v_mfma_f32_16x16x32_bf16 v[200:203], v[208:211], v[128:131], v[152:155]
  ds_read_b64_tr_b16 v[208:209], v241 offset:0
  v_exp_f32 v172, v172
  v_mfma_f32_16x16x32_bf16 v[184:187], v[212:215], v[100:103], v[184:187]
  ds_read_b64_tr_b16 v[210:211], v241 offset:512
  v_add_f32 v157, v157, v170
  v_mfma_f32_16x16x32_bf16 v[192:195], v[212:215], v[116:119], v[192:195]
  ds_read_b64_tr_b16 v[252:253], v241 offset:224
  v_exp_f32 v173, v173
  v_mfma_f32_16x16x32_bf16 v[200:203], v[212:215], v[132:135], v[200:203]
  ds_read_b64_tr_b16 v[212:213], v241 offset:32
  v_add_f32 v157, v157, v171
  v_mfma_f32_16x16x32_bf16 v[184:187], v[216:219], v[104:107], v[184:187]
  ds_read_b64_tr_b16 v[214:215], v241 offset:544
  v_exp_f32 v174, v174
  v_mfma_f32_16x16x32_bf16 v[192:195], v[216:219], v[120:123], v[192:195]
  ds_read_b64_tr_b16 v[254:255], v241 offset:736
  v_cvt_pk_bf16_f32 v169, v170, v171
  v_mfma_f32_16x16x32_bf16 v[200:203], v[216:219], v[136:139], v[200:203]
  ds_read_b64_tr_b16 v[216:217], v241 offset:64
  v_add_f32 v157, v157, v172
  v_mfma_f32_16x16x32_bf16 v[184:187], v[220:223], v[108:111], v[184:187]
  ds_read_b64_tr_b16 v[218:219], v241 offset:576
  v_exp_f32 v175, v175
  v_mfma_f32_16x16x32_bf16 v[192:195], v[220:223], v[124:127], v[192:195]
  v_add_f32 v157, v157, v173
  v_cvt_pk_bf16_f32 v170, v172, v173
  v_add_f32 v157, v157, v174
  v_mfma_f32_16x16x32_bf16 v[200:203], v[220:223], v[140:143], v[200:203]
  ds_read_b64_tr_b16 v[220:221], v241 offset:96
  v_add_f32 v157, v157, v175
  v_mfma_f32_16x16x32_bf16 v[188:191], v[224:227], v[96:99], v[144:147]
  ds_read_b64_tr_b16 v[222:223], v241 offset:608
  v_cvt_pk_bf16_f32 v171, v174, v175
  v_mfma_f32_16x16x32_bf16 v[196:199], v[224:227], v[112:115], v[148:151]
  v_exp_f32 v176, v176
  v_exp_f32 v177, v177
  v_mfma_f32_16x16x32_bf16 v[204:207], v[224:227], v[128:131], v[152:155]
  ds_read_b64_tr_b16 v[224:225], v241 offset:128
  v_add_f32 v158, v158, v176
  v_mfma_f32_16x16x32_bf16 v[188:191], v[228:231], v[100:103], v[188:191]
  ds_read_b64_tr_b16 v[226:227], v241 offset:640
  v_exp_f32 v178, v178
  v_mfma_f32_16x16x32_bf16 v[196:199], v[228:231], v[116:119], v[196:199]
  v_add_f32 v158, v158, v177
  v_exp_f32 v179, v179
  v_mfma_f32_16x16x32_bf16 v[204:207], v[228:231], v[132:135], v[204:207]
  ds_read_b64_tr_b16 v[228:229], v241 offset:160
  v_cvt_pk_bf16_f32 v176, v176, v177
  v_mfma_f32_16x16x32_bf16 v[188:191], v[232:235], v[104:107], v[188:191]
  s_waitcnt lgkmcnt(7)
  ds_read_b64_tr_b16 v[230:231], v241 offset:672
  v_exp_f32 v180, v180
  v_mfma_f32_16x16x32_bf16 v[196:199], v[232:235], v[120:123], v[196:199]
  v_add_f32 v158, v158, v178
  v_exp_f32 v181, v181
  v_mfma_f32_16x16x32_bf16 v[204:207], v[232:235], v[136:139], v[204:207]
  v_add_f32 v158, v158, v179
  v_exp_f32 v182, v182
  v_mfma_f32_16x16x32_bf16 v[188:191], v[236:239], v[108:111], v[188:191]
  v_cvt_pk_bf16_f32 v177, v178, v179
  v_add_f32 v158, v158, v180
  v_exp_f32 v183, v183
  v_mfma_f32_16x16x32_bf16 v[196:199], v[236:239], v[124:127], v[196:199]
  v_add_f32 v158, v158, v181
  v_cvt_pk_bf16_f32 v178, v180, v181
  v_add_f32 v158, v158, v182
  v_mfma_f32_16x16x32_bf16 v[204:207], v[236:239], v[140:143], v[204:207]
  v_add_f32 v158, v158, v183
  v_cvt_pk_bf16_f32 v179, v182, v183
  s_waitcnt lgkmcnt(0)
  s_barrier
  v_mfma_f32_16x16x32_bf16 v[0:3], v[208:211], v[160:163], v[0:3]
  ds_read_b128 v[232:235], v240 offset:640
  v_max_f32 v248, v184, v185
  v_mfma_f32_16x16x32_bf16 v[32:35], v[208:211], v[168:171], v[32:35]
  ds_read_b128 v[236:239], v240 offset:704
  v_max3_f32 v248, v248, v186, v187
  v_max3_f32 v248, v248, v192, v193
  v_mfma_f32_16x16x32_bf16 v[64:67], v[208:211], v[176:179], v[64:67]
  ds_read_b128 v[208:211], v240 offset:0
  v_max3_f32 v248, v248, v194, v195
  v_mfma_f32_16x16x32_bf16 v[4:7], v[212:215], v[160:163], v[4:7]
  v_max3_f32 v248, v248, v200, v201
  v_max3_f32 v248, v248, v202, v203
  v_max3_f32 v248, v248, v188, v189
  v_mfma_f32_16x16x32_bf16 v[36:39], v[212:215], v[168:171], v[36:39]
  v_max3_f32 v248, v248, v190, v191
  v_max3_f32 v248, v248, v196, v197
  v_max3_f32 v248, v248, v198, v199
  v_mfma_f32_16x16x32_bf16 v[68:71], v[212:215], v[176:179], v[68:71]
  ds_read_b128 v[212:215], v240 offset:64
  v_max3_f32 v248, v248, v204, v205
  v_max3_f32 v248, v248, v206, v207
  v_cmp_lt_f32 vcc, s42, v248
  s_cbranch_vccnz L_rare_154
  v_mfma_f32_16x16x32_bf16 v[8:11], v[216:219], v[160:163], v[8:11]
  v_add_u32 v241, s57, v241
  s_sub_u32 s57, 0, s57
  v_mfma_f32_16x16x32_bf16 v[40:43], v[216:219], v[168:171], v[40:43]
  v_exp_f32 v184, v184
  v_mfma_f32_16x16x32_bf16 v[72:75], v[216:219], v[176:179], v[72:75]
  ds_read_b128 v[216:219], v240 offset:128
  v_mfma_f32_16x16x32_bf16 v[12:15], v[220:223], v[160:163], v[12:15]
  v_exp_f32 v185, v185
  v_add_f32 v156, v156, v184
  v_mfma_f32_16x16x32_bf16 v[44:47], v[220:223], v[168:171], v[44:47]
  v_exp_f32 v186, v186
  v_add_f32 v156, v156, v185
  v_mfma_f32_16x16x32_bf16 v[76:79], v[220:223], v[176:179], v[76:79]
  ds_read_b128 v[220:223], v240 offset:192
  v_mfma_f32_16x16x32_bf16 v[16:19], v[224:227], v[160:163], v[16:19]
  v_exp_f32 v187, v187
  v_cvt_pk_bf16_f32 v184, v184, v185
  v_mfma_f32_16x16x32_bf16 v[48:51], v[224:227], v[168:171], v[48:51]
  v_exp_f32 v188, v188
  v_add_f32 v156, v156, v186
  v_mfma_f32_16x16x32_bf16 v[80:83], v[224:227], v[176:179], v[80:83]
  ds_read_b128 v[224:227], v240 offset:512
  v_mfma_f32_16x16x32_bf16 v[20:23], v[228:231], v[160:163], v[20:23]
  v_exp_f32 v189, v189
  v_add_f32 v156, v156, v187
  v_mfma_f32_16x16x32_bf16 v[52:55], v[228:231], v[168:171], v[52:55]
  v_exp_f32 v190, v190
  v_cvt_pk_bf16_f32 v185, v186, v187
  v_mfma_f32_16x16x32_bf16 v[84:87], v[228:231], v[176:179], v[84:87]
  ds_read_b128 v[228:231], v240 offset:576
  v_add_f32 v156, v156, v188
  v_mfma_f32_16x16x32_bf16 v[24:27], v[244:247], v[160:163], v[24:27]
  v_exp_f32 v191, v191
  v_add_f32 v156, v156, v189
  v_mfma_f32_16x16x32_bf16 v[56:59], v[244:247], v[168:171], v[56:59]
  v_cvt_pk_bf16_f32 v186, v188, v189
  v_add_f32 v156, v156, v190
  v_mfma_f32_16x16x32_bf16 v[88:91], v[244:247], v[176:179], v[88:91]
  v_add_f32 v156, v156, v191
  v_cvt_pk_bf16_f32 v187, v190, v191
  v_mfma_f32_16x16x32_bf16 v[28:31], v[252:255], v[160:163], v[28:31]
  v_exp_f32 v192, v192
  v_mfma_f32_16x16x32_bf16 v[60:63], v[252:255], v[168:171], v[60:63]
  v_exp_f32 v193, v193
  v_add_f32 v157, v157, v192
  v_mfma_f32_16x16x32_bf16 v[92:95], v[252:255], v[176:179], v[92:95]
  v_exp_f32 v194, v194
  v_add_f32 v157, v157, v193
L_rareb_155:
  v_add_u32 v240, s58, v240
  s_sub_u32 s58, 0, s58
  s_waitcnt lgkmcnt(0)
  s_barrier
  v_mfma_f32_16x16x32_bf16 v[160:163], v[208:211], v[96:99], v[144:147]
  ds_read_b64_tr_b16 v[244:245], v241 offset:192
  v_exp_f32 v195, v195
  v_mfma_f32_16x16x32_bf16 v[168:171], v[208:211], v[112:115], v[148:151]
  ds_read_b64_tr_b16 v[246:247], v241 offset:704
  v_cvt_pk_bf16_f32 v192, v192, v193
  v_mfma_f32_16x16x32_bf16 v[176:179], v[208:211], v[128:131], v[152:155]
  ds_read_b64_tr_b16 v[208:209], v241 offset:0
  v_exp_f32 v196, v196
  v_mfma_f32_16x16x32_bf16 v[160:163], v[212:215], v[100:103], v[160:163]
  ds_read_b64_tr_b16 v[210:211], v241 offset:512
  v_add_f32 v157, v157, v194
  v_mfma_f32_16x16x32_bf16 v[168:171], v[212:215], v[116:119], v[168:171]
  ds_read_b64_tr_b16 v[252:253], v241 offset:224
  v_exp_f32 v197, v197
  v_mfma_f32_16x16x32_bf16 v[176:179], v[212:215], v[132:135], v[176:179]
  ds_read_b64_tr_b16 v[212:213], v241 offset:32
  v_add_f32 v157, v157, v195
  v_mfma_f32_16x16x32_bf16 v[160:163], v[216:219], v[104:107], v[160:163]
  ds_read_b64_tr_b16 v[214:215], v241 offset:544
  v_exp_f32 v198, v198
  v_mfma_f32_16x16x32_bf16 v[168:171], v[216:219], v[120:123], v[168:171]
  ds_read_b64_tr_b16 v[254:255], v241 offset:736
  v_cvt_pk_bf16_f32 v193, v194, v195
  v_mfma_f32_16x16x32_bf16 v[176:179], v[216:219], v[136:139], v[176:179]
  ds_read_b64_tr_b16 v[216:217], v241 offset:64
  v_add_f32 v157, v157, v196
  v_mfma_f32_16x16x32_bf16 v[160:163], v[220:223], v[108:111], v[160:163]
  ds_read_b64_tr_b16 v[218:219], v241 offset:576
  v_exp_f32 v199, v199
  v_mfma_f32_16x16x32_bf16 v[168:171], v[220:223], v[124:127], v[168:171]
  v_add_f32 v157, v157, v197
  v_cvt_pk_bf16_f32 v194, v196, v197
  v_add_f32 v157, v157, v198
  v_mfma_f32_16x16x32_bf16 v[176:179], v[220:223], v[140:143], v[176:179]
  ds_read_b64_tr_b16 v[220:221], v241 offset:96
  v_add_f32 v157, v157, v199
  v_mfma_f32_16x16x32_bf16 v[164:167], v[224:227], v[96:99], v[144:147]
  ds_read_b64_tr_b16 v[222:223], v241 offset:608
  v_cvt_pk_bf16_f32 v195, v198, v199
  v_mfma_f32_16x16x32_bf16 v[172:175], v[224:227], v[112:115], v[148:151]
  v_exp_f32 v200, v200
  v_exp_f32 v201, v201
  v_mfma_f32_16x16x32_bf16 v[180:183], v[224:227], v[128:131], v[152:155]
  ds_read_b64_tr_b16 v[224:225], v241 offset:128
  v_add_f32 v158, v158, v200
  v_mfma_f32_16x16x32_bf16 v[164:167], v[228:231], v[100:103], v[164:167]
  ds_read_b64_tr_b16 v[226:227], v241 offset:640
  v_exp_f32 v202, v202
  v_mfma_f32_16x16x32_bf16 v[172:175], v[228:231], v[116:119], v[172:175]
  v_add_f32 v158, v158, v201
  v_exp_f32 v203, v203
  v_mfma_f32_16x16x32_bf16 v[180:183], v[228:231], v[132:135], v[180:183]
  ds_read_b64_tr_b16 v[228:229], v241 offset:160
  v_cvt_pk_bf16_f32 v200, v200, v201
  v_mfma_f32_16x16x32_bf16 v[164:167], v[232:235], v[104:107], v[164:167]
  s_waitcnt lgkmcnt(7)
  ds_read_b64_tr_b16 v[230:231], v241 offset:672
  v_exp_f32 v204, v204
  v_mfma_f32_16x16x32_bf16 v[172:175], v[232:235], v[120:123], v[172:175]
  v_add_f32 v158, v158, v202
  v_exp_f32 v205, v205
  v_mfma_f32_16x16x32_bf16 v[180:183], v[232:235], v[136:139], v[180:183]
  v_add_f32 v158, v158, v203
  v_exp_f32 v206, v206
  v_mfma_f32_16x16x32_bf16 v[164:167], v[236:239], v[108:111], v[164:167]
  v_cvt_pk_bf16_f32 v201, v202, v203
  v_add_f32 v158, v158, v204
  v_exp_f32 v207, v207
  v_mfma_f32_16x16x32_bf16 v[172:175], v[236:239], v[124:127], v[172:175]
  v_add_f32 v158, v158, v205
  v_cvt_pk_bf16_f32 v202, v204, v205
  v_add_f32 v158, v158, v206
  v_mfma_f32_16x16x32_bf16 v[180:183], v[236:239], v[140:143], v[180:183]
  v_add_f32 v158, v158, v207
  v_cvt_pk_bf16_f32 v203, v206, v207
  s_waitcnt lgkmcnt(0)
  s_barrier
  v_mfma_f32_16x16x32_bf16 v[0:3], v[208:211], v[184:187], v[0:3]
  ds_read_b128 v[232:235], v240 offset:640
  v_max_f32 v248, v160, v161
  v_mfma_f32_16x16x32_bf16 v[32:35], v[208:211], v[192:195], v[32:35]
  ds_read_b128 v[236:239], v240 offset:704
  v_max3_f32 v248, v248, v162, v163
  v_max3_f32 v248, v248, v168, v169
  v_mfma_f32_16x16x32_bf16 v[64:67], v[208:211], v[200:203], v[64:67]
  ds_read_b128 v[208:211], v240 offset:0
  v_max3_f32 v248, v248, v170, v171
  v_mfma_f32_16x16x32_bf16 v[4:7], v[212:215], v[184:187], v[4:7]
  v_max3_f32 v248, v248, v176, v177
  v_max3_f32 v248, v248, v178, v179
  v_max3_f32 v248, v248, v164, v165
  v_mfma_f32_16x16x32_bf16 v[36:39], v[212:215], v[192:195], v[36:39]
  v_max3_f32 v248, v248, v166, v167
  v_max3_f32 v248, v248, v172, v173
  v_max3_f32 v248, v248, v174, v175
  v_mfma_f32_16x16x32_bf16 v[68:71], v[212:215], v[200:203], v[68:71]
  ds_read_b128 v[212:215], v240 offset:64
  v_max3_f32 v248, v248, v180, v181
  v_max3_f32 v248, v248, v182, v183
  v_cmp_lt_f32 vcc, s42, v248
  s_cbranch_vccnz L_rare_156
  v_mfma_f32_16x16x32_bf16 v[8:11], v[216:219], v[184:187], v[8:11]
  v_add_u32 v241, s57, v241
  s_sub_u32 s57, 0, s57
  v_mfma_f32_16x16x32_bf16 v[40:43], v[216:219], v[192:195], v[40:43]
  v_exp_f32 v160, v160
  v_mfma_f32_16x16x32_bf16 v[72:75], v[216:219], v[200:203], v[72:75]
  ds_read_b128 v[216:219], v240 offset:128
  v_mfma_f32_16x16x32_bf16 v[12:15], v[220:223], v[184:187], v[12:15]
  v_exp_f32 v161, v161
  v_add_f32 v156, v156, v160
  v_mfma_f32_16x16x32_bf16 v[44:47], v[220:223], v[192:195], v[44:47]
  v_exp_f32 v162, v162
  v_add_f32 v156, v156, v161
  v_mfma_f32_16x16x32_bf16 v[76:79], v[220:223], v[200:203], v[76:79]
  ds_read_b128 v[220:223], v240 offset:192
  v_mfma_f32_16x16x32_bf16 v[16:19], v[224:227], v[184:187], v[16:19]
  v_exp_f32 v163, v163
  v_cvt_pk_bf16_f32 v160, v160, v161
  v_mfma_f32_16x16x32_bf16 v[48:51], v[224:227], v[192:195], v[48:51]
  v_exp_f32 v164, v164
  v_add_f32 v156, v156, v162
  v_mfma_f32_16x16x32_bf16 v[80:83], v[224:227], v[200:203], v[80:83]
  ds_read_b128 v[224:227], v240 offset:512
  v_mfma_f32_16x16x32_bf16 v[20:23], v[228:231], v[184:187], v[20:23]
  v_exp_f32 v165, v165
  v_add_f32 v156, v156, v163
  v_mfma_f32_16x16x32_bf16 v[52:55], v[228:231], v[192:195], v[52:55]
  v_exp_f32 v166, v166
  v_cvt_pk_bf16_f32 v161, v162, v163
  v_mfma_f32_16x16x32_bf16 v[84:87], v[228:231], v[200:203], v[84:87]
  ds_read_b128 v[228:231], v240 offset:576
  v_add_f32 v156, v156, v164
  v_mfma_f32_16x16x32_bf16 v[24:27], v[244:247], v[184:187], v[24:27]
  v_exp_f32 v167, v167
  v_add_f32 v156, v156, v165
  v_mfma_f32_16x16x32_bf16 v[56:59], v[244:247], v[192:195], v[56:59]
  v_cvt_pk_bf16_f32 v162, v164, v165
  v_add_f32 v156, v156, v166
  v_mfma_f32_16x16x32_bf16 v[88:91], v[244:247], v[200:203], v[88:91]
  v_add_f32 v156, v156, v167
  v_cvt_pk_bf16_f32 v163, v166, v167
  v_mfma_f32_16x16x32_bf16 v[28:31], v[252:255], v[184:187], v[28:31]
  v_exp_f32 v168, v168
  v_mfma_f32_16x16x32_bf16 v[60:63], v[252:255], v[192:195], v[60:63]
  v_exp_f32 v169, v169
  v_add_f32 v157, v157, v168
  v_mfma_f32_16x16x32_bf16 v[92:95], v[252:255], v[200:203], v[92:95]
  v_exp_f32 v170, v170
  v_add_f32 v157, v157, v169
L_rareb_157:
  v_add_u32 v240, s58, v240
  s_sub_u32 s58, 0, s58
  s_waitcnt lgkmcnt(0)
  s_sub_u32 s41, s41, 1
  s_cmp_lg_u32 s41, 0
  s_cbranch_scc1 L_loop_153
  s_barrier
  v_mfma_f32_16x16x32_bf16 v[184:187], v[208:211], v[96:99], v[144:147]
  ds_read_b64_tr_b16 v[244:245], v241 offset:192
  v_exp_f32 v171, v171
  v_mfma_f32_16x16x32_bf16 v[192:195], v[208:211], v[112:115], v[148:151]
  ds_read_b64_tr_b16 v[246:247], v241 offset:704
  v_cvt_pk_bf16_f32 v168, v168, v169
  v_mfma_f32_16x16x32_bf16 v[200:203], v[208:211], v[128:131], v[152:155]
  ds_read_b64_tr_b16 v[208:209], v241 offset:0
  v_exp_f32 v172, v172
  v_mfma_f32_16x16x32_bf16 v[184:187], v[212:215], v[100:103], v[184:187]
  ds_read_b64_tr_b16 v[210:211], v241 offset:512
  v_add_f32 v157, v157, v170
  v_mfma_f32_16x16x32_bf16 v[192:195], v[212:215], v[116:119], v[192:195]
  ds_read_b64_tr_b16 v[252:253], v241 offset:224
  v_exp_f32 v173, v173
  v_mfma_f32_16x16x32_bf16 v[200:203], v[212:215], v[132:135], v[200:203]
  ds_read_b64_tr_b16 v[212:213], v241 offset:32
  v_add_f32 v157, v157, v171
  v_mfma_f32_16x16x32_bf16 v[184:187], v[216:219], v[104:107], v[184:187]
  ds_read_b64_tr_b16 v[214:215], v241 offset:544
  v_exp_f32 v174, v174
  v_mfma_f32_16x16x32_bf16 v[192:195], v[216:219], v[120:123], v[192:195]
  ds_read_b64_tr_b16 v[254:255], v241 offset:736
  v_cvt_pk_bf16_f32 v169, v170, v171
  v_mfma_f32_16x16x32_bf16 v[200:203], v[216:219], v[136:139], v[200:203]
  ds_read_b64_tr_b16 v[216:217], v241 offset:64
  v_add_f32 v157, v157, v172
  v_mfma_f32_16x16x32_bf16 v[184:187], v[220:223], v[108:111], v[184:187]
  ds_read_b64_tr_b16 v[218:219], v241 offset:576
  v_exp_f32 v175, v175
  v_mfma_f32_16x16x32_bf16 v[192:195], v[220:223], v[124:127], v[192:195]
  v_add_f32 v157, v157, v173
  v_cvt_pk_bf16_f32 v170, v172, v173
  v_add_f32 v157, v157, v174
  v_mfma_f32_16x16x32_bf16 v[200:203], v[220:223], v[140:143], v[200:203]
  ds_read_b64_tr_b16 v[220:221], v241 offset:96
  v_add_f32 v157, v157, v175
  v_mfma_f32_16x16x32_bf16 v[188:191], v[224:227], v[96:99], v[144:147]
  ds_read_b64_tr_b16 v[222:223], v241 offset:608
  v_cvt_pk_bf16_f32 v171, v174, v175
  v_mfma_f32_16x16x32_bf16 v[196:199], v[224:227], v[112:115], v[148:151]
  v_exp_f32 v176, v176
  v_exp_f32 v177, v177
  v_mfma_f32_16x16x32_bf16 v[204:207], v[224:227], v[128:131], v[152:155]
  ds_read_b64_tr_b16 v[224:225], v241 offset:128
  v_add_f32 v158, v158, v176
  v_mfma_f32_16x16x32_bf16 v[188:191], v[228:231], v[100:103], v[188:191]
  ds_read_b64_tr_b16 v[226:227], v241 offset:640
  v_exp_f32 v178, v178
  v_mfma_f32_16x16x32_bf16 v[196:199], v[228:231], v[116:119], v[196:199]
  v_add_f32 v158, v158, v177
  v_exp_f32 v179, v179
  v_mfma_f32_16x16x32_bf16 v[204:207], v[228:231], v[132:135], v[204:207]
  ds_read_b64_tr_b16 v[228:229], v241 offset:160
  v_cvt_pk_bf16_f32 v176, v176, v177
  v_mfma_f32_16x16x32_bf16 v[188:191], v[232:235], v[104:107], v[188:191]
  s_waitcnt lgkmcnt(7)
  ds_read_b64_tr_b16 v[230:231], v241 offset:672
  v_exp_f32 v180, v180
  v_mfma_f32_16x16x32_bf16 v[196:199], v[232:235], v[120:123], v[196:199]
  v_add_f32 v158, v158, v178
  v_exp_f32 v181, v181
  v_mfma_f32_16x16x32_bf16 v[204:207], v[232:235], v[136:139], v[204:207]
  v_add_f32 v158, v158, v179
  v_exp_f32 v182, v182
  v_mfma_f32_16x16x32_bf16 v[188:191], v[236:239], v[108:111], v[188:191]
  v_cvt_pk_bf16_f32 v177, v178, v179
  v_add_f32 v158, v158, v180
  v_exp_f32 v183, v183
  v_mfma_f32_16x16x32_bf16 v[196:199], v[236:239], v[124:127], v[196:199]
  v_add_f32 v158, v158, v181
  v_cvt_pk_bf16_f32 v178, v180, v181
  v_add_f32 v158, v158, v182
  v_mfma_f32_16x16x32_bf16 v[204:207], v[236:239], v[140:143], v[204:207]
  v_add_f32 v158, v158, v183
  v_cvt_pk_bf16_f32 v179, v182, v183
  s_waitcnt lgkmcnt(0)
  s_barrier
  v_mfma_f32_16x16x32_bf16 v[0:3], v[208:211], v[160:163], v[0:3]
  ds_read_b128 v[232:235], v240 offset:640
  v_max_f32 v248, v184, v185
  v_mfma_f32_16x16x32_bf16 v[32:35], v[208:211], v[168:171], v[32:35]
  ds_read_b128 v[236:239], v240 offset:704
  v_max3_f32 v248, v248, v186, v187
  v_max3_f32 v248, v248, v192, v193
  v_mfma_f32_16x16x32_bf16 v[64:67], v[208:211], v[176:179], v[64:67]
  ds_read_b128 v[208:211], v240 offset:0
  v_max3_f32 v248, v248, v194, v195
  v_mfma_f32_16x16x32_bf16 v[4:7], v[212:215], v[160:163], v[4:7]
  v_max3_f32 v248, v248, v200, v201
  v_max3_f32 v248, v248, v202, v203
  v_max3_f32 v248, v248, v188, v189
  v_mfma_f32_16x16x32_bf16 v[36:39], v[212:215], v[168:171], v[36:39]
  v_max3_f32 v248, v248, v190, v191
  v_max3_f32 v248, v248, v196, v197
  v_max3_f32 v248, v248, v198, v199
  v_mfma_f32_16x16x32_bf16 v[68:71], v[212:215], v[176:179], v[68:71]
  ds_read_b128 v[212:215], v240 offset:64
  v_max3_f32 v248, v248, v204, v205
  v_max3_f32 v248, v248, v206, v207
  v_cmp_lt_f32 vcc, s42, v248
  s_cbranch_vccnz L_rare_158
  v_mfma_f32_16x16x32_bf16 v[8:11], v[216:219], v[160:163], v[8:11]
  v_add_u32 v241, s57, v241
  s_sub_u32 s57, 0, s57
  v_mfma_f32_16x16x32_bf16 v[40:43], v[216:219], v[168:171], v[40:43]
  v_exp_f32 v184, v184
  v_mfma_f32_16x16x32_bf16 v[72:75], v[216:219], v[176:179], v[72:75]
  ds_read_b128 v[216:219], v240 offset:128
  v_mfma_f32_16x16x32_bf16 v[12:15], v[220:223], v[160:163], v[12:15]
  v_exp_f32 v185, v185
  v_add_f32 v156, v156, v184
  v_mfma_f32_16x16x32_bf16 v[44:47], v[220:223], v[168:171], v[44:47]
  v_exp_f32 v186, v186
  v_add_f32 v156, v156, v185
  v_mfma_f32_16x16x32_bf16 v[76:79], v[220:223], v[176:179], v[76:79]
  ds_read_b128 v[220:223], v240 offset:192
  v_mfma_f32_16x16x32_bf16 v[16:19], v[224:227], v[160:163], v[16:19]
  v_exp_f32 v187, v187
  v_cvt_pk_bf16_f32 v184, v184, v185
  v_mfma_f32_16x16x32_bf16 v[48:51], v[224:227], v[168:171], v[48:51]
  v_exp_f32 v188, v188
  v_add_f32 v156, v156, v186
  v_mfma_f32_16x16x32_bf16 v[80:83], v[224:227], v[176:179], v[80:83]
  ds_read_b128 v[224:227], v240 offset:512
  v_mfma_f32_16x16x32_bf16 v[20:23], v[228:231], v[160:163], v[20:23]
  v_exp_f32 v189, v189
  v_add_f32 v156, v156, v187
  v_mfma_f32_16x16x32_bf16 v[52:55], v[228:231], v[168:171], v[52:55]
  v_exp_f32 v190, v190
  v_cvt_pk_bf16_f32 v185, v186, v187
  v_mfma_f32_16x16x32_bf16 v[84:87], v[228:231], v[176:179], v[84:87]
  ds_read_b128 v[228:231], v240 offset:576
  v_add_f32 v156, v156, v188
  v_mfma_f32_16x16x32_bf16 v[24:27], v[244:247], v[160:163], v[24:27]
  v_exp_f32 v191, v191
  v_add_f32 v156, v156, v189
  v_mfma_f32_16x16x32_bf16 v[56:59], v[244:247], v[168:171], v[56:59]
  v_cvt_pk_bf16_f32 v186, v188, v189
  v_add_f32 v156, v156, v190
  v_mfma_f32_16x16x32_bf16 v[88:91], v[244:247], v[176:179], v[88:91]
  v_add_f32 v156, v156, v191
  v_cvt_pk_bf16_f32 v187, v190, v191
  v_mfma_f32_16x16x32_bf16 v[28:31], v[252:255], v[160:163], v[28:31]
  v_exp_f32 v192, v192
  v_mfma_f32_16x16x32_bf16 v[60:63], v[252:255], v[168:171], v[60:63]
  v_exp_f32 v193, v193
  v_add_f32 v157, v157, v192
  v_mfma_f32_16x16x32_bf16 v[92:95], v[252:255], v[176:179], v[92:95]
  v_exp_f32 v194, v194
  v_add_f32 v157, v157, v193
L_rareb_159:
  v_add_u32 v240, s58, v240
  s_sub_u32 s58, 0, s58
  s_waitcnt lgkmcnt(0)
  s_cmp_eq_u32 s59, 1
  s_cbranch_scc1 L_last
  s_mov_b32 s59, 1
  ds_read_b128 v[96:99], v159 offset:0
  ds_read_b128 v[100:103], v159 offset:64
  ds_read_b128 v[104:107], v159 offset:128
  ds_read_b128 v[108:111], v159 offset:192
  ds_read_b128 v[112:115], v159 offset:4352
  ds_read_b128 v[116:119], v159 offset:4416
  ds_read_b128 v[120:123], v159 offset:4480
  ds_read_b128 v[124:127], v159 offset:4544
  ds_read_b128 v[128:131], v159 offset:8704
  ds_read_b128 v[132:135], v159 offset:8768
  ds_read_b128 v[136:139], v159 offset:8832
  ds_read_b128 v[140:143], v159 offset:8896
  s_waitcnt lgkmcnt(0)
  s_barrier
  v_mfma_f32_16x16x32_bf16 v[160:163], v[208:211], v[96:99], 0
  ds_read_b64_tr_b16 v[244:245], v241 offset:192
  v_exp_f32 v195, v195
  v_mfma_f32_16x16x32_bf16 v[168:171], v[208:211], v[112:115], 0
  ds_read_b64_tr_b16 v[246:247], v241 offset:704
  v_cvt_pk_bf16_f32 v192, v192, v193
  v_mfma_f32_16x16x32_bf16 v[176:179], v[208:211], v[128:131], 0
  ds_read_b64_tr_b16 v[208:209], v241 offset:0
  v_exp_f32 v196, v196
  v_mfma_f32_16x16x32_bf16 v[160:163], v[212:215], v[100:103], v[160:163]
  ds_read_b64_tr_b16 v[210:211], v241 offset:512
  v_add_f32 v157, v157, v194
  v_mfma_f32_16x16x32_bf16 v[168:171], v[212:215], v[116:119], v[168:171]
  ds_read_b64_tr_b16 v[252:253], v241 offset:224
  v_exp_f32 v197, v197
  v_mfma_f32_16x16x32_bf16 v[176:179], v[212:215], v[132:135], v[176:179]
  ds_read_b64_tr_b16 v[212:213], v241 offset:32
  v_add_f32 v157, v157, v195
  v_mfma_f32_16x16x32_bf16 v[160:163], v[216:219], v[104:107], v[160:163]
  ds_read_b64_tr_b16 v[214:215], v241 offset:544
  v_exp_f32 v198, v198
  v_mfma_f32_16x16x32_bf16 v[168:171], v[216:219], v[120:123], v[168:171]
  ds_read_b64_tr_b16 v[254:255], v241 offset:736
  v_cvt_pk_bf16_f32 v193, v194, v195
  v_mfma_f32_16x16x32_bf16 v[176:179], v[216:219], v[136:139], v[176:179]
  ds_read_b64_tr_b16 v[216:217], v241 offset:64
  v_add_f32 v157, v157, v196
  v_mfma_f32_16x16x32_bf16 v[160:163], v[220:223], v[108:111], v[160:163]
  ds_read_b64_tr_b16 v[218:219], v241 offset:576
  v_exp_f32 v199, v199
  v_mfma_f32_16x16x32_bf16 v[168:171], v[220:223], v[124:127], v[168:171]
  v_add_f32 v157, v157, v197
  v_cvt_pk_bf16_f32 v194, v196, v197
  v_add_f32 v157, v157, v198
  v_mfma_f32_16x16x32_bf16 v[176:179], v[220:223], v[140:143], v[176:179]
  ds_read_b64_tr_b16 v[220:221], v241 offset:96
  v_add_f32 v157, v157, v199
  v_mfma_f32_16x16x32_bf16 v[164:167], v[224:227], v[96:99], 0
  ds_read_b64_tr_b16 v[222:223], v241 offset:608
  v_cvt_pk_bf16_f32 v195, v198, v199
  v_mfma_f32_16x16x32_bf16 v[172:175], v[224:227], v[112:115], 0
  v_exp_f32 v200, v200
  v_exp_f32 v201, v201
  v_mfma_f32_16x16x32_bf16 v[180:183], v[224:227], v[128:131], 0
  ds_read_b64_tr_b16 v[224:225], v241 offset:128
  v_add_f32 v158, v158, v200
  v_mfma_f32_16x16x32_bf16 v[164:167], v[228:231], v[100:103], v[164:167]
  ds_read_b64_tr_b16 v[226:227], v241 offset:640
  v_exp_f32 v202, v202
  v_mfma_f32_16x16x32_bf16 v[172:175], v[228:231], v[116:119], v[172:175]
  v_add_f32 v158, v158, v201
  v_exp_f32 v203, v203
  v_mfma_f32_16x16x32_bf16 v[180:183], v[228:231], v[132:135], v[180:183]
  ds_read_b64_tr_b16 v[228:229], v241 offset:160
  v_cvt_pk_bf16_f32 v200, v200, v201
  v_mfma_f32_16x16x32_bf16 v[164:167], v[232:235], v[104:107], v[164:167]
  s_waitcnt lgkmcnt(7)
  ds_read_b64_tr_b16 v[230:231], v241 offset:672
  v_exp_f32 v204, v204
  v_mfma_f32_16x16x32_bf16 v[172:175], v[232:235], v[120:123], v[172:175]
  v_add_f32 v158, v158, v202
  v_exp_f32 v205, v205
  v_mfma_f32_16x16x32_bf16 v[180:183], v[232:235], v[136:139], v[180:183]
  v_add_f32 v158, v158, v203
  v_exp_f32 v206, v206
  v_mfma_f32_16x16x32_bf16 v[164:167], v[236:239], v[108:111], v[164:167]
  v_cvt_pk_bf16_f32 v201, v202, v203
  v_add_f32 v158, v158, v204
  v_exp_f32 v207, v207
  v_mfma_f32_16x16x32_bf16 v[172:175], v[236:239], v[124:127], v[172:175]
  v_add_f32 v158, v158, v205
  v_cvt_pk_bf16_f32 v202, v204, v205
  v_add_f32 v158, v158, v206
  v_mfma_f32_16x16x32_bf16 v[180:183], v[236:239], v[140:143], v[180:183]
  v_add_f32 v158, v158, v207
  v_cvt_pk_bf16_f32 v203, v206, v207
  s_waitcnt lgkmcnt(0)
  s_barrier
  v_mfma_f32_16x16x32_bf16 v[0:3], v[208:211], v[184:187], v[0:3]
  ds_read_b128 v[232:235], v240 offset:640
  v_mov_b32 v242, v156
  s_nop 1
  v_permlane16_swap_b32 v242, v156
  v_mfma_f32_16x16x32_bf16 v[32:35], v[208:211], v[192:195], v[32:35]
  ds_read_b128 v[236:239], v240 offset:704
  v_add_f32 v156, v156, v242
  v_mov_b32 v242, v156
  s_nop 1
  v_permlane32_swap_b32 v242, v156
  v_mfma_f32_16x16x32_bf16 v[64:67], v[208:211], v[200:203], v[64:67]
  ds_read_b128 v[208:211], v240 offset:0
  v_add_f32 v156, v156, v242
  v_rcp_f32 v156, v156
  v_mfma_f32_16x16x32_bf16 v[4:7], v[212:215], v[184:187], v[4:7]
  v_mov_b32 v242, v157
  s_nop 1
  v_permlane16_swap_b32 v242, v157
  v_add_f32 v157, v157, v242
  v_mov_b32 v242, v157
  v_mfma_f32_16x16x32_bf16 v[36:39], v[212:215], v[192:195], v[36:39]
  s_nop 0
  v_permlane32_swap_b32 v242, v157
  v_add_f32 v157, v157, v242
  v_rcp_f32 v157, v157
  v_mfma_f32_16x16x32_bf16 v[68:71], v[212:215], v[200:203], v[68:71]
  ds_read_b128 v[212:215], v240 offset:64
  v_mov_b32 v242, v158
  s_nop 1
  v_permlane16_swap_b32 v242, v158
  v_mfma_f32_16x16x32_bf16 v[8:11], v[216:219], v[184:187], v[8:11]
  v_add_f32 v158, v158, v242
  v_mov_b32 v242, v158
  s_nop 1
  v_permlane32_swap_b32 v242, v158
  v_add_f32 v158, v158, v242
  v_mfma_f32_16x16x32_bf16 v[40:43], v[216:219], v[192:195], v[40:43]
  v_rcp_f32 v158, v158
  v_max3_f32 v248, v160, v161, v162
  v_max3_f32 v248, v248, v163, v164
  v_max3_f32 v248, v248, v165, v166
  v_mfma_f32_16x16x32_bf16 v[72:75], v[216:219], v[200:203], v[72:75]
  ds_read_b128 v[216:219], v240 offset:128
  v_max_f32 v248, v248, v167
  v_mov_b32 v249, v248
  s_nop 1
  v_permlane16_swap_b32 v249, v248
  v_mfma_f32_16x16x32_bf16 v[12:15], v[220:223], v[184:187], v[12:15]
  v_max_f32 v248, v248, v249
  v_mov_b32 v249, v248
  s_nop 1
  v_permlane32_swap_b32 v249, v248
  v_max_f32 v248, v248, v249
  v_mfma_f32_16x16x32_bf16 v[44:47], v[220:223], v[192:195], v[44:47]
  v_sub_f32 v144, 0, v248
  v_sub_f32 v145, 0, v248
  v_sub_f32 v146, 0, v248
  v_sub_f32 v147, 0, v248
  v_sub_f32 v160, v160, v248
  v_mfma_f32_16x16x32_bf16 v[76:79], v[220:223], v[200:203], v[76:79]
  ds_read_b128 v[220:223], v240 offset:192
  v_sub_f32 v161, v161, v248
  v_sub_f32 v162, v162, v248
  v_sub_f32 v163, v163, v248
  v_mfma_f32_16x16x32_bf16 v[16:19], v[224:227], v[184:187], v[16:19]
  v_sub_f32 v164, v164, v248
  v_sub_f32 v165, v165, v248
  v_sub_f32 v166, v166, v248
  v_sub_f32 v167, v167, v248
  v_max3_f32 v248, v168, v169, v170
  v_mfma_f32_16x16x32_bf16 v[48:51], v[224:227], v[192:195], v[48:51]
  v_max3_f32 v248, v248, v171, v172
  v_max3_f32 v248, v248, v173, v174
  v_max_f32 v248, v248, v175
  v_mov_b32 v249, v248
  v_mfma_f32_16x16x32_bf16 v[80:83], v[224:227], v[200:203], v[80:83]
  ds_read_b128 v[224:227], v240 offset:512
  v_permlane16_swap_b32 v249, v248
  v_max_f32 v248, v248, v249
  v_mfma_f32_16x16x32_bf16 v[20:23], v[228:231], v[184:187], v[20:23]
  v_mov_b32 v249, v248
  s_nop 1
  v_permlane32_swap_b32 v249, v248
  v_max_f32 v248, v248, v249
  v_sub_f32 v148, 0, v248
  v_mfma_f32_16x16x32_bf16 v[52:55], v[228:231], v[192:195], v[52:55]
  v_sub_f32 v149, 0, v248
  v_sub_f32 v150, 0, v248
  v_sub_f32 v151, 0, v248
  v_sub_f32 v168, v168, v248
  v_sub_f32 v169, v169, v248
  v_mfma_f32_16x16x32_bf16 v[84:87], v[228:231], v[200:203], v[84:87]
  ds_read_b128 v[228:231], v240 offset:576
  v_sub_f32 v170, v170, v248
  v_sub_f32 v171, v171, v248
  v_sub_f32 v172, v172, v248
  v_mfma_f32_16x16x32_bf16 v[24:27], v[244:247], v[184:187], v[24:27]
  v_sub_f32 v173, v173, v248
  v_sub_f32 v174, v174, v248
  v_sub_f32 v175, v175, v248
  v_max3_f32 v248, v176, v177, v178
  v_max3_f32 v248, v248, v179, v180
  v_mfma_f32_16x16x32_bf16 v[56:59], v[244:247], v[192:195], v[56:59]
  v_max3_f32 v248, v248, v181, v182
  v_max_f32 v248, v248, v183
  v_mov_b32 v249, v248
  s_nop 1
  v_permlane16_swap_b32 v249, v248
  v_mfma_f32_16x16x32_bf16 v[88:91], v[244:247], v[200:203], v[88:91]
  v_max_f32 v248, v248, v249
  v_mov_b32 v249, v248
  s_nop 1
  v_permlane32_swap_b32 v249, v248
  v_mfma_f32_16x16x32_bf16 v[28:31], v[252:255], v[184:187], v[28:31]
  v_max_f32 v248, v248, v249
  v_sub_f32 v152, 0, v248
  v_sub_f32 v153, 0, v248
  v_sub_f32 v154, 0, v248
  v_mfma_f32_16x16x32_bf16 v[60:63], v[252:255], v[192:195], v[60:63]
  v_sub_f32 v155, 0, v248
  v_sub_f32 v176, v176, v248
  v_sub_f32 v177, v177, v248
  v_sub_f32 v178, v178, v248
  v_sub_f32 v179, v179, v248
  v_mfma_f32_16x16x32_bf16 v[92:95], v[252:255], v[200:203], v[92:95]
  v_sub_f32 v180, v180, v248
  v_sub_f32 v181, v181, v248
  v_sub_f32 v182, v182, v248
  v_sub_f32 v183, v183, v248
  s_waitcnt lgkmcnt(0)
  s_cmp_eq_u32 s67, 0
  s_cbranch_scc1 L_def_160
  s_barrier
L_def_160:
  v_mov_b32 v248, v156
  v_pk_mul_f32 v[0:1], v[0:1], v[248:249] op_sel_hi:[1,0]
  v_pk_mul_f32 v[2:3], v[2:3], v[248:249] op_sel_hi:[1,0]
  v_pk_mul_f32 v[4:5], v[4:5], v[248:249] op_sel_hi:[1,0]
  v_pk_mul_f32 v[6:7], v[6:7], v[248:249] op_sel_hi:[1,0]
  v_cvt_pk_bf16_f32 v0, v0, v1
  v_cvt_pk_bf16_f32 v1, v2, v3
  v_cvt_pk_bf16_f32 v2, v4, v5
  v_cvt_pk_bf16_f32 v3, v6, v7
  ds_write_b128 v243, v[0:3] offset:0
  v_pk_mul_f32 v[8:9], v[8:9], v[248:249] op_sel_hi:[1,0]
  v_pk_mul_f32 v[10:11], v[10:11], v[248:249] op_sel_hi:[1,0]
  v_pk_mul_f32 v[12:13], v[12:13], v[248:249] op_sel_hi:[1,0]
  v_pk_mul_f32 v[14:15], v[14:15], v[248:249] op_sel_hi:[1,0]
  v_cvt_pk_bf16_f32 v8, v8, v9
  v_cvt_pk_bf16_f32 v9, v10, v11
  v_cvt_pk_bf16_f32 v10, v12, v13
  v_cvt_pk_bf16_f32 v11, v14, v15
  ds_write_b128 v243, v[8:11] offset:1024
  v_pk_mul_f32 v[16:17], v[16:17], v[248:249] op_sel_hi:[1,0]
  v_pk_mul_f32 v[18:19], v[18:19], v[248:249] op_sel_hi:[1,0]
  v_pk_mul_f32 v[20:21], v[20:21], v[248:249] op_sel_hi:[1,0]
  v_pk_mul_f32 v[22:23], v[22:23], v[248:249] op_sel_hi:[1,0]
  v_cvt_pk_bf16_f32 v16, v16, v17
  v_cvt_pk_bf16_f32 v17, v18, v19
  v_cvt_pk_bf16_f32 v18, v20, v21
  v_cvt_pk_bf16_f32 v19, v22, v23
  ds_write_b128 v243, v[16:19] offset:2048
  v_pk_mul_f32 v[24:25], v[24:25], v[248:249] op_sel_hi:[1,0]
  v_pk_mul_f32 v[26:27], v[26:27], v[248:249] op_sel_hi:[1,0]
  v_pk_mul_f32 v[28:29], v[28:29], v[248:249] op_sel_hi:[1,0]
  v_pk_mul_f32 v[30:31], v[30:31], v[248:249] op_sel_hi:[1,0]
  v_cvt_pk_bf16_f32 v24, v24, v25
  v_cvt_pk_bf16_f32 v25, v26, v27
  v_cvt_pk_bf16_f32 v26, v28, v29
  v_cvt_pk_bf16_f32 v27, v30, v31
  ds_write_b128 v243, v[24:27] offset:3072
  v_mov_b32 v248, v157
  v_pk_mul_f32 v[32:33], v[32:33], v[248:249] op_sel_hi:[1,0]
  v_pk_mul_f32 v[34:35], v[34:35], v[248:249] op_sel_hi:[1,0]
  v_pk_mul_f32 v[36:37], v[36:37], v[248:249] op_sel_hi:[1,0]
  v_pk_mul_f32 v[38:39], v[38:39], v[248:249] op_sel_hi:[1,0]
  v_cvt_pk_bf16_f32 v32, v32, v33
  v_cvt_pk_bf16_f32 v33, v34, v35
  v_cvt_pk_bf16_f32 v34, v36, v37
  v_cvt_pk_bf16_f32 v35, v38, v39
  ds_write_b128 v243, v[32:35] offset:8192
  v_pk_mul_f32 v[40:41], v[40:41], v[248:249] op_sel_hi:[1,0]
  v_pk_mul_f32 v[42:43], v[42:43], v[248:249] op_sel_hi:[1,0]
  v_pk_mul_f32 v[44:45], v[44:45], v[248:249] op_sel_hi:[1,0]
  v_pk_mul_f32 v[46:47], v[46:47], v[248:249] op_sel_hi:[1,0]
  v_cvt_pk_bf16_f32 v40, v40, v41
  v_cvt_pk_bf16_f32 v41, v42, v43
  v_cvt_pk_bf16_f32 v42, v44, v45
  v_cvt_pk_bf16_f32 v43, v46, v47
  ds_write_b128 v243, v[40:43] offset:9216
  v_pk_mul_f32 v[48:49], v[48:49], v[248:249] op_sel_hi:[1,0]
  v_pk_mul_f32 v[50:51], v[50:51], v[248:249] op_sel_hi:[1,0]
  v_pk_mul_f32 v[52:53], v[52:53], v[248:249] op_sel_hi:[1,0]
  v_pk_mul_f32 v[54:55], v[54:55], v[248:249] op_sel_hi:[1,0]
  v_cvt_pk_bf16_f32 v48, v48, v49
  v_cvt_pk_bf16_f32 v49, v50, v51
  v_cvt_pk_bf16_f32 v50, v52, v53
  v_cvt_pk_bf16_f32 v51, v54, v55
  ds_write_b128 v243, v[48:51] offset:10240
  v_pk_mul_f32 v[56:57], v[56:57], v[248:249] op_sel_hi:[1,0]
  v_pk_mul_f32 v[58:59], v[58:59], v[248:249] op_sel_hi:[1,0]
  v_pk_mul_f32 v[60:61], v[60:61], v[248:249] op_sel_hi:[1,0]
  v_pk_mul_f32 v[62:63], v[62:63], v[248:249] op_sel_hi:[1,0]
  v_cvt_pk_bf16_f32 v56, v56, v57
  v_cvt_pk_bf16_f32 v57, v58, v59
  v_cvt_pk_bf16_f32 v58, v60, v61
  v_cvt_pk_bf16_f32 v59, v62, v63
  ds_write_b128 v243, v[56:59] offset:11264
  v_mov_b32 v248, v158
  v_pk_mul_f32 v[64:65], v[64:65], v[248:249] op_sel_hi:[1,0]
  v_pk_mul_f32 v[66:67], v[66:67], v[248:249] op_sel_hi:[1,0]
  v_pk_mul_f32 v[68:69], v[68:69], v[248:249] op_sel_hi:[1,0]
  v_pk_mul_f32 v[70:71], v[70:71], v[248:249] op_sel_hi:[1,0]
  v_cvt_pk_bf16_f32 v64, v64, v65
  v_cvt_pk_bf16_f32 v65, v66, v67
  v_cvt_pk_bf16_f32 v66, v68, v69
  v_cvt_pk_bf16_f32 v67, v70, v71
  ds_write_b128 v243, v[64:67] offset:16384
  v_pk_mul_f32 v[72:73], v[72:73], v[248:249] op_sel_hi:[1,0]
  v_pk_mul_f32 v[74:75], v[74:75], v[248:249] op_sel_hi:[1,0]
  v_pk_mul_f32 v[76:77], v[76:77], v[248:249] op_sel_hi:[1,0]
  v_pk_mul_f32 v[78:79], v[78:79], v[248:249] op_sel_hi:[1,0]
  v_cvt_pk_bf16_f32 v72, v72, v73
  v_cvt_pk_bf16_f32 v73, v74, v75
  v_cvt_pk_bf16_f32 v74, v76, v77
  v_cvt_pk_bf16_f32 v75, v78, v79
  ds_write_b128 v243, v[72:75] offset:17408
  v_pk_mul_f32 v[80:81], v[80:81], v[248:249] op_sel_hi:[1,0]
  v_pk_mul_f32 v[82:83], v[82:83], v[248:249] op_sel_hi:[1,0]
  v_pk_mul_f32 v[84:85], v[84:85], v[248:249] op_sel_hi:[1,0]
  v_pk_mul_f32 v[86:87], v[86:87], v[248:249] op_sel_hi:[1,0]
  v_cvt_pk_bf16_f32 v80, v80, v81
  v_cvt_pk_bf16_f32 v81, v82, v83
  v_cvt_pk_bf16_f32 v82, v84, v85
  v_cvt_pk_bf16_f32 v83, v86, v87
  ds_write_b128 v243, v[80:83] offset:18432
  v_pk_mul_f32 v[88:89], v[88:89], v[248:249] op_sel_hi:[1,0]
  v_pk_mul_f32 v[90:91], v[90:91], v[248:249] op_sel_hi:[1,0]
  v_pk_mul_f32 v[92:93], v[92:93], v[248:249] op_sel_hi:[1,0]
  v_pk_mul_f32 v[94:95], v[94:95], v[248:249] op_sel_hi:[1,0]
  v_cvt_pk_bf16_f32 v88, v88, v89
  v_cvt_pk_bf16_f32 v89, v90, v91
  v_cvt_pk_bf16_f32 v90, v92, v93
  v_cvt_pk_bf16_f32 v91, v94, v95
  ds_write_b128 v243, v[88:91] offset:19456
  v_mov_b32 v156, 0
  v_mov_b32 v157, 0
  v_mov_b32 v158, 0
  v_exp_f32 v160, v160
  v_exp_f32 v161, v161
  v_add_f32 v156, v156, v160
  v_exp_f32 v162, v162
  v_add_f32 v156, v156, v161
  v_exp_f32 v163, v163
  v_cvt_pk_bf16_f32 v160, v160, v161
  v_exp_f32 v164, v164
  v_add_f32 v156, v156, v162
  v_exp_f32 v165, v165
  v_add_f32 v156, v156, v163
  v_exp_f32 v166, v166
  v_cvt_pk_bf16_f32 v161, v162, v163
  v_add_f32 v156, v156, v164
  v_exp_f32 v167, v167
  v_add_f32 v156, v156, v165
  v_cvt_pk_bf16_f32 v162, v164, v165
  v_add_f32 v156, v156, v166
  v_add_f32 v156, v156, v167
  v_cvt_pk_bf16_f32 v163, v166, v167
  v_exp_f32 v168, v168
  v_exp_f32 v169, v169
  v_add_f32 v157, v157, v168
  v_exp_f32 v170, v170
  v_add_f32 v157, v157, v169
  s_waitcnt lgkmcnt(0)
  v_mov_b64 v[0:1], 0
  v_mov_b64 v[2:3], 0
  v_mov_b64 v[4:5], 0
  v_mov_b64 v[6:7], 0
  v_mov_b64 v[8:9], 0
  v_mov_b64 v[10:11], 0
  v_mov_b64 v[12:13], 0
  v_mov_b64 v[14:15], 0
  v_mov_b64 v[16:17], 0
  v_mov_b64 v[18:19], 0
  v_mov_b64 v[20:21], 0
  v_mov_b64 v[22:23], 0
  v_mov_b64 v[24:25], 0
  v_mov_b64 v[26:27], 0
  v_mov_b64 v[28:29], 0
  v_mov_b64 v[30:31], 0
  v_mov_b64 v[32:33], 0
  v_mov_b64 v[34:35], 0
  v_mov_b64 v[36:37], 0
  v_mov_b64 v[38:39], 0
  v_mov_b64 v[40:41], 0
  v_mov_b64 v[42:43], 0
  v_mov_b64 v[44:45], 0
  v_mov_b64 v[46:47], 0
  v_mov_b64 v[48:49], 0
  v_mov_b64 v[50:51], 0
  v_mov_b64 v[52:53], 0
  v_mov_b64 v[54:55], 0
  v_mov_b64 v[56:57], 0
  v_mov_b64 v[58:59], 0
  v_mov_b64 v[60:61], 0
  v_mov_b64 v[62:63], 0
  v_mov_b64 v[64:65], 0
  v_mov_b64 v[66:67], 0
  v_mov_b64 v[68:69], 0
  v_mov_b64 v[70:71], 0
  v_mov_b64 v[72:73], 0
  v_mov_b64 v[74:75], 0
  v_mov_b64 v[76:77], 0
  v_mov_b64 v[78:79], 0
  v_mov_b64 v[80:81], 0
  v_mov_b64 v[82:83], 0
  v_mov_b64 v[84:85], 0
  v_mov_b64 v[86:87], 0
  v_mov_b64 v[88:89], 0
  v_mov_b64 v[90:91], 0
  v_mov_b64 v[92:93], 0
  v_mov_b64 v[94:95], 0
  v_add_u32 v241, s57, v241
  s_sub_u32 s57, 0, s57
  v_add_u32 v240, s58, v240
  s_sub_u32 s58, 0, s58
  s_mov_b32 s41, 15
  s_cmp_eq_u32 s67, 1
  s_cbranch_scc1 L_M_in
  s_branch L_M
L_rare_146:
  s_waitcnt lgkmcnt(0)
  v_mfma_f32_16x16x32_bf16 v[8:11], v[216:219], v[160:163], v[8:11]
  v_mfma_f32_16x16x32_bf16 v[40:43], v[216:219], v[168:171], v[40:43]
  v_mfma_f32_16x16x32_bf16 v[72:75], v[216:219], v[176:179], v[72:75]
  ds_read_b128 v[216:219], v240 offset:128
  v_mfma_f32_16x16x32_bf16 v[12:15], v[220:223], v[160:163], v[12:15]
  v_mfma_f32_16x16x32_bf16 v[44:47], v[220:223], v[168:171], v[44:47]
  v_mfma_f32_16x16x32_bf16 v[76:79], v[220:223], v[176:179], v[76:79]
  ds_read_b128 v[220:223], v240 offset:192
  v_mfma_f32_16x16x32_bf16 v[16:19], v[224:227], v[160:163], v[16:19]
  v_mfma_f32_16x16x32_bf16 v[48:51], v[224:227], v[168:171], v[48:51]
  v_mfma_f32_16x16x32_bf16 v[80:83], v[224:227], v[176:179], v[80:83]
  ds_read_b128 v[224:227], v240 offset:512
  v_mfma_f32_16x16x32_bf16 v[20:23], v[228:231], v[160:163], v[20:23]
  v_mfma_f32_16x16x32_bf16 v[52:55], v[228:231], v[168:171], v[52:55]
  v_mfma_f32_16x16x32_bf16 v[84:87], v[228:231], v[176:179], v[84:87]
  ds_read_b128 v[228:231], v240 offset:576
  v_mfma_f32_16x16x32_bf16 v[24:27], v[244:247], v[160:163], v[24:27]
  v_mfma_f32_16x16x32_bf16 v[56:59], v[244:247], v[168:171], v[56:59]
  v_mfma_f32_16x16x32_bf16 v[88:91], v[244:247], v[176:179], v[88:91]
  v_mfma_f32_16x16x32_bf16 v[28:31], v[252:255], v[160:163], v[28:31]
  v_mfma_f32_16x16x32_bf16 v[60:63], v[252:255], v[168:171], v[60:63]
  v_mfma_f32_16x16x32_bf16 v[92:95], v[252:255], v[176:179], v[92:95]
  s_nop 7
  v_max3_f32 v248, v184, v185, v186
  v_max3_f32 v248, v248, v187, v188
  v_max3_f32 v248, v248, v189, v190
  v_max_f32 v248, v248, v191
  v_mov_b32 v249, v248
  s_nop 1
  v_permlane16_swap_b32 v249, v248
  v_max_f32 v248, v248, v249
  v_mov_b32 v249, v248
  s_nop 1
  v_permlane32_swap_b32 v249, v248
  v_max_f32 v248, v248, v249
  v_max_f32 v248, 0, v248
  v_sub_f32 v144, v144, v248
  v_sub_f32 v145, v145, v248
  v_sub_f32 v146, v146, v248
  v_sub_f32 v147, v147, v248
  v_sub_f32 v184, v184, v248
  v_sub_f32 v185, v185, v248
  v_sub_f32 v186, v186, v248
  v_sub_f32 v187, v187, v248
  v_sub_f32 v188, v188, v248
  v_sub_f32 v189, v189, v248
  v_sub_f32 v190, v190, v248
  v_sub_f32 v191, v191, v248
  v_sub_f32 v248, 0, v248
  v_exp_f32 v248, v248
  s_nop 0
  v_mul_f32 v156, v156, v248
  v_pk_mul_f32 v[0:1], v[0:1], v[248:249] op_sel_hi:[1,0]
  v_pk_mul_f32 v[2:3], v[2:3], v[248:249] op_sel_hi:[1,0]
  v_pk_mul_f32 v[4:5], v[4:5], v[248:249] op_sel_hi:[1,0]
  v_pk_mul_f32 v[6:7], v[6:7], v[248:249] op_sel_hi:[1,0]
  v_pk_mul_f32 v[8:9], v[8:9], v[248:249] op_sel_hi:[1,0]
  v_pk_mul_f32 v[10:11], v[10:11], v[248:249] op_sel_hi:[1,0]
  v_pk_mul_f32 v[12:13], v[12:13], v[248:249] op_sel_hi:[1,0]
  v_pk_mul_f32 v[14:15], v[14:15], v[248:249] op_sel_hi:[1,0]
  v_pk_mul_f32 v[16:17], v[16:17], v[248:249] op_sel_hi:[1,0]
  v_pk_mul_f32 v[18:19], v[18:19], v[248:249] op_sel_hi:[1,0]
  v_pk_mul_f32 v[20:21], v[20:21], v[248:249] op_sel_hi:[1,0]
  v_pk_mul_f32 v[22:23], v[22:23], v[248:249] op_sel_hi:[1,0]
  v_pk_mul_f32 v[24:25], v[24:25], v[248:249] op_sel_hi:[1,0]
  v_pk_mul_f32 v[26:27], v[26:27], v[248:249] op_sel_hi:[1,0]
  v_pk_mul_f32 v[28:29], v[28:29], v[248:249] op_sel_hi:[1,0]
  v_pk_mul_f32 v[30:31], v[30:31], v[248:249] op_sel_hi:[1,0]
  v_max3_f32 v248, v192, v193, v194
  v_max3_f32 v248, v248, v195, v196
  v_max3_f32 v248, v248, v197, v198
  v_max_f32 v248, v248, v199
  v_mov_b32 v249, v248
  s_nop 1
  v_permlane16_swap_b32 v249, v248
  v_max_f32 v248, v248, v249
  v_mov_b32 v249, v248
  s_nop 1
  v_permlane32_swap_b32 v249, v248
  v_max_f32 v248, v248, v249
  v_max_f32 v248, 0, v248
  v_sub_f32 v148, v148, v248
  v_sub_f32 v149, v149, v248
  v_sub_f32 v150, v150, v248
  v_sub_f32 v151, v151, v248
  v_sub_f32 v192, v192, v248
  v_sub_f32 v193, v193, v248
  v_sub_f32 v194, v194, v248
  v_sub_f32 v195, v195, v248
  v_sub_f32 v196, v196, v248
  v_sub_f32 v197, v197, v248
  v_sub_f32 v198, v198, v248
  v_sub_f32 v199, v199, v248
  v_sub_f32 v248, 0, v248
  v_exp_f32 v248, v248
  s_nop 0
  v_mul_f32 v157, v157, v248
  v_pk_mul_f32 v[32:33], v[32:33], v[248:249] op_sel_hi:[1,0]
  v_pk_mul_f32 v[34:35], v[34:35], v[248:249] op_sel_hi:[1,0]
  v_pk_mul_f32 v[36:37], v[36:37], v[248:249] op_sel_hi:[1,0]
  v_pk_mul_f32 v[38:39], v[38:39], v[248:249] op_sel_hi:[1,0]
  v_pk_mul_f32 v[40:41], v[40:41], v[248:249] op_sel_hi:[1,0]
  v_pk_mul_f32 v[42:43], v[42:43], v[248:249] op_sel_hi:[1,0]
  v_pk_mul_f32 v[44:45], v[44:45], v[248:249] op_sel_hi:[1,0]
  v_pk_mul_f32 v[46:47], v[46:47], v[248:249] op_sel_hi:[1,0]
  v_pk_mul_f32 v[48:49], v[48:49], v[248:249] op_sel_hi:[1,0]
  v_pk_mul_f32 v[50:51], v[50:51], v[248:249] op_sel_hi:[1,0]
  v_pk_mul_f32 v[52:53], v[52:53], v[248:249] op_sel_hi:[1,0]
  v_pk_mul_f32 v[54:55], v[54:55], v[248:249] op_sel_hi:[1,0]
  v_pk_mul_f32 v[56:57], v[56:57], v[248:249] op_sel_hi:[1,0]
  v_pk_mul_f32 v[58:59], v[58:59], v[248:249] op_sel_hi:[1,0]
  v_pk_mul_f32 v[60:61], v[60:61], v[248:249] op_sel_hi:[1,0]
  v_pk_mul_f32 v[62:63], v[62:63], v[248:249] op_sel_hi:[1,0]
  v_max3_f32 v248, v200, v201, v202
  v_max3_f32 v248, v248, v203, v204
  v_max3_f32 v248, v248, v205, v206
  v_max_f32 v248, v248, v207
  v_mov_b32 v249, v248
  s_nop 1
  v_permlane16_swap_b32 v249, v248
  v_max_f32 v248, v248, v249
  v_mov_b32 v249, v248
  s_nop 1
  v_permlane32_swap_b32 v249, v248
  v_max_f32 v248, v248, v249
  v_max_f32 v248, 0, v248
  v_sub_f32 v152, v152, v248
  v_sub_f32 v153, v153, v248
  v_sub_f32 v154, v154, v248
  v_sub_f32 v155, v155, v248
  v_sub_f32 v200, v200, v248
  v_sub_f32 v201, v201, v248
  v_sub_f32 v202, v202, v248
  v_sub_f32 v203, v203, v248
  v_sub_f32 v204, v204, v248
  v_sub_f32 v205, v205, v248
  v_sub_f32 v206, v206, v248
  v_sub_f32 v207, v207, v248
  v_sub_f32 v248, 0, v248
  v_exp_f32 v248, v248
  s_nop 0
  v_mul_f32 v158, v158, v248
  v_pk_mul_f32 v[64:65], v[64:65], v[248:249] op_sel_hi:[1,0]
  v_pk_mul_f32 v[66:67], v[66:67], v[248:249] op_sel_hi:[1,0]
  v_pk_mul_f32 v[68:69], v[68:69], v[248:249] op_sel_hi:[1,0]
  v_pk_mul_f32 v[70:71], v[70:71], v[248:249] op_sel_hi:[1,0]
  v_pk_mul_f32 v[72:73], v[72:73], v[248:249] op_sel_hi:[1,0]
  v_pk_mul_f32 v[74:75], v[74:75], v[248:249] op_sel_hi:[1,0]
  v_pk_mul_f32 v[76:77], v[76:77], v[248:249] op_sel_hi:[1,0]
  v_pk_mul_f32 v[78:79], v[78:79], v[248:249] op_sel_hi:[1,0]
  v_pk_mul_f32 v[80:81], v[80:81], v[248:249] op_sel_hi:[1,0]
  v_pk_mul_f32 v[82:83], v[82:83], v[248:249] op_sel_hi:[1,0]
  v_pk_mul_f32 v[84:85], v[84:85], v[248:249] op_sel_hi:[1,0]
  v_pk_mul_f32 v[86:87], v[86:87], v[248:249] op_sel_hi:[1,0]
  v_pk_mul_f32 v[88:89], v[88:89], v[248:249] op_sel_hi:[1,0]
  v_pk_mul_f32 v[90:91], v[90:91], v[248:249] op_sel_hi:[1,0]
  v_pk_mul_f32 v[92:93], v[92:93], v[248:249] op_sel_hi:[1,0]
  v_pk_mul_f32 v[94:95], v[94:95], v[248:249] op_sel_hi:[1,0]
  s_add_u32 s40, s40, 1
  s_cmp_eq_u32 s40, 4
  s_cselect_b32 s57, s56, s43
  s_cselect_b32 s40, 0, s40
  v_add_u32 v241, s57, v241
  v_exp_f32 v184, v184
  v_exp_f32 v185, v185
  v_add_f32 v156, v156, v184
  v_exp_f32 v186, v186
  v_add_f32 v156, v156, v185
  v_exp_f32 v187, v187
  v_cvt_pk_bf16_f32 v184, v184, v185
  v_exp_f32 v188, v188
  v_add_f32 v156, v156, v186
  v_exp_f32 v189, v189
  v_add_f32 v156, v156, v187
  v_exp_f32 v190, v190
  v_cvt_pk_bf16_f32 v185, v186, v187
  v_add_f32 v156, v156, v188
  v_exp_f32 v191, v191
  v_add_f32 v156, v156, v189
  v_cvt_pk_bf16_f32 v186, v188, v189
  v_add_f32 v156, v156, v190
  v_add_f32 v156, v156, v191
  v_cvt_pk_bf16_f32 v187, v190, v191
  v_exp_f32 v192, v192
  v_exp_f32 v193, v193
  v_add_f32 v157, v157, v192
  v_exp_f32 v194, v194
  v_add_f32 v157, v157, v193
  s_nop 1
  s_branch L_rareb_147
L_rare_148:
  s_waitcnt lgkmcnt(0)
  v_mfma_f32_16x16x32_bf16 v[8:11], v[216:219], v[184:187], v[8:11]
  v_mfma_f32_16x16x32_bf16 v[40:43], v[216:219], v[192:195], v[40:43]
  v_mfma_f32_16x16x32_bf16 v[72:75], v[216:219], v[200:203], v[72:75]
  ds_read_b128 v[216:219], v240 offset:128
  v_mfma_f32_16x16x32_bf16 v[12:15], v[220:223], v[184:187], v[12:15]
  v_mfma_f32_16x16x32_bf16 v[44:47], v[220:223], v[192:195], v[44:47]
  v_mfma_f32_16x16x32_bf16 v[76:79], v[220:223], v[200:203], v[76:79]
  ds_read_b128 v[220:223], v240 offset:192
  v_mfma_f32_16x16x32_bf16 v[16:19], v[224:227], v[184:187], v[16:19]
  v_mfma_f32_16x16x32_bf16 v[48:51], v[224:227], v[192:195], v[48:51]
  v_mfma_f32_16x16x32_bf16 v[80:83], v[224:227], v[200:203], v[80:83]
  ds_read_b128 v[224:227], v240 offset:512
  v_mfma_f32_16x16x32_bf16 v[20:23], v[228:231], v[184:187], v[20:23]
  v_mfma_f32_16x16x32_bf16 v[52:55], v[228:231], v[192:195], v[52:55]
  v_mfma_f32_16x16x32_bf16 v[84:87], v[228:231], v[200:203], v[84:87]
  ds_read_b128 v[228:231], v240 offset:576
  v_mfma_f32_16x16x32_bf16 v[24:27], v[244:247], v[184:187], v[24:27]
  v_mfma_f32_16x16x32_bf16 v[56:59], v[244:247], v[192:195], v[56:59]
  v_mfma_f32_16x16x32_bf16 v[88:91], v[244:247], v[200:203], v[88:91]
  v_mfma_f32_16x16x32_bf16 v[28:31], v[252:255], v[184:187], v[28:31]
  v_mfma_f32_16x16x32_bf16 v[60:63], v[252:255], v[192:195], v[60:63]
  v_mfma_f32_16x16x32_bf16 v[92:95], v[252:255], v[200:203], v[92:95]
  s_nop 7
  v_max3_f32 v248, v160, v161, v162
  v_max3_f32 v248, v248, v163, v164
  v_max3_f32 v248, v248, v165, v166
  v_max_f32 v248, v248, v167
  v_mov_b32 v249, v248
  s_nop 1
  v_permlane16_swap_b32 v249, v248
  v_max_f32 v248, v248, v249
  v_mov_b32 v249, v248
  s_nop 1
  v_permlane32_swap_b32 v249, v248
  v_max_f32 v248, v248, v249
  v_max_f32 v248, 0, v248
  v_sub_f32 v144, v144, v248
  v_sub_f32 v145, v145, v248
  v_sub_f32 v146, v146, v248
  v_sub_f32 v147, v147, v248
  v_sub_f32 v160, v160, v248
  v_sub_f32 v161, v161, v248
  v_sub_f32 v162, v162, v248
  v_sub_f32 v163, v163, v248
  v_sub_f32 v164, v164, v248
  v_sub_f32 v165, v165, v248
  v_sub_f32 v166, v166, v248
  v_sub_f32 v167, v167, v248
  v_sub_f32 v248, 0, v248
  v_exp_f32 v248, v248
  s_nop 0
  v_mul_f32 v156, v156, v248
  v_pk_mul_f32 v[0:1], v[0:1], v[248:249] op_sel_hi:[1,0]
  v_pk_mul_f32 v[2:3], v[2:3], v[248:249] op_sel_hi:[1,0]
  v_pk_mul_f32 v[4:5], v[4:5], v[248:249] op_sel_hi:[1,0]
  v_pk_mul_f32 v[6:7], v[6:7], v[248:249] op_sel_hi:[1,0]
  v_pk_mul_f32 v[8:9], v[8:9], v[248:249] op_sel_hi:[1,0]
  v_pk_mul_f32 v[10:11], v[10:11], v[248:249] op_sel_hi:[1,0]
  v_pk_mul_f32 v[12:13], v[12:13], v[248:249] op_sel_hi:[1,0]
  v_pk_mul_f32 v[14:15], v[14:15], v[248:249] op_sel_hi:[1,0]
  v_pk_mul_f32 v[16:17], v[16:17], v[248:249] op_sel_hi:[1,0]
  v_pk_mul_f32 v[18:19], v[18:19], v[248:249] op_sel_hi:[1,0]
  v_pk_mul_f32 v[20:21], v[20:21], v[248:249] op_sel_hi:[1,0]
  v_pk_mul_f32 v[22:23], v[22:23], v[248:249] op_sel_hi:[1,0]
  v_pk_mul_f32 v[24:25], v[24:25], v[248:249] op_sel_hi:[1,0]
  v_pk_mul_f32 v[26:27], v[26:27], v[248:249] op_sel_hi:[1,0]
  v_pk_mul_f32 v[28:29], v[28:29], v[248:249] op_sel_hi:[1,0]
  v_pk_mul_f32 v[30:31], v[30:31], v[248:249] op_sel_hi:[1,0]
  v_max3_f32 v248, v168, v169, v170
  v_max3_f32 v248, v248, v171, v172
  v_max3_f32 v248, v248, v173, v174
  v_max_f32 v248, v248, v175
  v_mov_b32 v249, v248
  s_nop 1
  v_permlane16_swap_b32 v249, v248
  v_max_f32 v248, v248, v249
  v_mov_b32 v249, v248
  s_nop 1
  v_permlane32_swap_b32 v249, v248
  v_max_f32 v248, v248, v249
  v_max_f32 v248, 0, v248
  v_sub_f32 v148, v148, v248
  v_sub_f32 v149, v149, v248
  v_sub_f32 v150, v150, v248
  v_sub_f32 v151, v151, v248
  v_sub_f32 v168, v168, v248
  v_sub_f32 v169, v169, v248
  v_sub_f32 v170, v170, v248
  v_sub_f32 v171, v171, v248
  v_sub_f32 v172, v172, v248
  v_sub_f32 v173, v173, v248
  v_sub_f32 v174, v174, v248
  v_sub_f32 v175, v175, v248
  v_sub_f32 v248, 0, v248
  v_exp_f32 v248, v248
  s_nop 0
  v_mul_f32 v157, v157, v248
  v_pk_mul_f32 v[32:33], v[32:33], v[248:249] op_sel_hi:[1,0]
  v_pk_mul_f32 v[34:35], v[34:35], v[248:249] op_sel_hi:[1,0]
  v_pk_mul_f32 v[36:37], v[36:37], v[248:249] op_sel_hi:[1,0]
  v_pk_mul_f32 v[38:39], v[38:39], v[248:249] op_sel_hi:[1,0]
  v_pk_mul_f32 v[40:41], v[40:41], v[248:249] op_sel_hi:[1,0]
  v_pk_mul_f32 v[42:43], v[42:43], v[248:249] op_sel_hi:[1,0]
  v_pk_mul_f32 v[44:45], v[44:45], v[248:249] op_sel_hi:[1,0]
  v_pk_mul_f32 v[46:47], v[46:47], v[248:249] op_sel_hi:[1,0]
  v_pk_mul_f32 v[48:49], v[48:49], v[248:249] op_sel_hi:[1,0]
  v_pk_mul_f32 v[50:51], v[50:51], v[248:249] op_sel_hi:[1,0]
  v_pk_mul_f32 v[52:53], v[52:53], v[248:249] op_sel_hi:[1,0]
  v_pk_mul_f32 v[54:55], v[54:55], v[248:249] op_sel_hi:[1,0]
  v_pk_mul_f32 v[56:57], v[56:57], v[248:249] op_sel_hi:[1,0]
  v_pk_mul_f32 v[58:59], v[58:59], v[248:249] op_sel_hi:[1,0]
  v_pk_mul_f32 v[60:61], v[60:61], v[248:249] op_sel_hi:[1,0]
  v_pk_mul_f32 v[62:63], v[62:63], v[248:249] op_sel_hi:[1,0]
  v_max3_f32 v248, v176, v177, v178
  v_max3_f32 v248, v248, v179, v180
  v_max3_f32 v248, v248, v181, v182
  v_max_f32 v248, v248, v183
  v_mov_b32 v249, v248
  s_nop 1
  v_permlane16_swap_b32 v249, v248
  v_max_f32 v248, v248, v249
  v_mov_b32 v249, v248
  s_nop 1
  v_permlane32_swap_b32 v249, v248
  v_max_f32 v248, v248, v249
  v_max_f32 v248, 0, v248
  v_sub_f32 v152, v152, v248
  v_sub_f32 v153, v153, v248
  v_sub_f32 v154, v154, v248
  v_sub_f32 v155, v155, v248
  v_sub_f32 v176, v176, v248
  v_sub_f32 v177, v177, v248
  v_sub_f32 v178, v178, v248
  v_sub_f32 v179, v179, v248
  v_sub_f32 v180, v180, v248
  v_sub_f32 v181, v181, v248
  v_sub_f32 v182, v182, v248
  v_sub_f32 v183, v183, v248
  v_sub_f32 v248, 0, v248
  v_exp_f32 v248, v248
  s_nop 0
  v_mul_f32 v158, v158, v248
  v_pk_mul_f32 v[64:65], v[64:65], v[248:249] op_sel_hi:[1,0]
  v_pk_mul_f32 v[66:67], v[66:67], v[248:249] op_sel_hi:[1,0]
  v_pk_mul_f32 v[68:69], v[68:69], v[248:249] op_sel_hi:[1,0]
  v_pk_mul_f32 v[70:71], v[70:71], v[248:249] op_sel_hi:[1,0]
  v_pk_mul_f32 v[72:73], v[72:73], v[248:249] op_sel_hi:[1,0]
  v_pk_mul_f32 v[74:75], v[74:75], v[248:249] op_sel_hi:[1,0]
  v_pk_mul_f32 v[76:77], v[76:77], v[248:249] op_sel_hi:[1,0]
  v_pk_mul_f32 v[78:79], v[78:79], v[248:249] op_sel_hi:[1,0]
  v_pk_mul_f32 v[80:81], v[80:81], v[248:249] op_sel_hi:[1,0]
  v_pk_mul_f32 v[82:83], v[82:83], v[248:249] op_sel_hi:[1,0]
  v_pk_mul_f32 v[84:85], v[84:85], v[248:249] op_sel_hi:[1,0]
  v_pk_mul_f32 v[86:87], v[86:87], v[248:249] op_sel_hi:[1,0]
  v_pk_mul_f32 v[88:89], v[88:89], v[248:249] op_sel_hi:[1,0]
  v_pk_mul_f32 v[90:91], v[90:91], v[248:249] op_sel_hi:[1,0]
  v_pk_mul_f32 v[92:93], v[92:93], v[248:249] op_sel_hi:[1,0]
  v_pk_mul_f32 v[94:95], v[94:95], v[248:249] op_sel_hi:[1,0]
  s_add_u32 s40, s40, 1
  s_cmp_eq_u32 s40, 4
  s_cselect_b32 s57, s56, s43
  s_cselect_b32 s40, 0, s40
  v_add_u32 v241, s57, v241
  v_exp_f32 v160, v160
  v_exp_f32 v161, v161
  v_add_f32 v156, v156, v160
  v_exp_f32 v162, v162
  v_add_f32 v156, v156, v161
  v_exp_f32 v163, v163
  v_cvt_pk_bf16_f32 v160, v160, v161
  v_exp_f32 v164, v164
  v_add_f32 v156, v156, v162
  v_exp_f32 v165, v165
  v_add_f32 v156, v156, v163
  v_exp_f32 v166, v166
  v_cvt_pk_bf16_f32 v161, v162, v163
  v_add_f32 v156, v156, v164
  v_exp_f32 v167, v167
  v_add_f32 v156, v156, v165
  v_cvt_pk_bf16_f32 v162, v164, v165
  v_add_f32 v156, v156, v166
  v_add_f32 v156, v156, v167
  v_cvt_pk_bf16_f32 v163, v166, v167
  v_exp_f32 v168, v168
  v_exp_f32 v169, v169
  v_add_f32 v157, v157, v168
  v_exp_f32 v170, v170
  v_add_f32 v157, v157, v169
  s_nop 1
  s_branch L_rareb_149
L_rare_150:
  s_waitcnt lgkmcnt(0)
  v_mfma_f32_16x16x32_bf16 v[8:11], v[216:219], v[160:163], v[8:11]
  v_mfma_f32_16x16x32_bf16 v[40:43], v[216:219], v[168:171], v[40:43]
  v_mfma_f32_16x16x32_bf16 v[72:75], v[216:219], v[176:179], v[72:75]
  ds_read_b128 v[216:219], v240 offset:128
  v_mfma_f32_16x16x32_bf16 v[12:15], v[220:223], v[160:163], v[12:15]
  v_mfma_f32_16x16x32_bf16 v[44:47], v[220:223], v[168:171], v[44:47]
  v_mfma_f32_16x16x32_bf16 v[76:79], v[220:223], v[176:179], v[76:79]
  ds_read_b128 v[220:223], v240 offset:192
  v_mfma_f32_16x16x32_bf16 v[16:19], v[224:227], v[160:163], v[16:19]
  v_mfma_f32_16x16x32_bf16 v[48:51], v[224:227], v[168:171], v[48:51]
  v_mfma_f32_16x16x32_bf16 v[80:83], v[224:227], v[176:179], v[80:83]
  ds_read_b128 v[224:227], v240 offset:512
  v_mfma_f32_16x16x32_bf16 v[20:23], v[228:231], v[160:163], v[20:23]
  v_mfma_f32_16x16x32_bf16 v[52:55], v[228:231], v[168:171], v[52:55]
  v_mfma_f32_16x16x32_bf16 v[84:87], v[228:231], v[176:179], v[84:87]
  ds_read_b128 v[228:231], v240 offset:576
  v_mfma_f32_16x16x32_bf16 v[24:27], v[244:247], v[160:163], v[24:27]
  v_mfma_f32_16x16x32_bf16 v[56:59], v[244:247], v[168:171], v[56:59]
  v_mfma_f32_16x16x32_bf16 v[88:91], v[244:247], v[176:179], v[88:91]
  v_mfma_f32_16x16x32_bf16 v[28:31], v[252:255], v[160:163], v[28:31]
  v_mfma_f32_16x16x32_bf16 v[60:63], v[252:255], v[168:171], v[60:63]
  v_mfma_f32_16x16x32_bf16 v[92:95], v[252:255], v[176:179], v[92:95]
  s_nop 7
  v_max3_f32 v248, v184, v185, v186
  v_max3_f32 v248, v248, v187, v188
  v_max3_f32 v248, v248, v189, v190
  v_max_f32 v248, v248, v191
  v_mov_b32 v249, v248
  s_nop 1
  v_permlane16_swap_b32 v249, v248
  v_max_f32 v248, v248, v249
  v_mov_b32 v249, v248
  s_nop 1
  v_permlane32_swap_b32 v249, v248
  v_max_f32 v248, v248, v249
  v_max_f32 v248, 0, v248
  v_sub_f32 v144, v144, v248
  v_sub_f32 v145, v145, v248
  v_sub_f32 v146, v146, v248
  v_sub_f32 v147, v147, v248
  v_sub_f32 v184, v184, v248
  v_sub_f32 v185, v185, v248
  v_sub_f32 v186, v186, v248
  v_sub_f32 v187, v187, v248
  v_sub_f32 v188, v188, v248
  v_sub_f32 v189, v189, v248
  v_sub_f32 v190, v190, v248
  v_sub_f32 v191, v191, v248
  v_sub_f32 v248, 0, v248
  v_exp_f32 v248, v248
  s_nop 0
  v_mul_f32 v156, v156, v248
  v_pk_mul_f32 v[0:1], v[0:1], v[248:249] op_sel_hi:[1,0]
  v_pk_mul_f32 v[2:3], v[2:3], v[248:249] op_sel_hi:[1,0]
  v_pk_mul_f32 v[4:5], v[4:5], v[248:249] op_sel_hi:[1,0]
  v_pk_mul_f32 v[6:7], v[6:7], v[248:249] op_sel_hi:[1,0]
  v_pk_mul_f32 v[8:9], v[8:9], v[248:249] op_sel_hi:[1,0]
  v_pk_mul_f32 v[10:11], v[10:11], v[248:249] op_sel_hi:[1,0]
  v_pk_mul_f32 v[12:13], v[12:13], v[248:249] op_sel_hi:[1,0]
  v_pk_mul_f32 v[14:15], v[14:15], v[248:249] op_sel_hi:[1,0]
  v_pk_mul_f32 v[16:17], v[16:17], v[248:249] op_sel_hi:[1,0]
  v_pk_mul_f32 v[18:19], v[18:19], v[248:249] op_sel_hi:[1,0]
  v_pk_mul_f32 v[20:21], v[20:21], v[248:249] op_sel_hi:[1,0]
  v_pk_mul_f32 v[22:23], v[22:23], v[248:249] op_sel_hi:[1,0]
  v_pk_mul_f32 v[24:25], v[24:25], v[248:249] op_sel_hi:[1,0]
  v_pk_mul_f32 v[26:27], v[26:27], v[248:249] op_sel_hi:[1,0]
  v_pk_mul_f32 v[28:29], v[28:29], v[248:249] op_sel_hi:[1,0]
  v_pk_mul_f32 v[30:31], v[30:31], v[248:249] op_sel_hi:[1,0]
  v_max3_f32 v248, v192, v193, v194
  v_max3_f32 v248, v248, v195, v196
  v_max3_f32 v248, v248, v197, v198
  v_max_f32 v248, v248, v199
  v_mov_b32 v249, v248
  s_nop 1
  v_permlane16_swap_b32 v249, v248
  v_max_f32 v248, v248, v249
  v_mov_b32 v249, v248
  s_nop 1
  v_permlane32_swap_b32 v249, v248
  v_max_f32 v248, v248, v249
  v_max_f32 v248, 0, v248
  v_sub_f32 v148, v148, v248
  v_sub_f32 v149, v149, v248
  v_sub_f32 v150, v150, v248
  v_sub_f32 v151, v151, v248
  v_sub_f32 v192, v192, v248
  v_sub_f32 v193, v193, v248
  v_sub_f32 v194, v194, v248
  v_sub_f32 v195, v195, v248
  v_sub_f32 v196, v196, v248
  v_sub_f32 v197, v197, v248
  v_sub_f32 v198, v198, v248
  v_sub_f32 v199, v199, v248
  v_sub_f32 v248, 0, v248
  v_exp_f32 v248, v248
  s_nop 0
  v_mul_f32 v157, v157, v248
  v_pk_mul_f32 v[32:33], v[32:33], v[248:249] op_sel_hi:[1,0]
  v_pk_mul_f32 v[34:35], v[34:35], v[248:249] op_sel_hi:[1,0]
  v_pk_mul_f32 v[36:37], v[36:37], v[248:249] op_sel_hi:[1,0]
  v_pk_mul_f32 v[38:39], v[38:39], v[248:249] op_sel_hi:[1,0]
  v_pk_mul_f32 v[40:41], v[40:41], v[248:249] op_sel_hi:[1,0]
  v_pk_mul_f32 v[42:43], v[42:43], v[248:249] op_sel_hi:[1,0]
  v_pk_mul_f32 v[44:45], v[44:45], v[248:249] op_sel_hi:[1,0]
  v_pk_mul_f32 v[46:47], v[46:47], v[248:249] op_sel_hi:[1,0]
  v_pk_mul_f32 v[48:49], v[48:49], v[248:249] op_sel_hi:[1,0]
  v_pk_mul_f32 v[50:51], v[50:51], v[248:249] op_sel_hi:[1,0]
  v_pk_mul_f32 v[52:53], v[52:53], v[248:249] op_sel_hi:[1,0]
  v_pk_mul_f32 v[54:55], v[54:55], v[248:249] op_sel_hi:[1,0]
  v_pk_mul_f32 v[56:57], v[56:57], v[248:249] op_sel_hi:[1,0]
  v_pk_mul_f32 v[58:59], v[58:59], v[248:249] op_sel_hi:[1,0]
  v_pk_mul_f32 v[60:61], v[60:61], v[248:249] op_sel_hi:[1,0]
  v_pk_mul_f32 v[62:63], v[62:63], v[248:249] op_sel_hi:[1,0]
  v_max3_f32 v248, v200, v201, v202
  v_max3_f32 v248, v248, v203, v204
  v_max3_f32 v248, v248, v205, v206
  v_max_f32 v248, v248, v207
  v_mov_b32 v249, v248
  s_nop 1
  v_permlane16_swap_b32 v249, v248
  v_max_f32 v248, v248, v249
  v_mov_b32 v249, v248
  s_nop 1
  v_permlane32_swap_b32 v249, v248
  v_max_f32 v248, v248, v249
  v_max_f32 v248, 0, v248
  v_sub_f32 v152, v152, v248
  v_sub_f32 v153, v153, v248
  v_sub_f32 v154, v154, v248
  v_sub_f32 v155, v155, v248
  v_sub_f32 v200, v200, v248
  v_sub_f32 v201, v201, v248
  v_sub_f32 v202, v202, v248
  v_sub_f32 v203, v203, v248
  v_sub_f32 v204, v204, v248
  v_sub_f32 v205, v205, v248
  v_sub_f32 v206, v206, v248
  v_sub_f32 v207, v207, v248
  v_sub_f32 v248, 0, v248
  v_exp_f32 v248, v248
  s_nop 0
  v_mul_f32 v158, v158, v248
  v_pk_mul_f32 v[64:65], v[64:65], v[248:249] op_sel_hi:[1,0]
  v_pk_mul_f32 v[66:67], v[66:67], v[248:249] op_sel_hi:[1,0]
  v_pk_mul_f32 v[68:69], v[68:69], v[248:249] op_sel_hi:[1,0]
  v_pk_mul_f32 v[70:71], v[70:71], v[248:249] op_sel_hi:[1,0]
  v_pk_mul_f32 v[72:73], v[72:73], v[248:249] op_sel_hi:[1,0]
  v_pk_mul_f32 v[74:75], v[74:75], v[248:249] op_sel_hi:[1,0]
  v_pk_mul_f32 v[76:77], v[76:77], v[248:249] op_sel_hi:[1,0]
  v_pk_mul_f32 v[78:79], v[78:79], v[248:249] op_sel_hi:[1,0]
  v_pk_mul_f32 v[80:81], v[80:81], v[248:249] op_sel_hi:[1,0]
  v_pk_mul_f32 v[82:83], v[82:83], v[248:249] op_sel_hi:[1,0]
  v_pk_mul_f32 v[84:85], v[84:85], v[248:249] op_sel_hi:[1,0]
  v_pk_mul_f32 v[86:87], v[86:87], v[248:249] op_sel_hi:[1,0]
  v_pk_mul_f32 v[88:89], v[88:89], v[248:249] op_sel_hi:[1,0]
  v_pk_mul_f32 v[90:91], v[90:91], v[248:249] op_sel_hi:[1,0]
  v_pk_mul_f32 v[92:93], v[92:93], v[248:249] op_sel_hi:[1,0]
  v_pk_mul_f32 v[94:95], v[94:95], v[248:249] op_sel_hi:[1,0]
  s_add_u32 s40, s40, 1
  s_cmp_eq_u32 s40, 4
  s_cselect_b32 s57, s56, s43
  s_cselect_b32 s40, 0, s40
  v_add_u32 v241, s57, v241
  v_exp_f32 v184, v184
  v_exp_f32 v185, v185
  v_add_f32 v156, v156, v184
  v_exp_f32 v186, v186
  v_add_f32 v156, v156, v185
  v_exp_f32 v187, v187
  v_cvt_pk_bf16_f32 v184, v184, v185
  v_exp_f32 v188, v188
  v_add_f32 v156, v156, v186
  v_exp_f32 v189, v189
  v_add_f32 v156, v156, v187
  v_exp_f32 v190, v190
  v_cvt_pk_bf16_f32 v185, v186, v187
  v_add_f32 v156, v156, v188
  v_exp_f32 v191, v191
  v_add_f32 v156, v156, v189
  v_cvt_pk_bf16_f32 v186, v188, v189
  v_add_f32 v156, v156, v190
  v_add_f32 v156, v156, v191
  v_cvt_pk_bf16_f32 v187, v190, v191
  v_exp_f32 v192, v192
  v_exp_f32 v193, v193
  v_add_f32 v157, v157, v192
  v_exp_f32 v194, v194
  v_add_f32 v157, v157, v193
  s_nop 1
  s_branch L_rareb_151
L_rare_154:
  s_waitcnt lgkmcnt(0)
  v_mfma_f32_16x16x32_bf16 v[8:11], v[216:219], v[160:163], v[8:11]
  v_mfma_f32_16x16x32_bf16 v[40:43], v[216:219], v[168:171], v[40:43]
  v_mfma_f32_16x16x32_bf16 v[72:75], v[216:219], v[176:179], v[72:75]
  ds_read_b128 v[216:219], v240 offset:128
  v_mfma_f32_16x16x32_bf16 v[12:15], v[220:223], v[160:163], v[12:15]
  v_mfma_f32_16x16x32_bf16 v[44:47], v[220:223], v[168:171], v[44:47]
  v_mfma_f32_16x16x32_bf16 v[76:79], v[220:223], v[176:179], v[76:79]
  ds_read_b128 v[220:223], v240 offset:192
  v_mfma_f32_16x16x32_bf16 v[16:19], v[224:227], v[160:163], v[16:19]
  v_mfma_f32_16x16x32_bf16 v[48:51], v[224:227], v[168:171], v[48:51]
  v_mfma_f32_16x16x32_bf16 v[80:83], v[224:227], v[176:179], v[80:83]
  ds_read_b128 v[224:227], v240 offset:512
  v_mfma_f32_16x16x32_bf16 v[20:23], v[228:231], v[160:163], v[20:23]
  v_mfma_f32_16x16x32_bf16 v[52:55], v[228:231], v[168:171], v[52:55]
  v_mfma_f32_16x16x32_bf16 v[84:87], v[228:231], v[176:179], v[84:87]
  ds_read_b128 v[228:231], v240 offset:576
  v_mfma_f32_16x16x32_bf16 v[24:27], v[244:247], v[160:163], v[24:27]
  v_mfma_f32_16x16x32_bf16 v[56:59], v[244:247], v[168:171], v[56:59]
  v_mfma_f32_16x16x32_bf16 v[88:91], v[244:247], v[176:179], v[88:91]
  v_mfma_f32_16x16x32_bf16 v[28:31], v[252:255], v[160:163], v[28:31]
  v_mfma_f32_16x16x32_bf16 v[60:63], v[252:255], v[168:171], v[60:63]
  v_mfma_f32_16x16x32_bf16 v[92:95], v[252:255], v[176:179], v[92:95]
  s_nop 7
  v_max3_f32 v248, v184, v185, v186
  v_max3_f32 v248, v248, v187, v188
  v_max3_f32 v248, v248, v189, v190
  v_max_f32 v248, v248, v191
  v_mov_b32 v249, v248
  s_nop 1
  v_permlane16_swap_b32 v249, v248
  v_max_f32 v248, v248, v249
  v_mov_b32 v249, v248
  s_nop 1
  v_permlane32_swap_b32 v249, v248
  v_max_f32 v248, v248, v249
  v_max_f32 v248, 0, v248
  v_sub_f32 v144, v144, v248
  v_sub_f32 v145, v145, v248
  v_sub_f32 v146, v146, v248
  v_sub_f32 v147, v147, v248
  v_sub_f32 v184, v184, v248
  v_sub_f32 v185, v185, v248
  v_sub_f32 v186, v186, v248
  v_sub_f32 v187, v187, v248
  v_sub_f32 v188, v188, v248
  v_sub_f32 v189, v189, v248
  v_sub_f32 v190, v190, v248
  v_sub_f32 v191, v191, v248
  v_sub_f32 v248, 0, v248
  v_exp_f32 v248, v248
  s_nop 0
  v_mul_f32 v156, v156, v248
  v_pk_mul_f32 v[0:1], v[0:1], v[248:249] op_sel_hi:[1,0]
  v_pk_mul_f32 v[2:3], v[2:3], v[248:249] op_sel_hi:[1,0]
  v_pk_mul_f32 v[4:5], v[4:5], v[248:249] op_sel_hi:[1,0]
  v_pk_mul_f32 v[6:7], v[6:7], v[248:249] op_sel_hi:[1,0]
  v_pk_mul_f32 v[8:9], v[8:9], v[248:249] op_sel_hi:[1,0]
  v_pk_mul_f32 v[10:11], v[10:11], v[248:249] op_sel_hi:[1,0]
  v_pk_mul_f32 v[12:13], v[12:13], v[248:249] op_sel_hi:[1,0]
  v_pk_mul_f32 v[14:15], v[14:15], v[248:249] op_sel_hi:[1,0]
  v_pk_mul_f32 v[16:17], v[16:17], v[248:249] op_sel_hi:[1,0]
  v_pk_mul_f32 v[18:19], v[18:19], v[248:249] op_sel_hi:[1,0]
  v_pk_mul_f32 v[20:21], v[20:21], v[248:249] op_sel_hi:[1,0]
  v_pk_mul_f32 v[22:23], v[22:23], v[248:249] op_sel_hi:[1,0]
  v_pk_mul_f32 v[24:25], v[24:25], v[248:249] op_sel_hi:[1,0]
  v_pk_mul_f32 v[26:27], v[26:27], v[248:249] op_sel_hi:[1,0]
  v_pk_mul_f32 v[28:29], v[28:29], v[248:249] op_sel_hi:[1,0]
  v_pk_mul_f32 v[30:31], v[30:31], v[248:249] op_sel_hi:[1,0]
  v_max3_f32 v248, v192, v193, v194
  v_max3_f32 v248, v248, v195, v196
  v_max3_f32 v248, v248, v197, v198
  v_max_f32 v248, v248, v199
  v_mov_b32 v249, v248
  s_nop 1
  v_permlane16_swap_b32 v249, v248
  v_max_f32 v248, v248, v249
  v_mov_b32 v249, v248
  s_nop 1
  v_permlane32_swap_b32 v249, v248
  v_max_f32 v248, v248, v249
  v_max_f32 v248, 0, v248
  v_sub_f32 v148, v148, v248
  v_sub_f32 v149, v149, v248
  v_sub_f32 v150, v150, v248
  v_sub_f32 v151, v151, v248
  v_sub_f32 v192, v192, v248
  v_sub_f32 v193, v193, v248
  v_sub_f32 v194, v194, v248
  v_sub_f32 v195, v195, v248
  v_sub_f32 v196, v196, v248
  v_sub_f32 v197, v197, v248
  v_sub_f32 v198, v198, v248
  v_sub_f32 v199, v199, v248
  v_sub_f32 v248, 0, v248
  v_exp_f32 v248, v248
  s_nop 0
  v_mul_f32 v157, v157, v248
  v_pk_mul_f32 v[32:33], v[32:33], v[248:249] op_sel_hi:[1,0]
  v_pk_mul_f32 v[34:35], v[34:35], v[248:249] op_sel_hi:[1,0]
  v_pk_mul_f32 v[36:37], v[36:37], v[248:249] op_sel_hi:[1,0]
  v_pk_mul_f32 v[38:39], v[38:39], v[248:249] op_sel_hi:[1,0]
  v_pk_mul_f32 v[40:41], v[40:41], v[248:249] op_sel_hi:[1,0]
  v_pk_mul_f32 v[42:43], v[42:43], v[248:249] op_sel_hi:[1,0]
  v_pk_mul_f32 v[44:45], v[44:45], v[248:249] op_sel_hi:[1,0]
  v_pk_mul_f32 v[46:47], v[46:47], v[248:249] op_sel_hi:[1,0]
  v_pk_mul_f32 v[48:49], v[48:49], v[248:249] op_sel_hi:[1,0]
  v_pk_mul_f32 v[50:51], v[50:51], v[248:249] op_sel_hi:[1,0]
  v_pk_mul_f32 v[52:53], v[52:53], v[248:249] op_sel_hi:[1,0]
  v_pk_mul_f32 v[54:55], v[54:55], v[248:249] op_sel_hi:[1,0]
  v_pk_mul_f32 v[56:57], v[56:57], v[248:249] op_sel_hi:[1,0]
  v_pk_mul_f32 v[58:59], v[58:59], v[248:249] op_sel_hi:[1,0]
  v_pk_mul_f32 v[60:61], v[60:61], v[248:249] op_sel_hi:[1,0]
  v_pk_mul_f32 v[62:63], v[62:63], v[248:249] op_sel_hi:[1,0]
  v_max3_f32 v248, v200, v201, v202
  v_max3_f32 v248, v248, v203, v204
  v_max3_f32 v248, v248, v205, v206
  v_max_f32 v248, v248, v207
  v_mov_b32 v249, v248
  s_nop 1
  v_permlane16_swap_b32 v249, v248
  v_max_f32 v248, v248, v249
  v_mov_b32 v249, v248
  s_nop 1
  v_permlane32_swap_b32 v249, v248
  v_max_f32 v248, v248, v249
  v_max_f32 v248, 0, v248
  v_sub_f32 v152, v152, v248
  v_sub_f32 v153, v153, v248
  v_sub_f32 v154, v154, v248
  v_sub_f32 v155, v155, v248
  v_sub_f32 v200, v200, v248
  v_sub_f32 v201, v201, v248
  v_sub_f32 v202, v202, v248
  v_sub_f32 v203, v203, v248
  v_sub_f32 v204, v204, v248
  v_sub_f32 v205, v205, v248
  v_sub_f32 v206, v206, v248
  v_sub_f32 v207, v207, v248
  v_sub_f32 v248, 0, v248
  v_exp_f32 v248, v248
  s_nop 0
  v_mul_f32 v158, v158, v248
  v_pk_mul_f32 v[64:65], v[64:65], v[248:249] op_sel_hi:[1,0]
  v_pk_mul_f32 v[66:67], v[66:67], v[248:249] op_sel_hi:[1,0]
  v_pk_mul_f32 v[68:69], v[68:69], v[248:249] op_sel_hi:[1,0]
  v_pk_mul_f32 v[70:71], v[70:71], v[248:249] op_sel_hi:[1,0]
  v_pk_mul_f32 v[72:73], v[72:73], v[248:249] op_sel_hi:[1,0]
  v_pk_mul_f32 v[74:75], v[74:75], v[248:249] op_sel_hi:[1,0]
  v_pk_mul_f32 v[76:77], v[76:77], v[248:249] op_sel_hi:[1,0]
  v_pk_mul_f32 v[78:79], v[78:79], v[248:249] op_sel_hi:[1,0]
  v_pk_mul_f32 v[80:81], v[80:81], v[248:249] op_sel_hi:[1,0]
  v_pk_mul_f32 v[82:83], v[82:83], v[248:249] op_sel_hi:[1,0]
  v_pk_mul_f32 v[84:85], v[84:85], v[248:249] op_sel_hi:[1,0]
  v_pk_mul_f32 v[86:87], v[86:87], v[248:249] op_sel_hi:[1,0]
  v_pk_mul_f32 v[88:89], v[88:89], v[248:249] op_sel_hi:[1,0]
  v_pk_mul_f32 v[90:91], v[90:91], v[248:249] op_sel_hi:[1,0]
  v_pk_mul_f32 v[92:93], v[92:93], v[248:249] op_sel_hi:[1,0]
  v_pk_mul_f32 v[94:95], v[94:95], v[248:249] op_sel_hi:[1,0]
  v_add_u32 v241, s57, v241
  s_sub_u32 s57, 0, s57
  v_exp_f32 v184, v184
  v_exp_f32 v185, v185
  v_add_f32 v156, v156, v184
  v_exp_f32 v186, v186
  v_add_f32 v156, v156, v185
  v_exp_f32 v187, v187
  v_cvt_pk_bf16_f32 v184, v184, v185
  v_exp_f32 v188, v188
  v_add_f32 v156, v156, v186
  v_exp_f32 v189, v189
  v_add_f32 v156, v156, v187
  v_exp_f32 v190, v190
  v_cvt_pk_bf16_f32 v185, v186, v187
  v_add_f32 v156, v156, v188
  v_exp_f32 v191, v191
  v_add_f32 v156, v156, v189
  v_cvt_pk_bf16_f32 v186, v188, v189
  v_add_f32 v156, v156, v190
  v_add_f32 v156, v156, v191
  v_cvt_pk_bf16_f32 v187, v190, v191
  v_exp_f32 v192, v192
  v_exp_f32 v193, v193
  v_add_f32 v157, v157, v192
  v_exp_f32 v194, v194
  v_add_f32 v157, v157, v193
  s_nop 1
  s_branch L_rareb_155
L_rare_156:
  s_waitcnt lgkmcnt(0)
  v_mfma_f32_16x16x32_bf16 v[8:11], v[216:219], v[184:187], v[8:11]
  v_mfma_f32_16x16x32_bf16 v[40:43], v[216:219], v[192:195], v[40:43]
  v_mfma_f32_16x16x32_bf16 v[72:75], v[216:219], v[200:203], v[72:75]
  ds_read_b128 v[216:219], v240 offset:128
  v_mfma_f32_16x16x32_bf16 v[12:15], v[220:223], v[184:187], v[12:15]
  v_mfma_f32_16x16x32_bf16 v[44:47], v[220:223], v[192:195], v[44:47]
  v_mfma_f32_16x16x32_bf16 v[76:79], v[220:223], v[200:203], v[76:79]
  ds_read_b128 v[220:223], v240 offset:192
  v_mfma_f32_16x16x32_bf16 v[16:19], v[224:227], v[184:187], v[16:19]
  v_mfma_f32_16x16x32_bf16 v[48:51], v[224:227], v[192:195], v[48:51]
  v_mfma_f32_16x16x32_bf16 v[80:83], v[224:227], v[200:203], v[80:83]
  ds_read_b128 v[224:227], v240 offset:512
  v_mfma_f32_16x16x32_bf16 v[20:23], v[228:231], v[184:187], v[20:23]
  v_mfma_f32_16x16x32_bf16 v[52:55], v[228:231], v[192:195], v[52:55]
  v_mfma_f32_16x16x32_bf16 v[84:87], v[228:231], v[200:203], v[84:87]
  ds_read_b128 v[228:231], v240 offset:576
  v_mfma_f32_16x16x32_bf16 v[24:27], v[244:247], v[184:187], v[24:27]
  v_mfma_f32_16x16x32_bf16 v[56:59], v[244:247], v[192:195], v[56:59]
  v_mfma_f32_16x16x32_bf16 v[88:91], v[244:247], v[200:203], v[88:91]
  v_mfma_f32_16x16x32_bf16 v[28:31], v[252:255], v[184:187], v[28:31]
  v_mfma_f32_16x16x32_bf16 v[60:63], v[252:255], v[192:195], v[60:63]
  v_mfma_f32_16x16x32_bf16 v[92:95], v[252:255], v[200:203], v[92:95]
  s_nop 7
  v_max3_f32 v248, v160, v161, v162
  v_max3_f32 v248, v248, v163, v164
  v_max3_f32 v248, v248, v165, v166
  v_max_f32 v248, v248, v167
  v_mov_b32 v249, v248
  s_nop 1
  v_permlane16_swap_b32 v249, v248
  v_max_f32 v248, v248, v249
  v_mov_b32 v249, v248
  s_nop 1
  v_permlane32_swap_b32 v249, v248
  v_max_f32 v248, v248, v249
  v_max_f32 v248, 0, v248
  v_sub_f32 v144, v144, v248
  v_sub_f32 v145, v145, v248
  v_sub_f32 v146, v146, v248
  v_sub_f32 v147, v147, v248
  v_sub_f32 v160, v160, v248
  v_sub_f32 v161, v161, v248
  v_sub_f32 v162, v162, v248
  v_sub_f32 v163, v163, v248
  v_sub_f32 v164, v164, v248
  v_sub_f32 v165, v165, v248
  v_sub_f32 v166, v166, v248
  v_sub_f32 v167, v167, v248
  v_sub_f32 v248, 0, v248
  v_exp_f32 v248, v248
  s_nop 0
  v_mul_f32 v156, v156, v248
  v_pk_mul_f32 v[0:1], v[0:1], v[248:249] op_sel_hi:[1,0]
  v_pk_mul_f32 v[2:3], v[2:3], v[248:249] op_sel_hi:[1,0]
  v_pk_mul_f32 v[4:5], v[4:5], v[248:249] op_sel_hi:[1,0]
  v_pk_mul_f32 v[6:7], v[6:7], v[248:249] op_sel_hi:[1,0]
  v_pk_mul_f32 v[8:9], v[8:9], v[248:249] op_sel_hi:[1,0]
  v_pk_mul_f32 v[10:11], v[10:11], v[248:249] op_sel_hi:[1,0]
  v_pk_mul_f32 v[12:13], v[12:13], v[248:249] op_sel_hi:[1,0]
  v_pk_mul_f32 v[14:15], v[14:15], v[248:249] op_sel_hi:[1,0]
  v_pk_mul_f32 v[16:17], v[16:17], v[248:249] op_sel_hi:[1,0]
  v_pk_mul_f32 v[18:19], v[18:19], v[248:249] op_sel_hi:[1,0]
  v_pk_mul_f32 v[20:21], v[20:21], v[248:249] op_sel_hi:[1,0]
  v_pk_mul_f32 v[22:23], v[22:23], v[248:249] op_sel_hi:[1,0]
  v_pk_mul_f32 v[24:25], v[24:25], v[248:249] op_sel_hi:[1,0]
  v_pk_mul_f32 v[26:27], v[26:27], v[248:249] op_sel_hi:[1,0]
  v_pk_mul_f32 v[28:29], v[28:29], v[248:249] op_sel_hi:[1,0]
  v_pk_mul_f32 v[30:31], v[30:31], v[248:249] op_sel_hi:[1,0]
  v_max3_f32 v248, v168, v169, v170
  v_max3_f32 v248, v248, v171, v172
  v_max3_f32 v248, v248, v173, v174
  v_max_f32 v248, v248, v175
  v_mov_b32 v249, v248
  s_nop 1
  v_permlane16_swap_b32 v249, v248
  v_max_f32 v248, v248, v249
  v_mov_b32 v249, v248
  s_nop 1
  v_permlane32_swap_b32 v249, v248
  v_max_f32 v248, v248, v249
  v_max_f32 v248, 0, v248
  v_sub_f32 v148, v148, v248
  v_sub_f32 v149, v149, v248
  v_sub_f32 v150, v150, v248
  v_sub_f32 v151, v151, v248
  v_sub_f32 v168, v168, v248
  v_sub_f32 v169, v169, v248
  v_sub_f32 v170, v170, v248
  v_sub_f32 v171, v171, v248
  v_sub_f32 v172, v172, v248
  v_sub_f32 v173, v173, v248
  v_sub_f32 v174, v174, v248
  v_sub_f32 v175, v175, v248
  v_sub_f32 v248, 0, v248
  v_exp_f32 v248, v248
  s_nop 0
  v_mul_f32 v157, v157, v248
  v_pk_mul_f32 v[32:33], v[32:33], v[248:249] op_sel_hi:[1,0]
  v_pk_mul_f32 v[34:35], v[34:35], v[248:249] op_sel_hi:[1,0]
  v_pk_mul_f32 v[36:37], v[36:37], v[248:249] op_sel_hi:[1,0]
  v_pk_mul_f32 v[38:39], v[38:39], v[248:249] op_sel_hi:[1,0]
  v_pk_mul_f32 v[40:41], v[40:41], v[248:249] op_sel_hi:[1,0]
  v_pk_mul_f32 v[42:43], v[42:43], v[248:249] op_sel_hi:[1,0]
  v_pk_mul_f32 v[44:45], v[44:45], v[248:249] op_sel_hi:[1,0]
  v_pk_mul_f32 v[46:47], v[46:47], v[248:249] op_sel_hi:[1,0]
  v_pk_mul_f32 v[48:49], v[48:49], v[248:249] op_sel_hi:[1,0]
  v_pk_mul_f32 v[50:51], v[50:51], v[248:249] op_sel_hi:[1,0]
  v_pk_mul_f32 v[52:53], v[52:53], v[248:249] op_sel_hi:[1,0]
  v_pk_mul_f32 v[54:55], v[54:55], v[248:249] op_sel_hi:[1,0]
  v_pk_mul_f32 v[56:57], v[56:57], v[248:249] op_sel_hi:[1,0]
  v_pk_mul_f32 v[58:59], v[58:59], v[248:249] op_sel_hi:[1,0]
  v_pk_mul_f32 v[60:61], v[60:61], v[248:249] op_sel_hi:[1,0]
  v_pk_mul_f32 v[62:63], v[62:63], v[248:249] op_sel_hi:[1,0]
  v_max3_f32 v248, v176, v177, v178
  v_max3_f32 v248, v248, v179, v180
  v_max3_f32 v248, v248, v181, v182
  v_max_f32 v248, v248, v183
  v_mov_b32 v249, v248
  s_nop 1
  v_permlane16_swap_b32 v249, v248
  v_max_f32 v248, v248, v249
  v_mov_b32 v249, v248
  s_nop 1
  v_permlane32_swap_b32 v249, v248
  v_max_f32 v248, v248, v249
  v_max_f32 v248, 0, v248
  v_sub_f32 v152, v152, v248
  v_sub_f32 v153, v153, v248
  v_sub_f32 v154, v154, v248
  v_sub_f32 v155, v155, v248
  v_sub_f32 v176, v176, v248
  v_sub_f32 v177, v177, v248
  v_sub_f32 v178, v178, v248
  v_sub_f32 v179, v179, v248
  v_sub_f32 v180, v180, v248
  v_sub_f32 v181, v181, v248
  v_sub_f32 v182, v182, v248
  v_sub_f32 v183, v183, v248
  v_sub_f32 v248, 0, v248
  v_exp_f32 v248, v248
  s_nop 0
  v_mul_f32 v158, v158, v248
  v_pk_mul_f32 v[64:65], v[64:65], v[248:249] op_sel_hi:[1,0]
  v_pk_mul_f32 v[66:67], v[66:67], v[248:249] op_sel_hi:[1,0]
  v_pk_mul_f32 v[68:69], v[68:69], v[248:249] op_sel_hi:[1,0]
  v_pk_mul_f32 v[70:71], v[70:71], v[248:249] op_sel_hi:[1,0]
  v_pk_mul_f32 v[72:73], v[72:73], v[248:249] op_sel_hi:[1,0]
  v_pk_mul_f32 v[74:75], v[74:75], v[248:249] op_sel_hi:[1,0]
  v_pk_mul_f32 v[76:77], v[76:77], v[248:249] op_sel_hi:[1,0]
  v_pk_mul_f32 v[78:79], v[78:79], v[248:249] op_sel_hi:[1,0]
  v_pk_mul_f32 v[80:81], v[80:81], v[248:249] op_sel_hi:[1,0]
  v_pk_mul_f32 v[82:83], v[82:83], v[248:249] op_sel_hi:[1,0]
  v_pk_mul_f32 v[84:85], v[84:85], v[248:249] op_sel_hi:[1,0]
  v_pk_mul_f32 v[86:87], v[86:87], v[248:249] op_sel_hi:[1,0]
  v_pk_mul_f32 v[88:89], v[88:89], v[248:249] op_sel_hi:[1,0]
  v_pk_mul_f32 v[90:91], v[90:91], v[248:249] op_sel_hi:[1,0]
  v_pk_mul_f32 v[92:93], v[92:93], v[248:249] op_sel_hi:[1,0]
  v_pk_mul_f32 v[94:95], v[94:95], v[248:249] op_sel_hi:[1,0]
  v_add_u32 v241, s57, v241
  s_sub_u32 s57, 0, s57
  v_exp_f32 v160, v160
  v_exp_f32 v161, v161
  v_add_f32 v156, v156, v160
  v_exp_f32 v162, v162
  v_add_f32 v156, v156, v161
  v_exp_f32 v163, v163
  v_cvt_pk_bf16_f32 v160, v160, v161
  v_exp_f32 v164, v164
  v_add_f32 v156, v156, v162
  v_exp_f32 v165, v165
  v_add_f32 v156, v156, v163
  v_exp_f32 v166, v166
  v_cvt_pk_bf16_f32 v161, v162, v163
  v_add_f32 v156, v156, v164
  v_exp_f32 v167, v167
  v_add_f32 v156, v156, v165
  v_cvt_pk_bf16_f32 v162, v164, v165
  v_add_f32 v156, v156, v166
  v_add_f32 v156, v156, v167
  v_cvt_pk_bf16_f32 v163, v166, v167
  v_exp_f32 v168, v168
  v_exp_f32 v169, v169
  v_add_f32 v157, v157, v168
  v_exp_f32 v170, v170
  v_add_f32 v157, v157, v169
  s_nop 1
  s_branch L_rareb_157
L_rare_158:
  s_waitcnt lgkmcnt(0)
  v_mfma_f32_16x16x32_bf16 v[8:11], v[216:219], v[160:163], v[8:11]
  v_mfma_f32_16x16x32_bf16 v[40:43], v[216:219], v[168:171], v[40:43]
  v_mfma_f32_16x16x32_bf16 v[72:75], v[216:219], v[176:179], v[72:75]
  ds_read_b128 v[216:219], v240 offset:128
  v_mfma_f32_16x16x32_bf16 v[12:15], v[220:223], v[160:163], v[12:15]
  v_mfma_f32_16x16x32_bf16 v[44:47], v[220:223], v[168:171], v[44:47]
  v_mfma_f32_16x16x32_bf16 v[76:79], v[220:223], v[176:179], v[76:79]
  ds_read_b128 v[220:223], v240 offset:192
  v_mfma_f32_16x16x32_bf16 v[16:19], v[224:227], v[160:163], v[16:19]
  v_mfma_f32_16x16x32_bf16 v[48:51], v[224:227], v[168:171], v[48:51]
  v_mfma_f32_16x16x32_bf16 v[80:83], v[224:227], v[176:179], v[80:83]
  ds_read_b128 v[224:227], v240 offset:512
  v_mfma_f32_16x16x32_bf16 v[20:23], v[228:231], v[160:163], v[20:23]
  v_mfma_f32_16x16x32_bf16 v[52:55], v[228:231], v[168:171], v[52:55]
  v_mfma_f32_16x16x32_bf16 v[84:87], v[228:231], v[176:179], v[84:87]
  ds_read_b128 v[228:231], v240 offset:576
  v_mfma_f32_16x16x32_bf16 v[24:27], v[244:247], v[160:163], v[24:27]
  v_mfma_f32_16x16x32_bf16 v[56:59], v[244:247], v[168:171], v[56:59]
  v_mfma_f32_16x16x32_bf16 v[88:91], v[244:247], v[176:179], v[88:91]
  v_mfma_f32_16x16x32_bf16 v[28:31], v[252:255], v[160:163], v[28:31]
  v_mfma_f32_16x16x32_bf16 v[60:63], v[252:255], v[168:171], v[60:63]
  v_mfma_f32_16x16x32_bf16 v[92:95], v[252:255], v[176:179], v[92:95]
  s_nop 7
  v_max3_f32 v248, v184, v185, v186
  v_max3_f32 v248, v248, v187, v188
  v_max3_f32 v248, v248, v189, v190
  v_max_f32 v248, v248, v191
  v_mov_b32 v249, v248
  s_nop 1
  v_permlane16_swap_b32 v249, v248
  v_max_f32 v248, v248, v249
  v_mov_b32 v249, v248
  s_nop 1
  v_permlane32_swap_b32 v249, v248
  v_max_f32 v248, v248, v249
  v_max_f32 v248, 0, v248
  v_sub_f32 v144, v144, v248
  v_sub_f32 v145, v145, v248
  v_sub_f32 v146, v146, v248
  v_sub_f32 v147, v147, v248
  v_sub_f32 v184, v184, v248
  v_sub_f32 v185, v185, v248
  v_sub_f32 v186, v186, v248
  v_sub_f32 v187, v187, v248
  v_sub_f32 v188, v188, v248
  v_sub_f32 v189, v189, v248
  v_sub_f32 v190, v190, v248
  v_sub_f32 v191, v191, v248
  v_sub_f32 v248, 0, v248
  v_exp_f32 v248, v248
  s_nop 0
  v_mul_f32 v156, v156, v248
  v_pk_mul_f32 v[0:1], v[0:1], v[248:249] op_sel_hi:[1,0]
  v_pk_mul_f32 v[2:3], v[2:3], v[248:249] op_sel_hi:[1,0]
  v_pk_mul_f32 v[4:5], v[4:5], v[248:249] op_sel_hi:[1,0]
  v_pk_mul_f32 v[6:7], v[6:7], v[248:249] op_sel_hi:[1,0]
  v_pk_mul_f32 v[8:9], v[8:9], v[248:249] op_sel_hi:[1,0]
  v_pk_mul_f32 v[10:11], v[10:11], v[248:249] op_sel_hi:[1,0]
  v_pk_mul_f32 v[12:13], v[12:13], v[248:249] op_sel_hi:[1,0]
  v_pk_mul_f32 v[14:15], v[14:15], v[248:249] op_sel_hi:[1,0]
  v_pk_mul_f32 v[16:17], v[16:17], v[248:249] op_sel_hi:[1,0]
  v_pk_mul_f32 v[18:19], v[18:19], v[248:249] op_sel_hi:[1,0]
  v_pk_mul_f32 v[20:21], v[20:21], v[248:249] op_sel_hi:[1,0]
  v_pk_mul_f32 v[22:23], v[22:23], v[248:249] op_sel_hi:[1,0]
  v_pk_mul_f32 v[24:25], v[24:25], v[248:249] op_sel_hi:[1,0]
  v_pk_mul_f32 v[26:27], v[26:27], v[248:249] op_sel_hi:[1,0]
  v_pk_mul_f32 v[28:29], v[28:29], v[248:249] op_sel_hi:[1,0]
  v_pk_mul_f32 v[30:31], v[30:31], v[248:249] op_sel_hi:[1,0]
  v_max3_f32 v248, v192, v193, v194
  v_max3_f32 v248, v248, v195, v196
  v_max3_f32 v248, v248, v197, v198
  v_max_f32 v248, v248, v199
  v_mov_b32 v249, v248
  s_nop 1
  v_permlane16_swap_b32 v249, v248
  v_max_f32 v248, v248, v249
  v_mov_b32 v249, v248
  s_nop 1
  v_permlane32_swap_b32 v249, v248
  v_max_f32 v248, v248, v249
  v_max_f32 v248, 0, v248
  v_sub_f32 v148, v148, v248
  v_sub_f32 v149, v149, v248
  v_sub_f32 v150, v150, v248
  v_sub_f32 v151, v151, v248
  v_sub_f32 v192, v192, v248
  v_sub_f32 v193, v193, v248
  v_sub_f32 v194, v194, v248
  v_sub_f32 v195, v195, v248
  v_sub_f32 v196, v196, v248
  v_sub_f32 v197, v197, v248
  v_sub_f32 v198, v198, v248
  v_sub_f32 v199, v199, v248
  v_sub_f32 v248, 0, v248
  v_exp_f32 v248, v248
  s_nop 0
  v_mul_f32 v157, v157, v248
  v_pk_mul_f32 v[32:33], v[32:33], v[248:249] op_sel_hi:[1,0]
  v_pk_mul_f32 v[34:35], v[34:35], v[248:249] op_sel_hi:[1,0]
  v_pk_mul_f32 v[36:37], v[36:37], v[248:249] op_sel_hi:[1,0]
  v_pk_mul_f32 v[38:39], v[38:39], v[248:249] op_sel_hi:[1,0]
  v_pk_mul_f32 v[40:41], v[40:41], v[248:249] op_sel_hi:[1,0]
  v_pk_mul_f32 v[42:43], v[42:43], v[248:249] op_sel_hi:[1,0]
  v_pk_mul_f32 v[44:45], v[44:45], v[248:249] op_sel_hi:[1,0]
  v_pk_mul_f32 v[46:47], v[46:47], v[248:249] op_sel_hi:[1,0]
  v_pk_mul_f32 v[48:49], v[48:49], v[248:249] op_sel_hi:[1,0]
  v_pk_mul_f32 v[50:51], v[50:51], v[248:249] op_sel_hi:[1,0]
  v_pk_mul_f32 v[52:53], v[52:53], v[248:249] op_sel_hi:[1,0]
  v_pk_mul_f32 v[54:55], v[54:55], v[248:249] op_sel_hi:[1,0]
  v_pk_mul_f32 v[56:57], v[56:57], v[248:249] op_sel_hi:[1,0]
  v_pk_mul_f32 v[58:59], v[58:59], v[248:249] op_sel_hi:[1,0]
  v_pk_mul_f32 v[60:61], v[60:61], v[248:249] op_sel_hi:[1,0]
  v_pk_mul_f32 v[62:63], v[62:63], v[248:249] op_sel_hi:[1,0]
  v_max3_f32 v248, v200, v201, v202
  v_max3_f32 v248, v248, v203, v204
  v_max3_f32 v248, v248, v205, v206
  v_max_f32 v248, v248, v207
  v_mov_b32 v249, v248
  s_nop 1
  v_permlane16_swap_b32 v249, v248
  v_max_f32 v248, v248, v249
  v_mov_b32 v249, v248
  s_nop 1
  v_permlane32_swap_b32 v249, v248
  v_max_f32 v248, v248, v249
  v_max_f32 v248, 0, v248
  v_sub_f32 v152, v152, v248
  v_sub_f32 v153, v153, v248
  v_sub_f32 v154, v154, v248
  v_sub_f32 v155, v155, v248
  v_sub_f32 v200, v200, v248
  v_sub_f32 v201, v201, v248
  v_sub_f32 v202, v202, v248
  v_sub_f32 v203, v203, v248
  v_sub_f32 v204, v204, v248
  v_sub_f32 v205, v205, v248
  v_sub_f32 v206, v206, v248
  v_sub_f32 v207, v207, v248
  v_sub_f32 v248, 0, v248
  v_exp_f32 v248, v248
  s_nop 0
  v_mul_f32 v158, v158, v248
  v_pk_mul_f32 v[64:65], v[64:65], v[248:249] op_sel_hi:[1,0]
  v_pk_mul_f32 v[66:67], v[66:67], v[248:249] op_sel_hi:[1,0]
  v_pk_mul_f32 v[68:69], v[68:69], v[248:249] op_sel_hi:[1,0]
  v_pk_mul_f32 v[70:71], v[70:71], v[248:249] op_sel_hi:[1,0]
  v_pk_mul_f32 v[72:73], v[72:73], v[248:249] op_sel_hi:[1,0]
  v_pk_mul_f32 v[74:75], v[74:75], v[248:249] op_sel_hi:[1,0]
  v_pk_mul_f32 v[76:77], v[76:77], v[248:249] op_sel_hi:[1,0]
  v_pk_mul_f32 v[78:79], v[78:79], v[248:249] op_sel_hi:[1,0]
  v_pk_mul_f32 v[80:81], v[80:81], v[248:249] op_sel_hi:[1,0]
  v_pk_mul_f32 v[82:83], v[82:83], v[248:249] op_sel_hi:[1,0]
  v_pk_mul_f32 v[84:85], v[84:85], v[248:249] op_sel_hi:[1,0]
  v_pk_mul_f32 v[86:87], v[86:87], v[248:249] op_sel_hi:[1,0]
  v_pk_mul_f32 v[88:89], v[88:89], v[248:249] op_sel_hi:[1,0]
  v_pk_mul_f32 v[90:91], v[90:91], v[248:249] op_sel_hi:[1,0]
  v_pk_mul_f32 v[92:93], v[92:93], v[248:249] op_sel_hi:[1,0]
  v_pk_mul_f32 v[94:95], v[94:95], v[248:249] op_sel_hi:[1,0]
  v_add_u32 v241, s57, v241
  s_sub_u32 s57, 0, s57
  v_exp_f32 v184, v184
  v_exp_f32 v185, v185
  v_add_f32 v156, v156, v184
  v_exp_f32 v186, v186
  v_add_f32 v156, v156, v185
  v_exp_f32 v187, v187
  v_cvt_pk_bf16_f32 v184, v184, v185
  v_exp_f32 v188, v188
  v_add_f32 v156, v156, v186
  v_exp_f32 v189, v189
  v_add_f32 v156, v156, v187
  v_exp_f32 v190, v190
  v_cvt_pk_bf16_f32 v185, v186, v187
  v_add_f32 v156, v156, v188
  v_exp_f32 v191, v191
  v_add_f32 v156, v156, v189
  v_cvt_pk_bf16_f32 v186, v188, v189
  v_add_f32 v156, v156, v190
  v_add_f32 v156, v156, v191
  v_cvt_pk_bf16_f32 v187, v190, v191
  v_exp_f32 v192, v192
  v_exp_f32 v193, v193
  v_add_f32 v157, v157, v192
  v_exp_f32 v194, v194
  v_add_f32 v157, v157, v193
  s_nop 1
  s_branch L_rareb_159
.section .rodata,"a"
.p2align 6
.amdhsa_kernel concat_heads__gqa_block_cached__mha_block_cached__near_ridge_kernel
  .amdhsa_next_free_vgpr 256
  .amdhsa_next_free_sgpr 102
  .amdhsa_accum_offset 256
  .amdhsa_group_segment_fixed_size 0
  .amdhsa_kernarg_size 104
  .amdhsa_user_sgpr_count 2
  .amdhsa_user_sgpr_kernarg_segment_ptr 1
  .amdhsa_system_sgpr_workgroup_id_x 1
.end_amdhsa_kernel
```
